```python
import torch

def _softmax(x, axis=-1):
    return torch.softmax(x, dim=axis)
def _gelu(x):
    return torch.nn.functional.gelu(x, approximate="tanh")
def _silu(x):
    return torch.nn.functional.silu(x)
def _sigmoid(x):
    return torch.sigmoid(x)
def _layernorm(x, axis=-1, eps=1e-5):
    m = x.mean(dim=axis, keepdim=True)
    v = x.var(dim=axis, keepdim=True, unbiased=False)
    return (x - m) / torch.sqrt(v + eps)
def _scatter_add(tgt, idx, src, axis=0):
    return tgt.clone().index_add_(axis, idx, src)
def _segment_sum(src, seg, n):
    out = torch.zeros((n,) + src.shape[1:], dtype=src.dtype)
    return out.index_add_(0, seg, src)
def _pad(x, pw):
    flat = tuple(v for pair in reversed(pw) for v in pair)
    return torch.nn.functional.pad(x, flat)

kernel_name = 'gated_mix__ssm_conv_s4d__dense_activation_squared_relu__prompt'

def setup_inputs():

    _w = (lambda a: (lambda t: t.to(torch.bfloat16) if t.is_floating_point() else t)(torch.as_tensor(a)))
    def _A_setup():
        Bsz, L, D, N = 1, 2048, 640, 128
        return {
            "u": _w((lambda *s: torch.randn(*s, dtype=torch.bfloat16) * 0.05)(Bsz, L, D)),
            "log_A_real": _w((lambda *s: torch.randn(*s, dtype=torch.bfloat16) * 6.4)(D, N) * 0.5),
            "A_imag": _w((lambda *s: torch.randn(*s, dtype=torch.bfloat16) * 0.1)(D, N) * 3.14),
            "C_real": _w((lambda *s: torch.randn(*s, dtype=torch.bfloat16) * 0.4)(D, N) / N ** 0.5),
            "C_imag": _w((lambda *s: torch.randn(*s, dtype=torch.bfloat16) * 0.4)(D, N) / N ** 0.5),
            "log_dt": _w((lambda *s: torch.randn(*s, dtype=torch.bfloat16) * 0.1)(D) * 0.5 - 4.0),
            "D_skip": _w((lambda *s: torch.randn(*s, dtype=torch.bfloat16) * 0.1)(D)),
        }
    _A_in = _A_setup()

    def _B_setup():
        B, S, D, F = 1, 2048, 640, 1728
        return {
            "x": _w((lambda *s: torch.randn(*s, dtype=torch.bfloat16) * 0.05)(B, S, D)),
            "w1": _w((lambda *s: torch.randn(*s, dtype=torch.bfloat16) * 0.05)(D, F)),
            "b1": _w((lambda *s: torch.randn(*s, dtype=torch.bfloat16) * 0.05)(F)),
            "w2": _w((lambda *s: torch.randn(*s, dtype=torch.bfloat16) * 0.05)(F, D)),
            "b2": _w((lambda *s: torch.randn(*s, dtype=torch.bfloat16) * 0.05)(D)),
        }
    _B_in = _B_setup()

    return {
        "A_u": _A_in["u"],
        "A_log_A_real": _A_in["log_A_real"],
        "A_A_imag": _A_in["A_imag"],
        "A_C_real": _A_in["C_real"],
        "A_C_imag": _A_in["C_imag"],
        "A_log_dt": _A_in["log_dt"],
        "A_D_skip": _A_in["D_skip"],
        "B_x": _B_in["x"],
        "B_w1": _B_in["w1"],
        "B_b1": _B_in["b1"],
        "B_w2": _B_in["w2"],
        "B_b2": _B_in["b2"],
        "gate_w": _w((lambda *s: torch.randn(*s, dtype=torch.bfloat16) * 0.05)(640) * 16.0),
    }

def reference(A_u, A_log_A_real, A_A_imag, A_C_real, A_C_imag, A_log_dt, A_D_skip, B_x, B_w1, B_b1, B_w2, B_b2, gate_w):
    def _A_ref(u, log_A_real, A_imag, C_real, C_imag, log_dt, D_skip):
        L = u.shape[1]
        dt = torch.exp(log_dt)
        A = -torch.exp(log_A_real) + 1j * A_imag
        C = (C_real + 1j * C_imag) * dt[:, None]
        pos = (lambda x, dt: x.to(dt))(torch.arange(L), log_dt.dtype)
        P = torch.exp((A * dt[:, None])[:, :, None] * pos[None, None, :])
        K = 2.0 * torch.einsum("dn,dnl->dl", C, P).real
        L2 = 2 * L
        u_t = (lambda x, *d: x.permute(*d))(u, 0, 2, 1)
        Kf = (lambda x, *a, **k: torch.fft.rfft(x.float(), *a, **k))(K, L2)
        Uf = (lambda x, *a, **k: torch.fft.rfft(x.float(), *a, **k))(u_t, L2)
        y = (lambda x, *a, **k: torch.fft.irfft(x, *a, **k).to(torch.bfloat16))(Uf * Kf[None, :, :], L2)[:, :, :L]
        y = (lambda x, *d: x.permute(*d))(y, 0, 2, 1)
        return y + u * D_skip[None, None, :]

    def _B_ref(x, w1, b1, w2, b2):
        h = torch.einsum("bsd,df->bsf", x, w1) + b1
        zero = torch.zeros_like(h)
        r = torch.where(h > zero, h, zero)
        h = r * r
        out = torch.einsum("bsf,fd->bsd", h, w2) + b2
        return out

    x = A_u
    g = _sigmoid((x * gate_w).sum(-1, keepdims=True))
    a = _A_ref(x, A_log_A_real, A_A_imag, A_C_real, A_C_imag, A_log_dt, A_D_skip)
    b = _B_ref(x, B_w1, B_b1, B_w2, B_b2)
    return g * a + (1 - g) * b
```

```asm
; @launch grid=(512,1,1) block=(256,1,1) lds=81920
.amdgcn_target "amdgcn-amd-amdhsa--gfx950"
.text
.globl gated_mix__ssm_conv_s4d__dense_activation_squared_relu__prompt_kernel
.p2align 8
.type gated_mix__ssm_conv_s4d__dense_activation_squared_relu__prompt_kernel,@function
gated_mix__ssm_conv_s4d__dense_activation_squared_relu__prompt_kernel:
    s_getpc_b64 s[12:13]
    s_load_dwordx16 s[16:31], s[0:1], 0
    s_load_dwordx16 s[32:47], s[0:1], 64
    v_lshrrev_b32 v1, 6, v0
    s_lshr_b32 s4, s2, 3
    s_and_b32 s4, s4, 31
    s_mul_i32 s4, s4, 3072
    v_lshlrev_b32 v2, 7, v0
    v_add_u32 v2, s4, v2
    v_min_u32 v2, gated_mix__ssm_conv_s4d__dense_activation_squared_relu__prompt_kernel_end-gated_mix__ssm_conv_s4d__dense_activation_squared_relu__prompt_kernel-8, v2
    v_cmp_gt_u32 vcc, 24, v0
    s_and_saveexec_b64 s[4:5], vcc
    s_cbranch_execz pf_skip_1
    global_load_dword v223, v2, s[12:13]
pf_skip_1:
    s_mov_b64 exec, s[4:5]
    v_and_b32 v0, 63, v0
    v_readfirstlane_b32 s3, v1
    s_waitcnt lgkmcnt(0)
    s_cmp_ge_u32 s2, 512
    s_cbranch_scc1 fz_end
    s_cmp_ge_u32 s2, 256
    s_cbranch_scc1 fz_G
    s_cmp_lg_u32 s2, 0
    s_cbranch_scc1 noep_2
    s_cmp_lg_u32 s3, 0
    s_cbranch_scc1 noep_2
    s_add_u32 s12, s46, 16842752
    s_addc_u32 s13, s47, 0
    s_mov_b32 s14, 8192
    s_mov_b32 s15, 0x00020000
    v_mov_b32 v5, 0
    buffer_load_dword v4, v5, s[12:15], 0 offen offset:0 sc1
    s_waitcnt vmcnt(0)
    v_add_u32 v4, 1, v4
    v_or_b32 v4, 0x80000000, v4
    s_mov_b64 exec, 1
    buffer_store_dword v4, v5, s[12:15], 0 offen offset:0 sc1
    s_mov_b32 s12, s44
    s_mov_b32 s13, s45
    s_mov_b32 s14, 256
    s_mov_b32 s15, 0x00020000
    buffer_store_dword v4, v5, s[12:15], 0 offen sc1
    s_mov_b64 exec, -1
noep_2:
    s_setprio 3
    s_lshr_b32 s10, s2, 5
    s_and_b32 s11, s2, 31
    s_mul_i32 s14, s10, 80
    s_cmp_lt_u32 s11, 16
    s_cselect_b32 s15, 3, 2
    s_mul_i32 s12, s11, 3
    s_lshl_b32 s13, s11, 1
    s_add_u32 s13, s13, 16
    s_cmp_lt_u32 s11, 16
    s_cselect_b32 s12, s12, s13
    s_add_u32 s14, s14, s12
    s_mov_b32 s98, s14
    s_mov_b32 s99, s15
    s_mov_b32 s48, s18
    s_mov_b32 s49, s19
    s_mov_b32 s50, 163840
    s_mov_b32 s51, 0x00020000
    s_mov_b32 s52, s20
    s_mov_b32 s53, s21
    s_mov_b32 s54, 163840
    s_mov_b32 s55, 0x00020000
    s_mov_b32 s56, s22
    s_mov_b32 s57, s23
    s_mov_b32 s58, 163840
    s_mov_b32 s59, 0x00020000
    s_mov_b32 s60, s24
    s_mov_b32 s61, s25
    s_mov_b32 s62, 163840
    s_mov_b32 s63, 0x00020000
    s_mov_b32 s66, 4096
    s_mov_b32 s67, 0x00020000
    s_mov_b32 s80, s26
    s_mov_b32 s81, s27
    s_mov_b32 s82, 1280
    s_mov_b32 s83, 0x00020000
    s_mov_b32 s84, s28
    s_mov_b32 s85, s29
    s_mov_b32 s86, 1280
    s_mov_b32 s87, 0x00020000
    s_add_u32 s88, s46, 13631488
    s_addc_u32 s89, s47, 0
    s_mov_b32 s90, 2621440
    s_mov_b32 s91, 0x00020000
    s_mov_b32 s70, 0x3fb8aa3b
    s_mov_b32 s71, 0x32a57060
    s_mov_b32 s72, 0x3f317218
    s_mov_b32 s73, 0x3e22f983
    s_and_b32 s4, s3, 1
    s_lshl_b32 s5, s4, 6
    v_add_u32 v1, s5, v0
    v_lshlrev_b32 v3, 2, v1
    v_lshlrev_b32 v1, 1, v1
    v_xor_b32 v11, 128, v1
    v_mov_b32 v2, 0
    s_mov_b32 s74, s14
    s_lshl_b32 s5, s3, 6
    v_add_u32 v8, s5, v0
    v_lshlrev_b32 v8, 4, v8
    s_add_u32 s6, s74, 0
    s_min_u32 s6, s6, 639
    s_lshl_b32 s5, s6, 8
    buffer_load_ushort v176, v1, s[48:51], s5 offen
    buffer_load_ushort v177, v1, s[52:55], s5 offen
    buffer_load_ushort v178, v1, s[56:59], s5 offen
    buffer_load_ushort v179, v1, s[60:63], s5 offen
    buffer_load_ushort v181, v11, s[56:59], s5 offen
    buffer_load_ushort v182, v11, s[60:63], s5 offen
    s_lshl_b32 s5, s6, 1
    buffer_load_ushort v180, v2, s[80:83], s5 offen
    s_add_u32 s6, s74, 1
    s_min_u32 s6, s6, 639
    s_lshl_b32 s5, s6, 8
    buffer_load_ushort v184, v1, s[48:51], s5 offen
    buffer_load_ushort v185, v1, s[52:55], s5 offen
    buffer_load_ushort v186, v1, s[56:59], s5 offen
    buffer_load_ushort v187, v1, s[60:63], s5 offen
    buffer_load_ushort v189, v11, s[56:59], s5 offen
    buffer_load_ushort v190, v11, s[60:63], s5 offen
    s_lshl_b32 s5, s6, 1
    buffer_load_ushort v188, v2, s[80:83], s5 offen
    s_add_u32 s6, s74, 2
    s_min_u32 s6, s6, 639
    s_lshl_b32 s5, s6, 8
    buffer_load_ushort v192, v1, s[48:51], s5 offen
    buffer_load_ushort v193, v1, s[52:55], s5 offen
    buffer_load_ushort v194, v1, s[56:59], s5 offen
    buffer_load_ushort v195, v1, s[60:63], s5 offen
    buffer_load_ushort v197, v11, s[56:59], s5 offen
    buffer_load_ushort v198, v11, s[60:63], s5 offen
    s_lshl_b32 s5, s6, 1
    buffer_load_ushort v196, v2, s[80:83], s5 offen
    s_and_b32 s10, s2, 7
    s_lshl_b32 s10, s10, 2
    s_lshr_b32 s11, s2, 3
    s_and_b32 s12, s11, 3
    s_add_u32 s68, s10, s12
    s_lshr_b32 s69, s11, 2
    s_mov_b32 s12, s16
    s_mov_b32 s13, s17
    s_mov_b32 s14, 2621440
    s_mov_b32 s15, 0x00020000
    s_mul_i32 s4, s68, 81920
    s_mul_i32 s5, s69, 160
    s_add_u32 s4, s4, s5
    s_lshl_b32 s6, s3, 6
    s_add_u32 s6, s6, 0
    v_add_u32 v24, s6, v0
    v_mul_u32_u24 v25, 6554, v24
    v_lshrrev_b32 v25, 16, v25
    v_mul_u32_u24 v27, 10, v25
    v_sub_u32 v26, v24, v27
    v_mul_u32_u24 v25, 1280, v25
    v_lshlrev_b32 v26, 4, v26
    v_add_u32 v25, v25, v26
    s_lshl_b32 s7, s3, 10
    s_add_u32 s7, s7, 49664
    s_mov_b32 m0, s7
    s_nop 0
    buffer_load_dwordx4 v25, s[12:15], s4 offen lds
    s_lshl_b32 s6, s3, 6
    s_add_u32 s6, s6, 256
    v_add_u32 v24, s6, v0
    v_mul_u32_u24 v25, 6554, v24
    v_lshrrev_b32 v25, 16, v25
    v_mul_u32_u24 v27, 10, v25
    v_sub_u32 v26, v24, v27
    v_mul_u32_u24 v25, 1280, v25
    v_lshlrev_b32 v26, 4, v26
    v_add_u32 v25, v25, v26
    s_lshl_b32 s7, s3, 10
    s_add_u32 s7, s7, 53760
    s_mov_b32 m0, s7
    s_nop 0
    buffer_load_dwordx4 v25, s[12:15], s4 offen lds
    s_lshl_b32 s6, s3, 6
    s_add_u32 s6, s6, 512
    v_add_u32 v24, s6, v0
    v_mul_u32_u24 v25, 6554, v24
    v_lshrrev_b32 v25, 16, v25
    v_mul_u32_u24 v27, 10, v25
    v_sub_u32 v26, v24, v27
    v_mul_u32_u24 v25, 1280, v25
    v_lshlrev_b32 v26, 4, v26
    v_add_u32 v25, v25, v26
    v_mov_b32 v27, 0x40000000
    v_cmp_gt_u32 vcc, 640, v24
    s_nop 1
    v_cndmask_b32 v25, v27, v25, vcc
    s_lshl_b32 s7, s3, 10
    s_add_u32 s7, s7, 57856
    s_mov_b32 m0, s7
    s_nop 0
    buffer_load_dwordx4 v25, s[12:15], s4 offen lds
    s_mul_i32 s10, s2, 68
    s_mul_i32 s11, s3, 17
    s_add_u32 s10, s10, s11
    v_add_u32 v13, s10, v0
    v_lshlrev_b32 v13, 7, v13
    v_min_u32 v13, 2211712, v13
    s_mov_b64 exec, 0x1ffff
    global_load_dword v222, v13, s[32:33]
    global_load_dword v222, v13, s[32:33]
    global_load_dword v222, v13, s[32:33]
    s_mov_b64 exec, -1
    s_cmp_ge_u32 s3, 2
    s_mov_b32 s6, 32272
    s_cselect_b32 s5, 15376, s6
    v_add_u32 v3, s5, v3
    v_and_b32 v22, 31, v0
    v_lshrrev_b32 v23, 5, v0
    v_and_b32 v24, 15, v0
    v_lshrrev_b32 v25, 4, v0
    v_mul_u32_u24 v4, 528, v24
    v_lshl_add_u32 v4, v25, 4, v4
    s_lshr_b32 s5, s3, 1
    s_mul_i32 s5, s5, 8448
    s_add_u32 s5, s5, 15376
    s_and_b32 s6, s3, 1
    s_mul_i32 s6, s6, 8448
    s_add_u32 s6, s6, 32272
    v_add_u32 v5, s6, v4
    v_add_u32 v4, s5, v4
    v_and_b32 v24, 7, v0
    v_mul_u32_u24 v6, 4160, v24
    v_bfe_u32 v24, v0, 3, 2
    v_sub_u32 v24, v23, v24
    v_lshlrev_b32 v24, 4, v24
    v_add_u32 v6, v6, v24
    v_add_u32 v6, 48688, v6
    v_mul_u32_u24 v7, 2560, v23
    v_lshl_add_u32 v7, v22, 4, v7
    v_add_u32 v9, 48640, v8
    v_and_b32 v24, 15, v0
    s_and_b32 s6, s3, 1
    s_lshl_b32 s6, s6, 4
    v_add_u32 v24, s6, v24
    v_and_b32 v25, 1, v24
    v_mul_u32_u24 v17, 2560, v25
    v_lshrrev_b32 v24, 1, v24
    v_lshl_add_u32 v17, v24, 4, v17
    v_add_u32 v17, 512, v17
    v_lshrrev_b32 v25, 4, v0
    s_cmp_ge_u32 s3, 2
    s_cbranch_scc1 kaddr1_3
    v_lshrrev_b32 v24, 1, v25
    v_lshl_add_u32 v17, v24, 8, v17
    v_and_b32 v24, 1, v25
    v_lshl_add_u32 v17, v24, 3, v17
    v_mov_b32 v13, v17
    s_branch kaddrd_4
kaddr1_3:
    v_add_u32 v24, 2, v25
    v_lshlrev_b32 v26, 1, v25
    v_cmp_gt_u32 vcc, 2, v25
    s_nop 1
    v_cndmask_b32 v24, v26, v24, vcc
    v_lshl_add_u32 v17, v24, 8, v17
    v_add_u32 v13, 256, v17
kaddrd_4:
    v_mul_u32_u24 v18, 2064, v23
    v_lshl_add_u32 v18, v22, 4, v18
    v_mul_u32_u24 v10, 528, v23
    v_lshl_add_u32 v10, v22, 4, v10
    v_lshlrev_b32 v24, 5, v22
    v_lshl_add_u32 v24, v23, 3, v24
    v_sub_u32 v19, 78760, v24
    v_lshlrev_b32 v20, 5, v22
    v_lshl_add_u32 v20, v23, 4, v20
    v_lshlrev_b32 v21, 4, v0
    s_mov_b32 s92, 1
    s_mov_b32 s93, 1
    s_mov_b32 s94, 0
    s_mov_b32 s95, -1
    s_mov_b32 s96, 0xaaaaaaaa
    s_mov_b32 s97, 0xaaaaaaaa
    v_and_b32 v22, 31, v0
    v_lshrrev_b32 v23, 5, v0
    v_mul_u32_u24 v24, 2560, v23
    v_lshl_add_u32 v24, v22, 4, v24
    v_mov_b32 v26, 0
    v_mov_b32 v27, 0
    v_mov_b32 v28, 0
    v_mov_b32 v29, 0
    ds_write_b128 v24, v[26:29] offset:0
    ds_write_b128 v24, v[26:29] offset:5120
    ds_write_b128 v24, v[26:29] offset:10240
    s_add_u32 s75, s98, s99
    s_lshl_b32 s10, s69, 7
    s_lshl_b32 s79, s68, 2
    s_add_u32 s79, s79, s10
    s_add_u32 s79, s79, 256
    s_waitcnt vmcnt(20)
    v_lshlrev_b32 v176, 16, v176
    v_lshlrev_b32 v177, 16, v177
    v_lshlrev_b32 v178, 16, v178
    v_lshlrev_b32 v179, 16, v179
    v_lshlrev_b32 v180, 16, v180
    v_lshlrev_b32 v181, 16, v181
    v_lshlrev_b32 v182, 16, v182
    v_mul_f32 v52, s70, v180
    v_fma_f32 v53, v180, s70, -v52
    v_fma_f32 v53, v180, s71, v53
    v_exp_f32 v38, v52
    v_mul_f32 v53, s72, v53
    s_nop 0
    v_fma_f32 v38, v38, v53, v38
    v_cvt_pk_bf16_f32 v38, v38, v38
    v_lshlrev_b32 v38, 16, v38
    v_mul_f32 v54, s70, v176
    v_fma_f32 v55, v176, s70, -v54
    v_fma_f32 v55, v176, s71, v55
    v_exp_f32 v39, v54
    v_mul_f32 v55, s72, v55
    s_nop 0
    v_fma_f32 v39, v39, v55, v39
    v_cvt_pk_bf16_f32 v39, v39, v39
    v_lshlrev_b32 v39, 16, v39
    v_mul_f32 v39, v39, v38
    v_mul_f32 v39, s70, v39
    v_sub_f32 v48, 0, v39
    v_mul_f32 v49, v177, v38
    v_mul_f32 v49, s73, v49
    v_mul_f32 v52, v178, v38
    v_mul_f32 v53, v179, v38
    v_add_f32 v52, v52, v52
    v_add_f32 v53, v53, v53
    v_max_f32 v54, |v52|, |v53|
    v_max_f32 v55, |v181|, |v182|
    v_mul_f32 v55, v55, v38
    v_add_f32 v55, v55, v55
    v_max_f32 v54, v54, v55
    s_cmp_ge_u32 s3, 2
    s_cbranch_scc1 kg0_A_5
    v_mov_b32 v56, 1.0
    v_mov_b32 v57, 0
    v_mul_f32 v76, 0x41000000, v48
    v_mul_f32 v77, 0x41000000, v49
    v_mul_f32 v79, 0x42000000, v48
    v_mul_f32 v80, 0x42000000, v49
    v_mul_f32 v82, 0x41800000, v48
    v_mul_f32 v83, 0x41800000, v49
    v_mul_f32 v85, 0x41c00000, v48
    v_mul_f32 v86, 0x41c00000, v49
    v_exp_f32 v76, v76
    v_fract_f32 v77, v77
    v_exp_f32 v79, v79
    v_fract_f32 v80, v80
    v_exp_f32 v82, v82
    v_fract_f32 v83, v83
    v_exp_f32 v85, v85
    v_fract_f32 v86, v86
    v_cos_f32 v78, v77
    v_sin_f32 v77, v77
    v_cos_f32 v81, v80
    v_sin_f32 v80, v80
    v_cos_f32 v84, v83
    v_sin_f32 v83, v83
    v_cos_f32 v87, v86
    v_sin_f32 v86, v86
    s_nop 0
    v_mul_f32 v58, v76, v78
    v_mul_f32 v59, v76, v77
    v_mul_f32 v64, v79, v81
    v_mul_f32 v65, v79, v80
    v_mul_f32 v60, v82, v84
    v_mul_f32 v61, v82, v83
    v_mul_f32 v62, v85, v87
    v_mul_f32 v63, v85, v86
    v_pk_mul_f32 v[66:67], v[56:57], v[64:65] op_sel:[0,0] op_sel_hi:[0,1]
    v_pk_mul_f32 v[68:69], v[58:59], v[64:65] op_sel:[0,0] op_sel_hi:[0,1]
    v_pk_mul_f32 v[70:71], v[60:61], v[64:65] op_sel:[0,0] op_sel_hi:[0,1]
    v_pk_mul_f32 v[72:73], v[62:63], v[64:65] op_sel:[0,0] op_sel_hi:[0,1]
    v_pk_fma_f32 v[66:67], v[56:57], v[64:65], v[66:67] op_sel:[1,1,0] op_sel_hi:[1,0,1] neg_lo:[1,0,0]
    v_pk_fma_f32 v[68:69], v[58:59], v[64:65], v[68:69] op_sel:[1,1,0] op_sel_hi:[1,0,1] neg_lo:[1,0,0]
    v_pk_fma_f32 v[70:71], v[60:61], v[64:65], v[70:71] op_sel:[1,1,0] op_sel_hi:[1,0,1] neg_lo:[1,0,0]
    v_pk_fma_f32 v[72:73], v[62:63], v[64:65], v[72:73] op_sel:[1,1,0] op_sel_hi:[1,0,1] neg_lo:[1,0,0]
    v_cvt_pk_f16_f32 v100, v56, v57
    v_cvt_pk_f16_f32 v101, v58, v59
    v_cvt_pk_f16_f32 v102, v60, v61
    v_cvt_pk_f16_f32 v103, v62, v63
    ds_write_b32 v3, v100 offset:0
    ds_write_b32 v3, v101 offset:528
    ds_write_b32 v3, v102 offset:1056
    ds_write_b32 v3, v103 offset:1584
    v_pk_mul_f32 v[56:57], v[66:67], v[64:65] op_sel:[0,0] op_sel_hi:[0,1]
    v_pk_mul_f32 v[58:59], v[68:69], v[64:65] op_sel:[0,0] op_sel_hi:[0,1]
    v_pk_mul_f32 v[60:61], v[70:71], v[64:65] op_sel:[0,0] op_sel_hi:[0,1]
    v_pk_mul_f32 v[62:63], v[72:73], v[64:65] op_sel:[0,0] op_sel_hi:[0,1]
    v_pk_fma_f32 v[56:57], v[66:67], v[64:65], v[56:57] op_sel:[1,1,0] op_sel_hi:[1,0,1] neg_lo:[1,0,0]
    v_pk_fma_f32 v[58:59], v[68:69], v[64:65], v[58:59] op_sel:[1,1,0] op_sel_hi:[1,0,1] neg_lo:[1,0,0]
    v_pk_fma_f32 v[60:61], v[70:71], v[64:65], v[60:61] op_sel:[1,1,0] op_sel_hi:[1,0,1] neg_lo:[1,0,0]
    v_pk_fma_f32 v[62:63], v[72:73], v[64:65], v[62:63] op_sel:[1,1,0] op_sel_hi:[1,0,1] neg_lo:[1,0,0]
    v_cvt_pk_f16_f32 v100, v66, v67
    v_cvt_pk_f16_f32 v101, v68, v69
    v_cvt_pk_f16_f32 v102, v70, v71
    v_cvt_pk_f16_f32 v103, v72, v73
    ds_write_b32 v3, v100 offset:2112
    ds_write_b32 v3, v101 offset:2640
    ds_write_b32 v3, v102 offset:3168
    ds_write_b32 v3, v103 offset:3696
    v_pk_mul_f32 v[66:67], v[56:57], v[64:65] op_sel:[0,0] op_sel_hi:[0,1]
    v_pk_mul_f32 v[68:69], v[58:59], v[64:65] op_sel:[0,0] op_sel_hi:[0,1]
    v_pk_mul_f32 v[70:71], v[60:61], v[64:65] op_sel:[0,0] op_sel_hi:[0,1]
    v_pk_mul_f32 v[72:73], v[62:63], v[64:65] op_sel:[0,0] op_sel_hi:[0,1]
    v_pk_fma_f32 v[66:67], v[56:57], v[64:65], v[66:67] op_sel:[1,1,0] op_sel_hi:[1,0,1] neg_lo:[1,0,0]
    v_pk_fma_f32 v[68:69], v[58:59], v[64:65], v[68:69] op_sel:[1,1,0] op_sel_hi:[1,0,1] neg_lo:[1,0,0]
    v_pk_fma_f32 v[70:71], v[60:61], v[64:65], v[70:71] op_sel:[1,1,0] op_sel_hi:[1,0,1] neg_lo:[1,0,0]
    v_pk_fma_f32 v[72:73], v[62:63], v[64:65], v[72:73] op_sel:[1,1,0] op_sel_hi:[1,0,1] neg_lo:[1,0,0]
    v_cvt_pk_f16_f32 v100, v56, v57
    v_cvt_pk_f16_f32 v101, v58, v59
    v_cvt_pk_f16_f32 v102, v60, v61
    v_cvt_pk_f16_f32 v103, v62, v63
    ds_write_b32 v3, v100 offset:4224
    ds_write_b32 v3, v101 offset:4752
    ds_write_b32 v3, v102 offset:5280
    ds_write_b32 v3, v103 offset:5808
    v_pk_mul_f32 v[56:57], v[66:67], v[64:65] op_sel:[0,0] op_sel_hi:[0,1]
    v_pk_mul_f32 v[58:59], v[68:69], v[64:65] op_sel:[0,0] op_sel_hi:[0,1]
    v_pk_mul_f32 v[60:61], v[70:71], v[64:65] op_sel:[0,0] op_sel_hi:[0,1]
    v_pk_mul_f32 v[62:63], v[72:73], v[64:65] op_sel:[0,0] op_sel_hi:[0,1]
    v_pk_fma_f32 v[56:57], v[66:67], v[64:65], v[56:57] op_sel:[1,1,0] op_sel_hi:[1,0,1] neg_lo:[1,0,0]
    v_pk_fma_f32 v[58:59], v[68:69], v[64:65], v[58:59] op_sel:[1,1,0] op_sel_hi:[1,0,1] neg_lo:[1,0,0]
    v_pk_fma_f32 v[60:61], v[70:71], v[64:65], v[60:61] op_sel:[1,1,0] op_sel_hi:[1,0,1] neg_lo:[1,0,0]
    v_pk_fma_f32 v[62:63], v[72:73], v[64:65], v[62:63] op_sel:[1,1,0] op_sel_hi:[1,0,1] neg_lo:[1,0,0]
    v_cvt_pk_f16_f32 v100, v66, v67
    v_cvt_pk_f16_f32 v101, v68, v69
    v_cvt_pk_f16_f32 v102, v70, v71
    v_cvt_pk_f16_f32 v103, v72, v73
    ds_write_b32 v3, v100 offset:6336
    ds_write_b32 v3, v101 offset:6864
    ds_write_b32 v3, v102 offset:7392
    ds_write_b32 v3, v103 offset:7920
    v_pk_mul_f32 v[66:67], v[56:57], v[64:65] op_sel:[0,0] op_sel_hi:[0,1]
    v_pk_mul_f32 v[68:69], v[58:59], v[64:65] op_sel:[0,0] op_sel_hi:[0,1]
    v_pk_mul_f32 v[70:71], v[60:61], v[64:65] op_sel:[0,0] op_sel_hi:[0,1]
    v_pk_mul_f32 v[72:73], v[62:63], v[64:65] op_sel:[0,0] op_sel_hi:[0,1]
    v_pk_fma_f32 v[66:67], v[56:57], v[64:65], v[66:67] op_sel:[1,1,0] op_sel_hi:[1,0,1] neg_lo:[1,0,0]
    v_pk_fma_f32 v[68:69], v[58:59], v[64:65], v[68:69] op_sel:[1,1,0] op_sel_hi:[1,0,1] neg_lo:[1,0,0]
    v_pk_fma_f32 v[70:71], v[60:61], v[64:65], v[70:71] op_sel:[1,1,0] op_sel_hi:[1,0,1] neg_lo:[1,0,0]
    v_pk_fma_f32 v[72:73], v[62:63], v[64:65], v[72:73] op_sel:[1,1,0] op_sel_hi:[1,0,1] neg_lo:[1,0,0]
    v_cvt_pk_f16_f32 v100, v56, v57
    v_cvt_pk_f16_f32 v101, v58, v59
    v_cvt_pk_f16_f32 v102, v60, v61
    v_cvt_pk_f16_f32 v103, v62, v63
    ds_write_b32 v3, v100 offset:8448
    ds_write_b32 v3, v101 offset:8976
    ds_write_b32 v3, v102 offset:9504
    ds_write_b32 v3, v103 offset:10032
    v_pk_mul_f32 v[56:57], v[66:67], v[64:65] op_sel:[0,0] op_sel_hi:[0,1]
    v_pk_mul_f32 v[58:59], v[68:69], v[64:65] op_sel:[0,0] op_sel_hi:[0,1]
    v_pk_mul_f32 v[60:61], v[70:71], v[64:65] op_sel:[0,0] op_sel_hi:[0,1]
    v_pk_mul_f32 v[62:63], v[72:73], v[64:65] op_sel:[0,0] op_sel_hi:[0,1]
    v_pk_fma_f32 v[56:57], v[66:67], v[64:65], v[56:57] op_sel:[1,1,0] op_sel_hi:[1,0,1] neg_lo:[1,0,0]
    v_pk_fma_f32 v[58:59], v[68:69], v[64:65], v[58:59] op_sel:[1,1,0] op_sel_hi:[1,0,1] neg_lo:[1,0,0]
    v_pk_fma_f32 v[60:61], v[70:71], v[64:65], v[60:61] op_sel:[1,1,0] op_sel_hi:[1,0,1] neg_lo:[1,0,0]
    v_pk_fma_f32 v[62:63], v[72:73], v[64:65], v[62:63] op_sel:[1,1,0] op_sel_hi:[1,0,1] neg_lo:[1,0,0]
    v_cvt_pk_f16_f32 v100, v66, v67
    v_cvt_pk_f16_f32 v101, v68, v69
    v_cvt_pk_f16_f32 v102, v70, v71
    v_cvt_pk_f16_f32 v103, v72, v73
    ds_write_b32 v3, v100 offset:10560
    ds_write_b32 v3, v101 offset:11088
    ds_write_b32 v3, v102 offset:11616
    ds_write_b32 v3, v103 offset:12144
    v_pk_mul_f32 v[66:67], v[56:57], v[64:65] op_sel:[0,0] op_sel_hi:[0,1]
    v_pk_mul_f32 v[68:69], v[58:59], v[64:65] op_sel:[0,0] op_sel_hi:[0,1]
    v_pk_mul_f32 v[70:71], v[60:61], v[64:65] op_sel:[0,0] op_sel_hi:[0,1]
    v_pk_mul_f32 v[72:73], v[62:63], v[64:65] op_sel:[0,0] op_sel_hi:[0,1]
    v_pk_fma_f32 v[66:67], v[56:57], v[64:65], v[66:67] op_sel:[1,1,0] op_sel_hi:[1,0,1] neg_lo:[1,0,0]
    v_pk_fma_f32 v[68:69], v[58:59], v[64:65], v[68:69] op_sel:[1,1,0] op_sel_hi:[1,0,1] neg_lo:[1,0,0]
    v_pk_fma_f32 v[70:71], v[60:61], v[64:65], v[70:71] op_sel:[1,1,0] op_sel_hi:[1,0,1] neg_lo:[1,0,0]
    v_pk_fma_f32 v[72:73], v[62:63], v[64:65], v[72:73] op_sel:[1,1,0] op_sel_hi:[1,0,1] neg_lo:[1,0,0]
    v_cvt_pk_f16_f32 v100, v56, v57
    v_cvt_pk_f16_f32 v101, v58, v59
    v_cvt_pk_f16_f32 v102, v60, v61
    v_cvt_pk_f16_f32 v103, v62, v63
    ds_write_b32 v3, v100 offset:12672
    ds_write_b32 v3, v101 offset:13200
    ds_write_b32 v3, v102 offset:13728
    ds_write_b32 v3, v103 offset:14256
    v_cvt_pk_f16_f32 v100, v66, v67
    v_cvt_pk_f16_f32 v101, v68, v69
    v_cvt_pk_f16_f32 v102, v70, v71
    v_cvt_pk_f16_f32 v103, v72, v73
    ds_write_b32 v3, v100 offset:14784
    ds_write_b32 v3, v101 offset:15312
    ds_write_b32 v3, v102 offset:15840
    ds_write_b32 v3, v103 offset:16368
    s_branch kg0_Tdone_6
kg0_A_5:
    v_mul_f32 v70, 0x3f800000, v48
    v_mul_f32 v71, 0x3f800000, v49
    v_mul_f32 v73, 0x41000000, v48
    v_mul_f32 v74, 0x41000000, v49
    v_mul_f32 v76, 0x43800000, v48
    v_mul_f32 v77, 0x43800000, v49
    v_mul_f32 v79, 0x40000000, v48
    v_mul_f32 v80, 0x40000000, v49
    v_mul_f32 v82, 0x40800000, v48
    v_mul_f32 v83, 0x40800000, v49
    v_exp_f32 v70, v70
    v_fract_f32 v71, v71
    v_exp_f32 v73, v73
    v_fract_f32 v74, v74
    v_exp_f32 v76, v76
    v_fract_f32 v77, v77
    v_exp_f32 v79, v79
    v_fract_f32 v80, v80
    v_exp_f32 v82, v82
    v_fract_f32 v83, v83
    v_cos_f32 v72, v71
    v_sin_f32 v71, v71
    v_cos_f32 v75, v74
    v_sin_f32 v74, v74
    v_cos_f32 v78, v77
    v_sin_f32 v77, v77
    v_cos_f32 v81, v80
    v_sin_f32 v80, v80
    v_cos_f32 v84, v83
    v_sin_f32 v83, v83
    s_nop 0
    v_mul_f32 v56, v70, v72
    v_mul_f32 v57, v70, v71
    v_mul_f32 v62, v73, v75
    v_mul_f32 v63, v73, v74
    v_mul_f32 v64, v76, v78
    v_mul_f32 v65, v76, v77
    v_mul_f32 v58, v79, v81
    v_mul_f32 v59, v79, v80
    v_mul_f32 v60, v82, v84
    v_mul_f32 v61, v82, v83
    s_nop 0
    v_max_f32_dpp v54, v54, v54 row_ror:8 row_mask:0xf bank_mask:0xf
    s_nop 0
    s_nop 0
    v_max_f32_dpp v54, v54, v54 row_ror:4 row_mask:0xf bank_mask:0xf
    s_nop 0
    s_nop 0
    v_max_f32_dpp v54, v54, v54 row_ror:2 row_mask:0xf bank_mask:0xf
    s_nop 0
    s_nop 0
    v_max_f32_dpp v54, v54, v54 row_ror:1 row_mask:0xf bank_mask:0xf
    s_nop 0
    v_readlane_b32 s8, v54, 0
    v_readlane_b32 s9, v54, 16
    v_readlane_b32 s10, v54, 32
    v_readlane_b32 s11, v54, 48
    s_nop 1
    s_max_u32 s8, s8, s9
    s_max_u32 s10, s10, s11
    s_max_u32 s8, s8, s10
    s_lshr_b32 s8, s8, 23
    s_min_u32 s8, s8, 252
    s_sub_u32 s9, 253, s8
    s_lshl_b32 s9, s9, 23
    s_add_u32 s10, s8, 1
    s_lshl_b32 s10, s10, 23
    v_mul_f32 v52, s9, v52
    v_mul_f32 v53, s9, v53
    v_mov_b32 v54, s10
    v_mov_b32 v55, 15360
    ds_write_b32 v55, v54
    v_cvt_pk_f16_f32 v100, v52, -v53
    ds_write_b32 v3, v100 offset:0
    v_pk_mul_f32 v[66:67], v[52:53], v[56:57] op_sel:[0,0] op_sel_hi:[0,1]
    v_pk_mul_f32 v[68:69], v[52:53], v[58:59] op_sel:[0,0] op_sel_hi:[0,1]
    v_pk_mul_f32 v[70:71], v[52:53], v[60:61] op_sel:[0,0] op_sel_hi:[0,1]
    v_pk_mul_f32 v[72:73], v[52:53], v[64:65] op_sel:[0,0] op_sel_hi:[0,1]
    v_pk_fma_f32 v[66:67], v[52:53], v[56:57], v[66:67] op_sel:[1,1,0] op_sel_hi:[1,0,1] neg_lo:[1,0,0]
    v_pk_fma_f32 v[68:69], v[52:53], v[58:59], v[68:69] op_sel:[1,1,0] op_sel_hi:[1,0,1] neg_lo:[1,0,0]
    v_pk_fma_f32 v[70:71], v[52:53], v[60:61], v[70:71] op_sel:[1,1,0] op_sel_hi:[1,0,1] neg_lo:[1,0,0]
    v_pk_fma_f32 v[72:73], v[52:53], v[64:65], v[72:73] op_sel:[1,1,0] op_sel_hi:[1,0,1] neg_lo:[1,0,0]
    v_cvt_pk_f16_f32 v100, v66, -v67
    v_cvt_pk_f16_f32 v101, v68, -v69
    v_cvt_pk_f16_f32 v102, v70, -v71
    v_cvt_pk_f16_f32 v103, v72, -v73
    ds_write_b32 v3, v100 offset:528
    ds_write_b32 v3, v101 offset:1056
    ds_write_b32 v3, v102 offset:2112
    ds_write_b32 v3, v103 offset:4224
    v_pk_mul_f32 v[74:75], v[68:69], v[56:57] op_sel:[0,0] op_sel_hi:[0,1]
    v_pk_mul_f32 v[76:77], v[70:71], v[56:57] op_sel:[0,0] op_sel_hi:[0,1]
    v_pk_mul_f32 v[78:79], v[70:71], v[58:59] op_sel:[0,0] op_sel_hi:[0,1]
    v_pk_mul_f32 v[80:81], v[72:73], v[64:65] op_sel:[0,0] op_sel_hi:[0,1]
    v_pk_fma_f32 v[74:75], v[68:69], v[56:57], v[74:75] op_sel:[1,1,0] op_sel_hi:[1,0,1] neg_lo:[1,0,0]
    v_pk_fma_f32 v[76:77], v[70:71], v[56:57], v[76:77] op_sel:[1,1,0] op_sel_hi:[1,0,1] neg_lo:[1,0,0]
    v_pk_fma_f32 v[78:79], v[70:71], v[58:59], v[78:79] op_sel:[1,1,0] op_sel_hi:[1,0,1] neg_lo:[1,0,0]
    v_pk_fma_f32 v[80:81], v[72:73], v[64:65], v[80:81] op_sel:[1,1,0] op_sel_hi:[1,0,1] neg_lo:[1,0,0]
    v_cvt_pk_f16_f32 v100, v74, -v75
    v_cvt_pk_f16_f32 v101, v76, -v77
    v_cvt_pk_f16_f32 v102, v78, -v79
    v_cvt_pk_f16_f32 v103, v80, -v81
    ds_write_b32 v3, v100 offset:1584
    ds_write_b32 v3, v101 offset:2640
    ds_write_b32 v3, v102 offset:3168
    ds_write_b32 v3, v103 offset:8448
    v_pk_mul_f32 v[82:83], v[78:79], v[56:57] op_sel:[0,0] op_sel_hi:[0,1]
    v_pk_mul_f32 v[84:85], v[72:73], v[58:59] op_sel:[0,0] op_sel_hi:[0,1]
    v_pk_mul_f32 v[86:87], v[72:73], v[60:61] op_sel:[0,0] op_sel_hi:[0,1]
    v_pk_mul_f32 v[88:89], v[72:73], v[62:63] op_sel:[0,0] op_sel_hi:[0,1]
    v_pk_fma_f32 v[82:83], v[78:79], v[56:57], v[82:83] op_sel:[1,1,0] op_sel_hi:[1,0,1] neg_lo:[1,0,0]
    v_pk_fma_f32 v[84:85], v[72:73], v[58:59], v[84:85] op_sel:[1,1,0] op_sel_hi:[1,0,1] neg_lo:[1,0,0]
    v_pk_fma_f32 v[86:87], v[72:73], v[60:61], v[86:87] op_sel:[1,1,0] op_sel_hi:[1,0,1] neg_lo:[1,0,0]
    v_pk_fma_f32 v[88:89], v[72:73], v[62:63], v[88:89] op_sel:[1,1,0] op_sel_hi:[1,0,1] neg_lo:[1,0,0]
    v_cvt_pk_f16_f32 v100, v82, -v83
    v_cvt_pk_f16_f32 v101, v84, -v85
    v_cvt_pk_f16_f32 v102, v86, -v87
    v_cvt_pk_f16_f32 v103, v86, -v87
    v_cvt_pk_f16_f32 v104, v88, -v89
    ds_write_b32 v3, v100 offset:3696
    ds_write_b32 v3, v101 offset:4752
    ds_write_b32 v3, v102 offset:5280
    ds_write_b32 v3, v103 offset:6336
    ds_write_b32 v3, v104 offset:7392
    v_pk_mul_f32 v[90:91], v[86:87], v[58:59] op_sel:[0,0] op_sel_hi:[0,1]
    v_pk_mul_f32 v[92:93], v[80:81], v[64:65] op_sel:[0,0] op_sel_hi:[0,1]
    v_pk_fma_f32 v[90:91], v[86:87], v[58:59], v[90:91] op_sel:[1,1,0] op_sel_hi:[1,0,1] neg_lo:[1,0,0]
    v_pk_fma_f32 v[92:93], v[80:81], v[64:65], v[92:93] op_sel:[1,1,0] op_sel_hi:[1,0,1] neg_lo:[1,0,0]
    v_cvt_pk_f16_f32 v100, v90, -v91
    v_cvt_pk_f16_f32 v101, v92, -v93
    ds_write_b32 v3, v100 offset:6864
    ds_write_b32 v3, v101 offset:10560
    v_pk_mul_f32 v[66:67], v[80:81], v[60:61] op_sel:[0,0] op_sel_hi:[0,1]
    v_pk_mul_f32 v[68:69], v[80:81], v[62:63] op_sel:[0,0] op_sel_hi:[0,1]
    v_pk_mul_f32 v[70:71], v[92:93], v[64:65] op_sel:[0,0] op_sel_hi:[0,1]
    v_pk_fma_f32 v[66:67], v[80:81], v[60:61], v[66:67] op_sel:[1,1,0] op_sel_hi:[1,0,1] neg_lo:[1,0,0]
    v_pk_fma_f32 v[68:69], v[80:81], v[62:63], v[68:69] op_sel:[1,1,0] op_sel_hi:[1,0,1] neg_lo:[1,0,0]
    v_pk_fma_f32 v[70:71], v[92:93], v[64:65], v[70:71] op_sel:[1,1,0] op_sel_hi:[1,0,1] neg_lo:[1,0,0]
    v_cvt_pk_f16_f32 v100, v66, -v67
    v_cvt_pk_f16_f32 v101, v68, -v69
    v_cvt_pk_f16_f32 v102, v70, -v71
    ds_write_b32 v3, v100 offset:8976
    ds_write_b32 v3, v101 offset:9504
    ds_write_b32 v3, v102 offset:12672
    v_pk_mul_f32 v[72:73], v[92:93], v[60:61] op_sel:[0,0] op_sel_hi:[0,1]
    v_pk_mul_f32 v[74:75], v[92:93], v[62:63] op_sel:[0,0] op_sel_hi:[0,1]
    v_pk_mul_f32 v[76:77], v[70:71], v[62:63] op_sel:[0,0] op_sel_hi:[0,1]
    v_pk_mul_f32 v[78:79], v[70:71], v[64:65] op_sel:[0,0] op_sel_hi:[0,1]
    v_pk_fma_f32 v[72:73], v[92:93], v[60:61], v[72:73] op_sel:[1,1,0] op_sel_hi:[1,0,1] neg_lo:[1,0,0]
    v_pk_fma_f32 v[74:75], v[92:93], v[62:63], v[74:75] op_sel:[1,1,0] op_sel_hi:[1,0,1] neg_lo:[1,0,0]
    v_pk_fma_f32 v[76:77], v[70:71], v[62:63], v[76:77] op_sel:[1,1,0] op_sel_hi:[1,0,1] neg_lo:[1,0,0]
    v_pk_fma_f32 v[78:79], v[70:71], v[64:65], v[78:79] op_sel:[1,1,0] op_sel_hi:[1,0,1] neg_lo:[1,0,0]
    v_cvt_pk_f16_f32 v100, v72, -v73
    v_cvt_pk_f16_f32 v101, v74, -v75
    v_cvt_pk_f16_f32 v102, v76, -v77
    v_cvt_pk_f16_f32 v103, v78, -v79
    ds_write_b32 v3, v100 offset:11088
    ds_write_b32 v3, v101 offset:11616
    ds_write_b32 v3, v102 offset:13200
    ds_write_b32 v3, v103 offset:13728
    v_pk_mul_f32 v[80:81], v[78:79], v[62:63] op_sel:[0,0] op_sel_hi:[0,1]
    v_pk_mul_f32 v[82:83], v[78:79], v[64:65] op_sel:[0,0] op_sel_hi:[0,1]
    v_pk_fma_f32 v[80:81], v[78:79], v[62:63], v[80:81] op_sel:[1,1,0] op_sel_hi:[1,0,1] neg_lo:[1,0,0]
    v_pk_fma_f32 v[82:83], v[78:79], v[64:65], v[82:83] op_sel:[1,1,0] op_sel_hi:[1,0,1] neg_lo:[1,0,0]
    v_cvt_pk_f16_f32 v100, v80, -v81
    v_cvt_pk_f16_f32 v101, v82, -v83
    ds_write_b32 v3, v100 offset:14256
    ds_write_b32 v3, v101 offset:14784
    v_pk_mul_f32 v[84:85], v[82:83], v[62:63] op_sel:[0,0] op_sel_hi:[0,1]
    v_pk_mul_f32 v[86:87], v[82:83], v[64:65] op_sel:[0,0] op_sel_hi:[0,1]
    v_pk_fma_f32 v[84:85], v[82:83], v[62:63], v[84:85] op_sel:[1,1,0] op_sel_hi:[1,0,1] neg_lo:[1,0,0]
    v_pk_fma_f32 v[86:87], v[82:83], v[64:65], v[86:87] op_sel:[1,1,0] op_sel_hi:[1,0,1] neg_lo:[1,0,0]
    v_cvt_pk_f16_f32 v100, v84, -v85
    v_cvt_pk_f16_f32 v101, v86, -v87
    ds_write_b32 v3, v100 offset:15312
    ds_write_b32 v3, v101 offset:15840
    v_pk_mul_f32 v[88:89], v[86:87], v[62:63] op_sel:[0,0] op_sel_hi:[0,1]
    v_pk_fma_f32 v[88:89], v[86:87], v[62:63], v[88:89] op_sel:[1,1,0] op_sel_hi:[1,0,1] neg_lo:[1,0,0]
    v_cvt_pk_f16_f32 v100, v88, -v89
    ds_write_b32 v3, v100 offset:16368
kg0_Tdone_6:
    s_mov_b32 s12, s46
    s_mov_b32 s13, s47
    s_mov_b32 s14, 2621440
    s_mov_b32 s15, 0x00020000
    v_lshrrev_b32 v52, 4, v0
    v_bfe_u32 v53, v0, 2, 2
    v_and_b32 v54, 3, v0
    v_lshlrev_b32 v55, 2, v52
    v_sub_u32 v55, v55, v53
    s_lshl_b32 s6, s3, 4
    s_add_u32 s6, s6, 3
    v_add_u32 v55, s6, v55
    v_mul_u32_u24 v55, 160, v55
    v_lshlrev_b32 v54, 3, v54
    v_add_u32 v55, v55, v54
    v_add_u32 v55, 49664, v55
    v_and_b32 v56, 15, v0
    v_mul_u32_u24 v56, 144, v56
    v_lshlrev_b32 v57, 3, v52
    v_sub_u32 v56, v56, v57
    s_lshl_b32 s6, s3, 5
    s_sub_u32 s6, 62072, s6
    v_add_u32 v56, s6, v56
    v_lshrrev_b32 v52, 3, v0
    v_and_b32 v53, 7, v0
    v_mul_u32_u24 v57, 144, v52
    v_lshlrev_b32 v53, 4, v53
    v_add_u32 v57, v57, v53
    s_mul_i32 s6, s3, 1152
    s_add_u32 s6, s6, 61952
    v_add_u32 v57, s6, v57
    v_mul_u32_u24 v52, 4096, v52
    v_add_u32 v52, v52, v53
    s_mul_i32 s6, s69, 327680
    s_mul_i32 s7, s3, 32768
    s_add_u32 s6, s6, s7
    s_lshl_b32 s7, s68, 7
    s_sub_u32 s6, s6, s7
    s_add_u32 s6, s6, 3968
    s_waitcnt vmcnt(3)
    s_barrier
    ds_read_b64_tr_b16 v[60:61], v55 offset:0
    ds_read_b64_tr_b16 v[62:63], v55 offset:32
    ds_read_b64_tr_b16 v[64:65], v55 offset:64
    ds_read_b64_tr_b16 v[66:67], v55 offset:96
    ds_read_b64_tr_b16 v[68:69], v55 offset:128
    s_waitcnt lgkmcnt(4)
    ds_write_b64 v56, v[60:61] offset:0
    s_waitcnt lgkmcnt(3)
    ds_write_b64 v56, v[62:63] offset:2304
    s_waitcnt lgkmcnt(2)
    ds_write_b64 v56, v[64:65] offset:4608
    s_waitcnt lgkmcnt(1)
    ds_write_b64 v56, v[66:67] offset:6912
    s_waitcnt lgkmcnt(0)
    ds_write_b64 v56, v[68:69] offset:9216
    s_waitcnt lgkmcnt(0)
    s_barrier
    ds_read_b128 v[60:63], v57
    ds_read_b128 v[64:67], v57 offset:4608
    ds_read_b128 v[68:71], v57 offset:9216
    s_waitcnt lgkmcnt(2)
    buffer_store_dwordx4 v[60:63], v52, s[12:15], s6 offen sc1
    s_add_u32 s6, s6, 131072
    s_waitcnt lgkmcnt(1)
    buffer_store_dwordx4 v[64:67], v52, s[12:15], s6 offen sc1
    s_add_u32 s6, s6, 131072
    s_waitcnt lgkmcnt(0)
    s_cmp_ge_u32 s3, 2
    s_cbranch_scc1 T_skip_7
    buffer_store_dwordx4 v[68:71], v52, s[12:15], s6 offen sc1
T_skip_7:
    s_mov_b32 s12, s44
    s_mov_b32 s13, s45
    s_mov_b32 s14, 256
    s_mov_b32 s15, 0x00020000
    buffer_load_dword v12, v2, s[12:15], 0 offen sc1
    s_waitcnt lgkmcnt(0)
    s_barrier
    v_mov_b32 v53, 15360
    ds_read_b32 v54, v53
    ds_read_b128 v[96:99], v4 offset:0
    ds_read_b128 v[100:103], v5 offset:0
    ds_read_b128 v[104:107], v4 offset:64
    ds_read_b128 v[108:111], v5 offset:64
    ds_read_b128 v[112:115], v4 offset:128
    ds_read_b128 v[116:119], v5 offset:128
    ds_read_b128 v[120:123], v4 offset:192
    ds_read_b128 v[124:127], v5 offset:192
    ds_read_b128 v[128:131], v4 offset:256
    ds_read_b128 v[132:135], v5 offset:256
    ds_read_b128 v[136:139], v4 offset:320
    ds_read_b128 v[140:143], v5 offset:320
    v_mov_b32 v64, 0
    v_mov_b32 v65, 0
    v_mov_b32 v66, 0
    v_mov_b32 v67, 0
    s_nop 0
    s_waitcnt lgkmcnt(10)
    v_mfma_f32_16x16x32_f16 v[64:67], v[96:99], v[100:103], v[64:67]
    ds_read_b128 v[96:99], v4 offset:384
    ds_read_b128 v[100:103], v5 offset:384
    s_waitcnt lgkmcnt(10)
    v_mfma_f32_16x16x32_f16 v[64:67], v[104:107], v[108:111], v[64:67]
    ds_read_b128 v[104:107], v4 offset:448
    ds_read_b128 v[108:111], v5 offset:448
    s_waitcnt lgkmcnt(10)
    v_mfma_f32_16x16x32_f16 v[64:67], v[112:115], v[116:119], v[64:67]
    s_waitcnt lgkmcnt(8)
    v_mfma_f32_16x16x32_f16 v[64:67], v[120:123], v[124:127], v[64:67]
    s_waitcnt lgkmcnt(6)
    v_mfma_f32_16x16x32_f16 v[64:67], v[128:131], v[132:135], v[64:67]
    s_waitcnt lgkmcnt(4)
    v_mfma_f32_16x16x32_f16 v[64:67], v[136:139], v[140:143], v[64:67]
    s_waitcnt lgkmcnt(2)
    v_mfma_f32_16x16x32_f16 v[64:67], v[96:99], v[100:103], v[64:67]
    s_waitcnt lgkmcnt(0)
    v_mfma_f32_16x16x32_f16 v[64:67], v[104:107], v[108:111], v[64:67]
    s_nop 7
    v_mul_f32 v64, v54, v64
    v_mul_f32 v65, v54, v65
    v_mul_f32 v66, v54, v66
    v_mul_f32 v67, v54, v67
    s_cmp_ge_u32 s3, 2
    s_cbranch_scc1 kg0_R1_8
    v_cndmask_b32 v70, v65, v64, s[94:95]
    v_cndmask_b32 v71, v66, v65, s[94:95]
    v_cndmask_b32 v72, v67, v66, s[94:95]
    v_cvt_pk_bf16_f32 v80, v64, v70
    v_cvt_pk_bf16_f32 v81, v71, v72
    ds_write_b64 v17, v[80:81]
    s_branch kg0_K2_9
kg0_R1_8:
    v_cndmask_b32 v70, v65, v64, s[94:95]
    v_cndmask_b32 v71, v64, v65, s[96:97]
    v_cndmask_b32 v71, v65, v71, s[94:95]
    v_cndmask_b32 v72, v66, v65, s[94:95]
    v_cndmask_b32 v73, v66, v67, s[96:97]
    v_cvt_pk_bf16_f32 v80, v64, v64
    v_cvt_pk_bf16_f32 v81, v64, v70
    v_cvt_pk_bf16_f32 v82, v71, v65
    v_cvt_pk_bf16_f32 v83, v72, v72
    v_cvt_pk_bf16_f32 v84, v66, v66
    v_cvt_pk_bf16_f32 v86, v73, v67
    v_cvt_pk_bf16_f32 v87, v67, v67
    v_mov_b32 v85, v84
    v_add_u32 v74, 75264, v21
    v_cndmask_b32 v74, v74, v13, s[94:95]
    ds_write_b128 v17, v[80:83]
    ds_write_b128 v74, v[84:87]
kg0_K2_9:
    s_waitcnt lgkmcnt(0)
    v_add_u32 v17, 5120, v17
    v_add_u32 v13, 5120, v13
    s_waitcnt lgkmcnt(0)
    s_barrier
    s_waitcnt vmcnt(0)
    v_readfirstlane_b32 s101, v12
    s_cmp_lg_u32 s101, 0
    s_cbranch_scc1 haveep_10
    s_mov_b32 s12, s44
    s_mov_b32 s13, s45
    s_mov_b32 s14, 256
    s_mov_b32 s15, 0x00020000
    v_mov_b32 v25, 0
    s_mov_b32 s10, 400000
ep_11:
    buffer_load_dword v24, v25, s[12:15], 0 offen sc1
    s_waitcnt vmcnt(0)
    v_readfirstlane_b32 s101, v24
    s_sub_u32 s10, s10, 1
    s_cmp_eq_u32 s10, 0
    s_cbranch_scc1 epd_12
    s_cmp_lg_u32 s101, 0
    s_cbranch_scc1 epd_12
    s_sleep 1
    s_branch ep_11
epd_12:
haveep_10:
    s_barrier
    s_cmp_lg_u32 s3, 0
    s_cbranch_scc1 sigT_13
    s_add_u32 s12, s46, 16842752
    s_addc_u32 s13, s47, 0
    s_mov_b32 s14, 8192
    s_mov_b32 s15, 0x00020000
    v_mov_b32 v24, s101
    v_mov_b32 v25, 0
    s_mov_b64 exec, 1
    buffer_store_dword v24, v25, s[12:15], s79 offen sc1
    s_mov_b64 exec, -1
sigT_13:
    s_setprio 2
    v_lshlrev_b32 v184, 16, v184
    v_lshlrev_b32 v185, 16, v185
    v_lshlrev_b32 v186, 16, v186
    v_lshlrev_b32 v187, 16, v187
    v_lshlrev_b32 v188, 16, v188
    v_lshlrev_b32 v189, 16, v189
    v_lshlrev_b32 v190, 16, v190
    v_mul_f32 v52, s70, v188
    v_fma_f32 v53, v188, s70, -v52
    v_fma_f32 v53, v188, s71, v53
    v_exp_f32 v38, v52
    v_mul_f32 v53, s72, v53
    s_nop 0
    v_fma_f32 v38, v38, v53, v38
    v_cvt_pk_bf16_f32 v38, v38, v38
    v_lshlrev_b32 v38, 16, v38
    v_mul_f32 v54, s70, v184
    v_fma_f32 v55, v184, s70, -v54
    v_fma_f32 v55, v184, s71, v55
    v_exp_f32 v39, v54
    v_mul_f32 v55, s72, v55
    s_nop 0
    v_fma_f32 v39, v39, v55, v39
    v_cvt_pk_bf16_f32 v39, v39, v39
    v_lshlrev_b32 v39, 16, v39
    v_mul_f32 v39, v39, v38
    v_mul_f32 v39, s70, v39
    v_sub_f32 v48, 0, v39
    v_mul_f32 v49, v185, v38
    v_mul_f32 v49, s73, v49
    v_mul_f32 v52, v186, v38
    v_mul_f32 v53, v187, v38
    v_add_f32 v52, v52, v52
    v_add_f32 v53, v53, v53
    v_max_f32 v54, |v52|, |v53|
    v_max_f32 v55, |v189|, |v190|
    v_mul_f32 v55, v55, v38
    v_add_f32 v55, v55, v55
    v_max_f32 v54, v54, v55
    s_cmp_ge_u32 s3, 2
    s_cbranch_scc1 kg1_A_14
    v_mov_b32 v56, 1.0
    v_mov_b32 v57, 0
    v_mul_f32 v76, 0x41000000, v48
    v_mul_f32 v77, 0x41000000, v49
    v_mul_f32 v79, 0x42000000, v48
    v_mul_f32 v80, 0x42000000, v49
    v_mul_f32 v82, 0x41800000, v48
    v_mul_f32 v83, 0x41800000, v49
    v_mul_f32 v85, 0x41c00000, v48
    v_mul_f32 v86, 0x41c00000, v49
    v_exp_f32 v76, v76
    v_fract_f32 v77, v77
    v_exp_f32 v79, v79
    v_fract_f32 v80, v80
    v_exp_f32 v82, v82
    v_fract_f32 v83, v83
    v_exp_f32 v85, v85
    v_fract_f32 v86, v86
    v_cos_f32 v78, v77
    v_sin_f32 v77, v77
    v_cos_f32 v81, v80
    v_sin_f32 v80, v80
    v_cos_f32 v84, v83
    v_sin_f32 v83, v83
    v_cos_f32 v87, v86
    v_sin_f32 v86, v86
    s_nop 0
    v_mul_f32 v58, v76, v78
    v_mul_f32 v59, v76, v77
    v_mul_f32 v64, v79, v81
    v_mul_f32 v65, v79, v80
    v_mul_f32 v60, v82, v84
    v_mul_f32 v61, v82, v83
    v_mul_f32 v62, v85, v87
    v_mul_f32 v63, v85, v86
    v_pk_mul_f32 v[66:67], v[56:57], v[64:65] op_sel:[0,0] op_sel_hi:[0,1]
    v_pk_mul_f32 v[68:69], v[58:59], v[64:65] op_sel:[0,0] op_sel_hi:[0,1]
    v_pk_mul_f32 v[70:71], v[60:61], v[64:65] op_sel:[0,0] op_sel_hi:[0,1]
    v_pk_mul_f32 v[72:73], v[62:63], v[64:65] op_sel:[0,0] op_sel_hi:[0,1]
    v_pk_fma_f32 v[66:67], v[56:57], v[64:65], v[66:67] op_sel:[1,1,0] op_sel_hi:[1,0,1] neg_lo:[1,0,0]
    v_pk_fma_f32 v[68:69], v[58:59], v[64:65], v[68:69] op_sel:[1,1,0] op_sel_hi:[1,0,1] neg_lo:[1,0,0]
    v_pk_fma_f32 v[70:71], v[60:61], v[64:65], v[70:71] op_sel:[1,1,0] op_sel_hi:[1,0,1] neg_lo:[1,0,0]
    v_pk_fma_f32 v[72:73], v[62:63], v[64:65], v[72:73] op_sel:[1,1,0] op_sel_hi:[1,0,1] neg_lo:[1,0,0]
    v_cvt_pk_f16_f32 v100, v56, v57
    v_cvt_pk_f16_f32 v101, v58, v59
    v_cvt_pk_f16_f32 v102, v60, v61
    v_cvt_pk_f16_f32 v103, v62, v63
    ds_write_b32 v3, v100 offset:0
    ds_write_b32 v3, v101 offset:528
    ds_write_b32 v3, v102 offset:1056
    ds_write_b32 v3, v103 offset:1584
    v_pk_mul_f32 v[56:57], v[66:67], v[64:65] op_sel:[0,0] op_sel_hi:[0,1]
    v_pk_mul_f32 v[58:59], v[68:69], v[64:65] op_sel:[0,0] op_sel_hi:[0,1]
    v_pk_mul_f32 v[60:61], v[70:71], v[64:65] op_sel:[0,0] op_sel_hi:[0,1]
    v_pk_mul_f32 v[62:63], v[72:73], v[64:65] op_sel:[0,0] op_sel_hi:[0,1]
    v_pk_fma_f32 v[56:57], v[66:67], v[64:65], v[56:57] op_sel:[1,1,0] op_sel_hi:[1,0,1] neg_lo:[1,0,0]
    v_pk_fma_f32 v[58:59], v[68:69], v[64:65], v[58:59] op_sel:[1,1,0] op_sel_hi:[1,0,1] neg_lo:[1,0,0]
    v_pk_fma_f32 v[60:61], v[70:71], v[64:65], v[60:61] op_sel:[1,1,0] op_sel_hi:[1,0,1] neg_lo:[1,0,0]
    v_pk_fma_f32 v[62:63], v[72:73], v[64:65], v[62:63] op_sel:[1,1,0] op_sel_hi:[1,0,1] neg_lo:[1,0,0]
    v_cvt_pk_f16_f32 v100, v66, v67
    v_cvt_pk_f16_f32 v101, v68, v69
    v_cvt_pk_f16_f32 v102, v70, v71
    v_cvt_pk_f16_f32 v103, v72, v73
    ds_write_b32 v3, v100 offset:2112
    ds_write_b32 v3, v101 offset:2640
    ds_write_b32 v3, v102 offset:3168
    ds_write_b32 v3, v103 offset:3696
    v_pk_mul_f32 v[66:67], v[56:57], v[64:65] op_sel:[0,0] op_sel_hi:[0,1]
    v_pk_mul_f32 v[68:69], v[58:59], v[64:65] op_sel:[0,0] op_sel_hi:[0,1]
    v_pk_mul_f32 v[70:71], v[60:61], v[64:65] op_sel:[0,0] op_sel_hi:[0,1]
    v_pk_mul_f32 v[72:73], v[62:63], v[64:65] op_sel:[0,0] op_sel_hi:[0,1]
    v_pk_fma_f32 v[66:67], v[56:57], v[64:65], v[66:67] op_sel:[1,1,0] op_sel_hi:[1,0,1] neg_lo:[1,0,0]
    v_pk_fma_f32 v[68:69], v[58:59], v[64:65], v[68:69] op_sel:[1,1,0] op_sel_hi:[1,0,1] neg_lo:[1,0,0]
    v_pk_fma_f32 v[70:71], v[60:61], v[64:65], v[70:71] op_sel:[1,1,0] op_sel_hi:[1,0,1] neg_lo:[1,0,0]
    v_pk_fma_f32 v[72:73], v[62:63], v[64:65], v[72:73] op_sel:[1,1,0] op_sel_hi:[1,0,1] neg_lo:[1,0,0]
    v_cvt_pk_f16_f32 v100, v56, v57
    v_cvt_pk_f16_f32 v101, v58, v59
    v_cvt_pk_f16_f32 v102, v60, v61
    v_cvt_pk_f16_f32 v103, v62, v63
    ds_write_b32 v3, v100 offset:4224
    ds_write_b32 v3, v101 offset:4752
    ds_write_b32 v3, v102 offset:5280
    ds_write_b32 v3, v103 offset:5808
    v_pk_mul_f32 v[56:57], v[66:67], v[64:65] op_sel:[0,0] op_sel_hi:[0,1]
    v_pk_mul_f32 v[58:59], v[68:69], v[64:65] op_sel:[0,0] op_sel_hi:[0,1]
    v_pk_mul_f32 v[60:61], v[70:71], v[64:65] op_sel:[0,0] op_sel_hi:[0,1]
    v_pk_mul_f32 v[62:63], v[72:73], v[64:65] op_sel:[0,0] op_sel_hi:[0,1]
    v_pk_fma_f32 v[56:57], v[66:67], v[64:65], v[56:57] op_sel:[1,1,0] op_sel_hi:[1,0,1] neg_lo:[1,0,0]
    v_pk_fma_f32 v[58:59], v[68:69], v[64:65], v[58:59] op_sel:[1,1,0] op_sel_hi:[1,0,1] neg_lo:[1,0,0]
    v_pk_fma_f32 v[60:61], v[70:71], v[64:65], v[60:61] op_sel:[1,1,0] op_sel_hi:[1,0,1] neg_lo:[1,0,0]
    v_pk_fma_f32 v[62:63], v[72:73], v[64:65], v[62:63] op_sel:[1,1,0] op_sel_hi:[1,0,1] neg_lo:[1,0,0]
    v_cvt_pk_f16_f32 v100, v66, v67
    v_cvt_pk_f16_f32 v101, v68, v69
    v_cvt_pk_f16_f32 v102, v70, v71
    v_cvt_pk_f16_f32 v103, v72, v73
    ds_write_b32 v3, v100 offset:6336
    ds_write_b32 v3, v101 offset:6864
    ds_write_b32 v3, v102 offset:7392
    ds_write_b32 v3, v103 offset:7920
    v_pk_mul_f32 v[66:67], v[56:57], v[64:65] op_sel:[0,0] op_sel_hi:[0,1]
    v_pk_mul_f32 v[68:69], v[58:59], v[64:65] op_sel:[0,0] op_sel_hi:[0,1]
    v_pk_mul_f32 v[70:71], v[60:61], v[64:65] op_sel:[0,0] op_sel_hi:[0,1]
    v_pk_mul_f32 v[72:73], v[62:63], v[64:65] op_sel:[0,0] op_sel_hi:[0,1]
    v_pk_fma_f32 v[66:67], v[56:57], v[64:65], v[66:67] op_sel:[1,1,0] op_sel_hi:[1,0,1] neg_lo:[1,0,0]
    v_pk_fma_f32 v[68:69], v[58:59], v[64:65], v[68:69] op_sel:[1,1,0] op_sel_hi:[1,0,1] neg_lo:[1,0,0]
    v_pk_fma_f32 v[70:71], v[60:61], v[64:65], v[70:71] op_sel:[1,1,0] op_sel_hi:[1,0,1] neg_lo:[1,0,0]
    v_pk_fma_f32 v[72:73], v[62:63], v[64:65], v[72:73] op_sel:[1,1,0] op_sel_hi:[1,0,1] neg_lo:[1,0,0]
    v_cvt_pk_f16_f32 v100, v56, v57
    v_cvt_pk_f16_f32 v101, v58, v59
    v_cvt_pk_f16_f32 v102, v60, v61
    v_cvt_pk_f16_f32 v103, v62, v63
    ds_write_b32 v3, v100 offset:8448
    ds_write_b32 v3, v101 offset:8976
    ds_write_b32 v3, v102 offset:9504
    ds_write_b32 v3, v103 offset:10032
    v_pk_mul_f32 v[56:57], v[66:67], v[64:65] op_sel:[0,0] op_sel_hi:[0,1]
    v_pk_mul_f32 v[58:59], v[68:69], v[64:65] op_sel:[0,0] op_sel_hi:[0,1]
    v_pk_mul_f32 v[60:61], v[70:71], v[64:65] op_sel:[0,0] op_sel_hi:[0,1]
    v_pk_mul_f32 v[62:63], v[72:73], v[64:65] op_sel:[0,0] op_sel_hi:[0,1]
    v_pk_fma_f32 v[56:57], v[66:67], v[64:65], v[56:57] op_sel:[1,1,0] op_sel_hi:[1,0,1] neg_lo:[1,0,0]
    v_pk_fma_f32 v[58:59], v[68:69], v[64:65], v[58:59] op_sel:[1,1,0] op_sel_hi:[1,0,1] neg_lo:[1,0,0]
    v_pk_fma_f32 v[60:61], v[70:71], v[64:65], v[60:61] op_sel:[1,1,0] op_sel_hi:[1,0,1] neg_lo:[1,0,0]
    v_pk_fma_f32 v[62:63], v[72:73], v[64:65], v[62:63] op_sel:[1,1,0] op_sel_hi:[1,0,1] neg_lo:[1,0,0]
    v_cvt_pk_f16_f32 v100, v66, v67
    v_cvt_pk_f16_f32 v101, v68, v69
    v_cvt_pk_f16_f32 v102, v70, v71
    v_cvt_pk_f16_f32 v103, v72, v73
    ds_write_b32 v3, v100 offset:10560
    ds_write_b32 v3, v101 offset:11088
    ds_write_b32 v3, v102 offset:11616
    ds_write_b32 v3, v103 offset:12144
    v_pk_mul_f32 v[66:67], v[56:57], v[64:65] op_sel:[0,0] op_sel_hi:[0,1]
    v_pk_mul_f32 v[68:69], v[58:59], v[64:65] op_sel:[0,0] op_sel_hi:[0,1]
    v_pk_mul_f32 v[70:71], v[60:61], v[64:65] op_sel:[0,0] op_sel_hi:[0,1]
    v_pk_mul_f32 v[72:73], v[62:63], v[64:65] op_sel:[0,0] op_sel_hi:[0,1]
    v_pk_fma_f32 v[66:67], v[56:57], v[64:65], v[66:67] op_sel:[1,1,0] op_sel_hi:[1,0,1] neg_lo:[1,0,0]
    v_pk_fma_f32 v[68:69], v[58:59], v[64:65], v[68:69] op_sel:[1,1,0] op_sel_hi:[1,0,1] neg_lo:[1,0,0]
    v_pk_fma_f32 v[70:71], v[60:61], v[64:65], v[70:71] op_sel:[1,1,0] op_sel_hi:[1,0,1] neg_lo:[1,0,0]
    v_pk_fma_f32 v[72:73], v[62:63], v[64:65], v[72:73] op_sel:[1,1,0] op_sel_hi:[1,0,1] neg_lo:[1,0,0]
    v_cvt_pk_f16_f32 v100, v56, v57
    v_cvt_pk_f16_f32 v101, v58, v59
    v_cvt_pk_f16_f32 v102, v60, v61
    v_cvt_pk_f16_f32 v103, v62, v63
    ds_write_b32 v3, v100 offset:12672
    ds_write_b32 v3, v101 offset:13200
    ds_write_b32 v3, v102 offset:13728
    ds_write_b32 v3, v103 offset:14256
    v_cvt_pk_f16_f32 v100, v66, v67
    v_cvt_pk_f16_f32 v101, v68, v69
    v_cvt_pk_f16_f32 v102, v70, v71
    v_cvt_pk_f16_f32 v103, v72, v73
    ds_write_b32 v3, v100 offset:14784
    ds_write_b32 v3, v101 offset:15312
    ds_write_b32 v3, v102 offset:15840
    ds_write_b32 v3, v103 offset:16368
    s_branch kg1_Tdone_15
kg1_A_14:
    v_mul_f32 v70, 0x3f800000, v48
    v_mul_f32 v71, 0x3f800000, v49
    v_mul_f32 v73, 0x41000000, v48
    v_mul_f32 v74, 0x41000000, v49
    v_mul_f32 v76, 0x43800000, v48
    v_mul_f32 v77, 0x43800000, v49
    v_mul_f32 v79, 0x40000000, v48
    v_mul_f32 v80, 0x40000000, v49
    v_mul_f32 v82, 0x40800000, v48
    v_mul_f32 v83, 0x40800000, v49
    v_exp_f32 v70, v70
    v_fract_f32 v71, v71
    v_exp_f32 v73, v73
    v_fract_f32 v74, v74
    v_exp_f32 v76, v76
    v_fract_f32 v77, v77
    v_exp_f32 v79, v79
    v_fract_f32 v80, v80
    v_exp_f32 v82, v82
    v_fract_f32 v83, v83
    v_cos_f32 v72, v71
    v_sin_f32 v71, v71
    v_cos_f32 v75, v74
    v_sin_f32 v74, v74
    v_cos_f32 v78, v77
    v_sin_f32 v77, v77
    v_cos_f32 v81, v80
    v_sin_f32 v80, v80
    v_cos_f32 v84, v83
    v_sin_f32 v83, v83
    s_nop 0
    v_mul_f32 v56, v70, v72
    v_mul_f32 v57, v70, v71
    v_mul_f32 v62, v73, v75
    v_mul_f32 v63, v73, v74
    v_mul_f32 v64, v76, v78
    v_mul_f32 v65, v76, v77
    v_mul_f32 v58, v79, v81
    v_mul_f32 v59, v79, v80
    v_mul_f32 v60, v82, v84
    v_mul_f32 v61, v82, v83
    s_nop 0
    v_max_f32_dpp v54, v54, v54 row_ror:8 row_mask:0xf bank_mask:0xf
    s_nop 0
    s_nop 0
    v_max_f32_dpp v54, v54, v54 row_ror:4 row_mask:0xf bank_mask:0xf
    s_nop 0
    s_nop 0
    v_max_f32_dpp v54, v54, v54 row_ror:2 row_mask:0xf bank_mask:0xf
    s_nop 0
    s_nop 0
    v_max_f32_dpp v54, v54, v54 row_ror:1 row_mask:0xf bank_mask:0xf
    s_nop 0
    v_readlane_b32 s8, v54, 0
    v_readlane_b32 s9, v54, 16
    v_readlane_b32 s10, v54, 32
    v_readlane_b32 s11, v54, 48
    s_nop 1
    s_max_u32 s8, s8, s9
    s_max_u32 s10, s10, s11
    s_max_u32 s8, s8, s10
    s_lshr_b32 s8, s8, 23
    s_min_u32 s8, s8, 252
    s_sub_u32 s9, 253, s8
    s_lshl_b32 s9, s9, 23
    s_add_u32 s10, s8, 1
    s_lshl_b32 s10, s10, 23
    v_mul_f32 v52, s9, v52
    v_mul_f32 v53, s9, v53
    v_mov_b32 v54, s10
    v_mov_b32 v55, 15360
    ds_write_b32 v55, v54
    v_cvt_pk_f16_f32 v100, v52, -v53
    ds_write_b32 v3, v100 offset:0
    v_pk_mul_f32 v[66:67], v[52:53], v[56:57] op_sel:[0,0] op_sel_hi:[0,1]
    v_pk_mul_f32 v[68:69], v[52:53], v[58:59] op_sel:[0,0] op_sel_hi:[0,1]
    v_pk_mul_f32 v[70:71], v[52:53], v[60:61] op_sel:[0,0] op_sel_hi:[0,1]
    v_pk_mul_f32 v[72:73], v[52:53], v[64:65] op_sel:[0,0] op_sel_hi:[0,1]
    v_pk_fma_f32 v[66:67], v[52:53], v[56:57], v[66:67] op_sel:[1,1,0] op_sel_hi:[1,0,1] neg_lo:[1,0,0]
    v_pk_fma_f32 v[68:69], v[52:53], v[58:59], v[68:69] op_sel:[1,1,0] op_sel_hi:[1,0,1] neg_lo:[1,0,0]
    v_pk_fma_f32 v[70:71], v[52:53], v[60:61], v[70:71] op_sel:[1,1,0] op_sel_hi:[1,0,1] neg_lo:[1,0,0]
    v_pk_fma_f32 v[72:73], v[52:53], v[64:65], v[72:73] op_sel:[1,1,0] op_sel_hi:[1,0,1] neg_lo:[1,0,0]
    v_cvt_pk_f16_f32 v100, v66, -v67
    v_cvt_pk_f16_f32 v101, v68, -v69
    v_cvt_pk_f16_f32 v102, v70, -v71
    v_cvt_pk_f16_f32 v103, v72, -v73
    ds_write_b32 v3, v100 offset:528
    ds_write_b32 v3, v101 offset:1056
    ds_write_b32 v3, v102 offset:2112
    ds_write_b32 v3, v103 offset:4224
    v_pk_mul_f32 v[74:75], v[68:69], v[56:57] op_sel:[0,0] op_sel_hi:[0,1]
    v_pk_mul_f32 v[76:77], v[70:71], v[56:57] op_sel:[0,0] op_sel_hi:[0,1]
    v_pk_mul_f32 v[78:79], v[70:71], v[58:59] op_sel:[0,0] op_sel_hi:[0,1]
    v_pk_mul_f32 v[80:81], v[72:73], v[64:65] op_sel:[0,0] op_sel_hi:[0,1]
    v_pk_fma_f32 v[74:75], v[68:69], v[56:57], v[74:75] op_sel:[1,1,0] op_sel_hi:[1,0,1] neg_lo:[1,0,0]
    v_pk_fma_f32 v[76:77], v[70:71], v[56:57], v[76:77] op_sel:[1,1,0] op_sel_hi:[1,0,1] neg_lo:[1,0,0]
    v_pk_fma_f32 v[78:79], v[70:71], v[58:59], v[78:79] op_sel:[1,1,0] op_sel_hi:[1,0,1] neg_lo:[1,0,0]
    v_pk_fma_f32 v[80:81], v[72:73], v[64:65], v[80:81] op_sel:[1,1,0] op_sel_hi:[1,0,1] neg_lo:[1,0,0]
    v_cvt_pk_f16_f32 v100, v74, -v75
    v_cvt_pk_f16_f32 v101, v76, -v77
    v_cvt_pk_f16_f32 v102, v78, -v79
    v_cvt_pk_f16_f32 v103, v80, -v81
    ds_write_b32 v3, v100 offset:1584
    ds_write_b32 v3, v101 offset:2640
    ds_write_b32 v3, v102 offset:3168
    ds_write_b32 v3, v103 offset:8448
    v_pk_mul_f32 v[82:83], v[78:79], v[56:57] op_sel:[0,0] op_sel_hi:[0,1]
    v_pk_mul_f32 v[84:85], v[72:73], v[58:59] op_sel:[0,0] op_sel_hi:[0,1]
    v_pk_mul_f32 v[86:87], v[72:73], v[60:61] op_sel:[0,0] op_sel_hi:[0,1]
    v_pk_mul_f32 v[88:89], v[72:73], v[62:63] op_sel:[0,0] op_sel_hi:[0,1]
    v_pk_fma_f32 v[82:83], v[78:79], v[56:57], v[82:83] op_sel:[1,1,0] op_sel_hi:[1,0,1] neg_lo:[1,0,0]
    v_pk_fma_f32 v[84:85], v[72:73], v[58:59], v[84:85] op_sel:[1,1,0] op_sel_hi:[1,0,1] neg_lo:[1,0,0]
    v_pk_fma_f32 v[86:87], v[72:73], v[60:61], v[86:87] op_sel:[1,1,0] op_sel_hi:[1,0,1] neg_lo:[1,0,0]
    v_pk_fma_f32 v[88:89], v[72:73], v[62:63], v[88:89] op_sel:[1,1,0] op_sel_hi:[1,0,1] neg_lo:[1,0,0]
    v_cvt_pk_f16_f32 v100, v82, -v83
    v_cvt_pk_f16_f32 v101, v84, -v85
    v_cvt_pk_f16_f32 v102, v86, -v87
    v_cvt_pk_f16_f32 v103, v86, -v87
    v_cvt_pk_f16_f32 v104, v88, -v89
    ds_write_b32 v3, v100 offset:3696
    ds_write_b32 v3, v101 offset:4752
    ds_write_b32 v3, v102 offset:5280
    ds_write_b32 v3, v103 offset:6336
    ds_write_b32 v3, v104 offset:7392
    v_pk_mul_f32 v[90:91], v[86:87], v[58:59] op_sel:[0,0] op_sel_hi:[0,1]
    v_pk_mul_f32 v[92:93], v[80:81], v[64:65] op_sel:[0,0] op_sel_hi:[0,1]
    v_pk_fma_f32 v[90:91], v[86:87], v[58:59], v[90:91] op_sel:[1,1,0] op_sel_hi:[1,0,1] neg_lo:[1,0,0]
    v_pk_fma_f32 v[92:93], v[80:81], v[64:65], v[92:93] op_sel:[1,1,0] op_sel_hi:[1,0,1] neg_lo:[1,0,0]
    v_cvt_pk_f16_f32 v100, v90, -v91
    v_cvt_pk_f16_f32 v101, v92, -v93
    ds_write_b32 v3, v100 offset:6864
    ds_write_b32 v3, v101 offset:10560
    v_pk_mul_f32 v[66:67], v[80:81], v[60:61] op_sel:[0,0] op_sel_hi:[0,1]
    v_pk_mul_f32 v[68:69], v[80:81], v[62:63] op_sel:[0,0] op_sel_hi:[0,1]
    v_pk_mul_f32 v[70:71], v[92:93], v[64:65] op_sel:[0,0] op_sel_hi:[0,1]
    v_pk_fma_f32 v[66:67], v[80:81], v[60:61], v[66:67] op_sel:[1,1,0] op_sel_hi:[1,0,1] neg_lo:[1,0,0]
    v_pk_fma_f32 v[68:69], v[80:81], v[62:63], v[68:69] op_sel:[1,1,0] op_sel_hi:[1,0,1] neg_lo:[1,0,0]
    v_pk_fma_f32 v[70:71], v[92:93], v[64:65], v[70:71] op_sel:[1,1,0] op_sel_hi:[1,0,1] neg_lo:[1,0,0]
    v_cvt_pk_f16_f32 v100, v66, -v67
    v_cvt_pk_f16_f32 v101, v68, -v69
    v_cvt_pk_f16_f32 v102, v70, -v71
    ds_write_b32 v3, v100 offset:8976
    ds_write_b32 v3, v101 offset:9504
    ds_write_b32 v3, v102 offset:12672
    v_pk_mul_f32 v[72:73], v[92:93], v[60:61] op_sel:[0,0] op_sel_hi:[0,1]
    v_pk_mul_f32 v[74:75], v[92:93], v[62:63] op_sel:[0,0] op_sel_hi:[0,1]
    v_pk_mul_f32 v[76:77], v[70:71], v[62:63] op_sel:[0,0] op_sel_hi:[0,1]
    v_pk_mul_f32 v[78:79], v[70:71], v[64:65] op_sel:[0,0] op_sel_hi:[0,1]
    v_pk_fma_f32 v[72:73], v[92:93], v[60:61], v[72:73] op_sel:[1,1,0] op_sel_hi:[1,0,1] neg_lo:[1,0,0]
    v_pk_fma_f32 v[74:75], v[92:93], v[62:63], v[74:75] op_sel:[1,1,0] op_sel_hi:[1,0,1] neg_lo:[1,0,0]
    v_pk_fma_f32 v[76:77], v[70:71], v[62:63], v[76:77] op_sel:[1,1,0] op_sel_hi:[1,0,1] neg_lo:[1,0,0]
    v_pk_fma_f32 v[78:79], v[70:71], v[64:65], v[78:79] op_sel:[1,1,0] op_sel_hi:[1,0,1] neg_lo:[1,0,0]
    v_cvt_pk_f16_f32 v100, v72, -v73
    v_cvt_pk_f16_f32 v101, v74, -v75
    v_cvt_pk_f16_f32 v102, v76, -v77
    v_cvt_pk_f16_f32 v103, v78, -v79
    ds_write_b32 v3, v100 offset:11088
    ds_write_b32 v3, v101 offset:11616
    ds_write_b32 v3, v102 offset:13200
    ds_write_b32 v3, v103 offset:13728
    v_pk_mul_f32 v[80:81], v[78:79], v[62:63] op_sel:[0,0] op_sel_hi:[0,1]
    v_pk_mul_f32 v[82:83], v[78:79], v[64:65] op_sel:[0,0] op_sel_hi:[0,1]
    v_pk_fma_f32 v[80:81], v[78:79], v[62:63], v[80:81] op_sel:[1,1,0] op_sel_hi:[1,0,1] neg_lo:[1,0,0]
    v_pk_fma_f32 v[82:83], v[78:79], v[64:65], v[82:83] op_sel:[1,1,0] op_sel_hi:[1,0,1] neg_lo:[1,0,0]
    v_cvt_pk_f16_f32 v100, v80, -v81
    v_cvt_pk_f16_f32 v101, v82, -v83
    ds_write_b32 v3, v100 offset:14256
    ds_write_b32 v3, v101 offset:14784
    v_pk_mul_f32 v[84:85], v[82:83], v[62:63] op_sel:[0,0] op_sel_hi:[0,1]
    v_pk_mul_f32 v[86:87], v[82:83], v[64:65] op_sel:[0,0] op_sel_hi:[0,1]
    v_pk_fma_f32 v[84:85], v[82:83], v[62:63], v[84:85] op_sel:[1,1,0] op_sel_hi:[1,0,1] neg_lo:[1,0,0]
    v_pk_fma_f32 v[86:87], v[82:83], v[64:65], v[86:87] op_sel:[1,1,0] op_sel_hi:[1,0,1] neg_lo:[1,0,0]
    v_cvt_pk_f16_f32 v100, v84, -v85
    v_cvt_pk_f16_f32 v101, v86, -v87
    ds_write_b32 v3, v100 offset:15312
    ds_write_b32 v3, v101 offset:15840
    v_pk_mul_f32 v[88:89], v[86:87], v[62:63] op_sel:[0,0] op_sel_hi:[0,1]
    v_pk_fma_f32 v[88:89], v[86:87], v[62:63], v[88:89] op_sel:[1,1,0] op_sel_hi:[1,0,1] neg_lo:[1,0,0]
    v_cvt_pk_f16_f32 v100, v88, -v89
    ds_write_b32 v3, v100 offset:16368
kg1_Tdone_15:
    s_waitcnt lgkmcnt(0)
    s_barrier
    v_mov_b32 v53, 15360
    ds_read_b32 v54, v53
    ds_read_b128 v[96:99], v4 offset:0
    ds_read_b128 v[100:103], v5 offset:0
    ds_read_b128 v[104:107], v4 offset:64
    ds_read_b128 v[108:111], v5 offset:64
    ds_read_b128 v[112:115], v4 offset:128
    ds_read_b128 v[116:119], v5 offset:128
    ds_read_b128 v[120:123], v4 offset:192
    ds_read_b128 v[124:127], v5 offset:192
    ds_read_b128 v[128:131], v4 offset:256
    ds_read_b128 v[132:135], v5 offset:256
    ds_read_b128 v[136:139], v4 offset:320
    ds_read_b128 v[140:143], v5 offset:320
    v_mov_b32 v64, 0
    v_mov_b32 v65, 0
    v_mov_b32 v66, 0
    v_mov_b32 v67, 0
    s_nop 0
    s_waitcnt lgkmcnt(10)
    v_mfma_f32_16x16x32_f16 v[64:67], v[96:99], v[100:103], v[64:67]
    ds_read_b128 v[96:99], v4 offset:384
    ds_read_b128 v[100:103], v5 offset:384
    s_waitcnt lgkmcnt(10)
    v_mfma_f32_16x16x32_f16 v[64:67], v[104:107], v[108:111], v[64:67]
    ds_read_b128 v[104:107], v4 offset:448
    ds_read_b128 v[108:111], v5 offset:448
    s_waitcnt lgkmcnt(10)
    v_mfma_f32_16x16x32_f16 v[64:67], v[112:115], v[116:119], v[64:67]
    s_waitcnt lgkmcnt(8)
    v_mfma_f32_16x16x32_f16 v[64:67], v[120:123], v[124:127], v[64:67]
    s_waitcnt lgkmcnt(6)
    v_mfma_f32_16x16x32_f16 v[64:67], v[128:131], v[132:135], v[64:67]
    s_waitcnt lgkmcnt(4)
    v_mfma_f32_16x16x32_f16 v[64:67], v[136:139], v[140:143], v[64:67]
    s_waitcnt lgkmcnt(2)
    v_mfma_f32_16x16x32_f16 v[64:67], v[96:99], v[100:103], v[64:67]
    s_waitcnt lgkmcnt(0)
    v_mfma_f32_16x16x32_f16 v[64:67], v[104:107], v[108:111], v[64:67]
    s_nop 7
    v_mul_f32 v64, v54, v64
    v_mul_f32 v65, v54, v65
    v_mul_f32 v66, v54, v66
    v_mul_f32 v67, v54, v67
    s_cmp_ge_u32 s3, 2
    s_cbranch_scc1 kg1_R1_16
    v_cndmask_b32 v70, v65, v64, s[94:95]
    v_cndmask_b32 v71, v66, v65, s[94:95]
    v_cndmask_b32 v72, v67, v66, s[94:95]
    v_cvt_pk_bf16_f32 v80, v64, v70
    v_cvt_pk_bf16_f32 v81, v71, v72
    ds_write_b64 v17, v[80:81]
    s_branch kg1_K2_17
kg1_R1_16:
    v_cndmask_b32 v70, v65, v64, s[94:95]
    v_cndmask_b32 v71, v64, v65, s[96:97]
    v_cndmask_b32 v71, v65, v71, s[94:95]
    v_cndmask_b32 v72, v66, v65, s[94:95]
    v_cndmask_b32 v73, v66, v67, s[96:97]
    v_cvt_pk_bf16_f32 v80, v64, v64
    v_cvt_pk_bf16_f32 v81, v64, v70
    v_cvt_pk_bf16_f32 v82, v71, v65
    v_cvt_pk_bf16_f32 v83, v72, v72
    v_cvt_pk_bf16_f32 v84, v66, v66
    v_cvt_pk_bf16_f32 v86, v73, v67
    v_cvt_pk_bf16_f32 v87, v67, v67
    v_mov_b32 v85, v84
    v_add_u32 v74, 75264, v21
    v_cndmask_b32 v74, v74, v13, s[94:95]
    ds_write_b128 v17, v[80:83]
    ds_write_b128 v74, v[84:87]
kg1_K2_17:
    s_waitcnt lgkmcnt(0)
    v_add_u32 v17, 5120, v17
    v_add_u32 v13, 5120, v13
    s_waitcnt lgkmcnt(0)
    s_barrier
    s_cmp_lt_u32 s99, 3
    s_cbranch_scc1 nokg2_18
    v_lshlrev_b32 v192, 16, v192
    v_lshlrev_b32 v193, 16, v193
    v_lshlrev_b32 v194, 16, v194
    v_lshlrev_b32 v195, 16, v195
    v_lshlrev_b32 v196, 16, v196
    v_lshlrev_b32 v197, 16, v197
    v_lshlrev_b32 v198, 16, v198
    v_mul_f32 v52, s70, v196
    v_fma_f32 v53, v196, s70, -v52
    v_fma_f32 v53, v196, s71, v53
    v_exp_f32 v38, v52
    v_mul_f32 v53, s72, v53
    s_nop 0
    v_fma_f32 v38, v38, v53, v38
    v_cvt_pk_bf16_f32 v38, v38, v38
    v_lshlrev_b32 v38, 16, v38
    v_mul_f32 v54, s70, v192
    v_fma_f32 v55, v192, s70, -v54
    v_fma_f32 v55, v192, s71, v55
    v_exp_f32 v39, v54
    v_mul_f32 v55, s72, v55
    s_nop 0
    v_fma_f32 v39, v39, v55, v39
    v_cvt_pk_bf16_f32 v39, v39, v39
    v_lshlrev_b32 v39, 16, v39
    v_mul_f32 v39, v39, v38
    v_mul_f32 v39, s70, v39
    v_sub_f32 v48, 0, v39
    v_mul_f32 v49, v193, v38
    v_mul_f32 v49, s73, v49
    v_mul_f32 v52, v194, v38
    v_mul_f32 v53, v195, v38
    v_add_f32 v52, v52, v52
    v_add_f32 v53, v53, v53
    v_max_f32 v54, |v52|, |v53|
    v_max_f32 v55, |v197|, |v198|
    v_mul_f32 v55, v55, v38
    v_add_f32 v55, v55, v55
    v_max_f32 v54, v54, v55
    s_cmp_ge_u32 s3, 2
    s_cbranch_scc1 kg2_A_20
    v_mov_b32 v56, 1.0
    v_mov_b32 v57, 0
    v_mul_f32 v76, 0x41000000, v48
    v_mul_f32 v77, 0x41000000, v49
    v_mul_f32 v79, 0x42000000, v48
    v_mul_f32 v80, 0x42000000, v49
    v_mul_f32 v82, 0x41800000, v48
    v_mul_f32 v83, 0x41800000, v49
    v_mul_f32 v85, 0x41c00000, v48
    v_mul_f32 v86, 0x41c00000, v49
    v_exp_f32 v76, v76
    v_fract_f32 v77, v77
    v_exp_f32 v79, v79
    v_fract_f32 v80, v80
    v_exp_f32 v82, v82
    v_fract_f32 v83, v83
    v_exp_f32 v85, v85
    v_fract_f32 v86, v86
    v_cos_f32 v78, v77
    v_sin_f32 v77, v77
    v_cos_f32 v81, v80
    v_sin_f32 v80, v80
    v_cos_f32 v84, v83
    v_sin_f32 v83, v83
    v_cos_f32 v87, v86
    v_sin_f32 v86, v86
    s_nop 0
    v_mul_f32 v58, v76, v78
    v_mul_f32 v59, v76, v77
    v_mul_f32 v64, v79, v81
    v_mul_f32 v65, v79, v80
    v_mul_f32 v60, v82, v84
    v_mul_f32 v61, v82, v83
    v_mul_f32 v62, v85, v87
    v_mul_f32 v63, v85, v86
    v_pk_mul_f32 v[66:67], v[56:57], v[64:65] op_sel:[0,0] op_sel_hi:[0,1]
    v_pk_mul_f32 v[68:69], v[58:59], v[64:65] op_sel:[0,0] op_sel_hi:[0,1]
    v_pk_mul_f32 v[70:71], v[60:61], v[64:65] op_sel:[0,0] op_sel_hi:[0,1]
    v_pk_mul_f32 v[72:73], v[62:63], v[64:65] op_sel:[0,0] op_sel_hi:[0,1]
    v_pk_fma_f32 v[66:67], v[56:57], v[64:65], v[66:67] op_sel:[1,1,0] op_sel_hi:[1,0,1] neg_lo:[1,0,0]
    v_pk_fma_f32 v[68:69], v[58:59], v[64:65], v[68:69] op_sel:[1,1,0] op_sel_hi:[1,0,1] neg_lo:[1,0,0]
    v_pk_fma_f32 v[70:71], v[60:61], v[64:65], v[70:71] op_sel:[1,1,0] op_sel_hi:[1,0,1] neg_lo:[1,0,0]
    v_pk_fma_f32 v[72:73], v[62:63], v[64:65], v[72:73] op_sel:[1,1,0] op_sel_hi:[1,0,1] neg_lo:[1,0,0]
    v_cvt_pk_f16_f32 v100, v56, v57
    v_cvt_pk_f16_f32 v101, v58, v59
    v_cvt_pk_f16_f32 v102, v60, v61
    v_cvt_pk_f16_f32 v103, v62, v63
    ds_write_b32 v3, v100 offset:0
    ds_write_b32 v3, v101 offset:528
    ds_write_b32 v3, v102 offset:1056
    ds_write_b32 v3, v103 offset:1584
    v_pk_mul_f32 v[56:57], v[66:67], v[64:65] op_sel:[0,0] op_sel_hi:[0,1]
    v_pk_mul_f32 v[58:59], v[68:69], v[64:65] op_sel:[0,0] op_sel_hi:[0,1]
    v_pk_mul_f32 v[60:61], v[70:71], v[64:65] op_sel:[0,0] op_sel_hi:[0,1]
    v_pk_mul_f32 v[62:63], v[72:73], v[64:65] op_sel:[0,0] op_sel_hi:[0,1]
    v_pk_fma_f32 v[56:57], v[66:67], v[64:65], v[56:57] op_sel:[1,1,0] op_sel_hi:[1,0,1] neg_lo:[1,0,0]
    v_pk_fma_f32 v[58:59], v[68:69], v[64:65], v[58:59] op_sel:[1,1,0] op_sel_hi:[1,0,1] neg_lo:[1,0,0]
    v_pk_fma_f32 v[60:61], v[70:71], v[64:65], v[60:61] op_sel:[1,1,0] op_sel_hi:[1,0,1] neg_lo:[1,0,0]
    v_pk_fma_f32 v[62:63], v[72:73], v[64:65], v[62:63] op_sel:[1,1,0] op_sel_hi:[1,0,1] neg_lo:[1,0,0]
    v_cvt_pk_f16_f32 v100, v66, v67
    v_cvt_pk_f16_f32 v101, v68, v69
    v_cvt_pk_f16_f32 v102, v70, v71
    v_cvt_pk_f16_f32 v103, v72, v73
    ds_write_b32 v3, v100 offset:2112
    ds_write_b32 v3, v101 offset:2640
    ds_write_b32 v3, v102 offset:3168
    ds_write_b32 v3, v103 offset:3696
    v_pk_mul_f32 v[66:67], v[56:57], v[64:65] op_sel:[0,0] op_sel_hi:[0,1]
    v_pk_mul_f32 v[68:69], v[58:59], v[64:65] op_sel:[0,0] op_sel_hi:[0,1]
    v_pk_mul_f32 v[70:71], v[60:61], v[64:65] op_sel:[0,0] op_sel_hi:[0,1]
    v_pk_mul_f32 v[72:73], v[62:63], v[64:65] op_sel:[0,0] op_sel_hi:[0,1]
    v_pk_fma_f32 v[66:67], v[56:57], v[64:65], v[66:67] op_sel:[1,1,0] op_sel_hi:[1,0,1] neg_lo:[1,0,0]
    v_pk_fma_f32 v[68:69], v[58:59], v[64:65], v[68:69] op_sel:[1,1,0] op_sel_hi:[1,0,1] neg_lo:[1,0,0]
    v_pk_fma_f32 v[70:71], v[60:61], v[64:65], v[70:71] op_sel:[1,1,0] op_sel_hi:[1,0,1] neg_lo:[1,0,0]
    v_pk_fma_f32 v[72:73], v[62:63], v[64:65], v[72:73] op_sel:[1,1,0] op_sel_hi:[1,0,1] neg_lo:[1,0,0]
    v_cvt_pk_f16_f32 v100, v56, v57
    v_cvt_pk_f16_f32 v101, v58, v59
    v_cvt_pk_f16_f32 v102, v60, v61
    v_cvt_pk_f16_f32 v103, v62, v63
    ds_write_b32 v3, v100 offset:4224
    ds_write_b32 v3, v101 offset:4752
    ds_write_b32 v3, v102 offset:5280
    ds_write_b32 v3, v103 offset:5808
    v_pk_mul_f32 v[56:57], v[66:67], v[64:65] op_sel:[0,0] op_sel_hi:[0,1]
    v_pk_mul_f32 v[58:59], v[68:69], v[64:65] op_sel:[0,0] op_sel_hi:[0,1]
    v_pk_mul_f32 v[60:61], v[70:71], v[64:65] op_sel:[0,0] op_sel_hi:[0,1]
    v_pk_mul_f32 v[62:63], v[72:73], v[64:65] op_sel:[0,0] op_sel_hi:[0,1]
    v_pk_fma_f32 v[56:57], v[66:67], v[64:65], v[56:57] op_sel:[1,1,0] op_sel_hi:[1,0,1] neg_lo:[1,0,0]
    v_pk_fma_f32 v[58:59], v[68:69], v[64:65], v[58:59] op_sel:[1,1,0] op_sel_hi:[1,0,1] neg_lo:[1,0,0]
    v_pk_fma_f32 v[60:61], v[70:71], v[64:65], v[60:61] op_sel:[1,1,0] op_sel_hi:[1,0,1] neg_lo:[1,0,0]
    v_pk_fma_f32 v[62:63], v[72:73], v[64:65], v[62:63] op_sel:[1,1,0] op_sel_hi:[1,0,1] neg_lo:[1,0,0]
    v_cvt_pk_f16_f32 v100, v66, v67
    v_cvt_pk_f16_f32 v101, v68, v69
    v_cvt_pk_f16_f32 v102, v70, v71
    v_cvt_pk_f16_f32 v103, v72, v73
    ds_write_b32 v3, v100 offset:6336
    ds_write_b32 v3, v101 offset:6864
    ds_write_b32 v3, v102 offset:7392
    ds_write_b32 v3, v103 offset:7920
    v_pk_mul_f32 v[66:67], v[56:57], v[64:65] op_sel:[0,0] op_sel_hi:[0,1]
    v_pk_mul_f32 v[68:69], v[58:59], v[64:65] op_sel:[0,0] op_sel_hi:[0,1]
    v_pk_mul_f32 v[70:71], v[60:61], v[64:65] op_sel:[0,0] op_sel_hi:[0,1]
    v_pk_mul_f32 v[72:73], v[62:63], v[64:65] op_sel:[0,0] op_sel_hi:[0,1]
    v_pk_fma_f32 v[66:67], v[56:57], v[64:65], v[66:67] op_sel:[1,1,0] op_sel_hi:[1,0,1] neg_lo:[1,0,0]
    v_pk_fma_f32 v[68:69], v[58:59], v[64:65], v[68:69] op_sel:[1,1,0] op_sel_hi:[1,0,1] neg_lo:[1,0,0]
    v_pk_fma_f32 v[70:71], v[60:61], v[64:65], v[70:71] op_sel:[1,1,0] op_sel_hi:[1,0,1] neg_lo:[1,0,0]
    v_pk_fma_f32 v[72:73], v[62:63], v[64:65], v[72:73] op_sel:[1,1,0] op_sel_hi:[1,0,1] neg_lo:[1,0,0]
    v_cvt_pk_f16_f32 v100, v56, v57
    v_cvt_pk_f16_f32 v101, v58, v59
    v_cvt_pk_f16_f32 v102, v60, v61
    v_cvt_pk_f16_f32 v103, v62, v63
    ds_write_b32 v3, v100 offset:8448
    ds_write_b32 v3, v101 offset:8976
    ds_write_b32 v3, v102 offset:9504
    ds_write_b32 v3, v103 offset:10032
    v_pk_mul_f32 v[56:57], v[66:67], v[64:65] op_sel:[0,0] op_sel_hi:[0,1]
    v_pk_mul_f32 v[58:59], v[68:69], v[64:65] op_sel:[0,0] op_sel_hi:[0,1]
    v_pk_mul_f32 v[60:61], v[70:71], v[64:65] op_sel:[0,0] op_sel_hi:[0,1]
    v_pk_mul_f32 v[62:63], v[72:73], v[64:65] op_sel:[0,0] op_sel_hi:[0,1]
    v_pk_fma_f32 v[56:57], v[66:67], v[64:65], v[56:57] op_sel:[1,1,0] op_sel_hi:[1,0,1] neg_lo:[1,0,0]
    v_pk_fma_f32 v[58:59], v[68:69], v[64:65], v[58:59] op_sel:[1,1,0] op_sel_hi:[1,0,1] neg_lo:[1,0,0]
    v_pk_fma_f32 v[60:61], v[70:71], v[64:65], v[60:61] op_sel:[1,1,0] op_sel_hi:[1,0,1] neg_lo:[1,0,0]
    v_pk_fma_f32 v[62:63], v[72:73], v[64:65], v[62:63] op_sel:[1,1,0] op_sel_hi:[1,0,1] neg_lo:[1,0,0]
    v_cvt_pk_f16_f32 v100, v66, v67
    v_cvt_pk_f16_f32 v101, v68, v69
    v_cvt_pk_f16_f32 v102, v70, v71
    v_cvt_pk_f16_f32 v103, v72, v73
    ds_write_b32 v3, v100 offset:10560
    ds_write_b32 v3, v101 offset:11088
    ds_write_b32 v3, v102 offset:11616
    ds_write_b32 v3, v103 offset:12144
    v_pk_mul_f32 v[66:67], v[56:57], v[64:65] op_sel:[0,0] op_sel_hi:[0,1]
    v_pk_mul_f32 v[68:69], v[58:59], v[64:65] op_sel:[0,0] op_sel_hi:[0,1]
    v_pk_mul_f32 v[70:71], v[60:61], v[64:65] op_sel:[0,0] op_sel_hi:[0,1]
    v_pk_mul_f32 v[72:73], v[62:63], v[64:65] op_sel:[0,0] op_sel_hi:[0,1]
    v_pk_fma_f32 v[66:67], v[56:57], v[64:65], v[66:67] op_sel:[1,1,0] op_sel_hi:[1,0,1] neg_lo:[1,0,0]
    v_pk_fma_f32 v[68:69], v[58:59], v[64:65], v[68:69] op_sel:[1,1,0] op_sel_hi:[1,0,1] neg_lo:[1,0,0]
    v_pk_fma_f32 v[70:71], v[60:61], v[64:65], v[70:71] op_sel:[1,1,0] op_sel_hi:[1,0,1] neg_lo:[1,0,0]
    v_pk_fma_f32 v[72:73], v[62:63], v[64:65], v[72:73] op_sel:[1,1,0] op_sel_hi:[1,0,1] neg_lo:[1,0,0]
    v_cvt_pk_f16_f32 v100, v56, v57
    v_cvt_pk_f16_f32 v101, v58, v59
    v_cvt_pk_f16_f32 v102, v60, v61
    v_cvt_pk_f16_f32 v103, v62, v63
    ds_write_b32 v3, v100 offset:12672
    ds_write_b32 v3, v101 offset:13200
    ds_write_b32 v3, v102 offset:13728
    ds_write_b32 v3, v103 offset:14256
    v_cvt_pk_f16_f32 v100, v66, v67
    v_cvt_pk_f16_f32 v101, v68, v69
    v_cvt_pk_f16_f32 v102, v70, v71
    v_cvt_pk_f16_f32 v103, v72, v73
    ds_write_b32 v3, v100 offset:14784
    ds_write_b32 v3, v101 offset:15312
    ds_write_b32 v3, v102 offset:15840
    ds_write_b32 v3, v103 offset:16368
    s_branch kg2_Tdone_21
kg2_A_20:
    v_mul_f32 v70, 0x3f800000, v48
    v_mul_f32 v71, 0x3f800000, v49
    v_mul_f32 v73, 0x41000000, v48
    v_mul_f32 v74, 0x41000000, v49
    v_mul_f32 v76, 0x43800000, v48
    v_mul_f32 v77, 0x43800000, v49
    v_mul_f32 v79, 0x40000000, v48
    v_mul_f32 v80, 0x40000000, v49
    v_mul_f32 v82, 0x40800000, v48
    v_mul_f32 v83, 0x40800000, v49
    v_exp_f32 v70, v70
    v_fract_f32 v71, v71
    v_exp_f32 v73, v73
    v_fract_f32 v74, v74
    v_exp_f32 v76, v76
    v_fract_f32 v77, v77
    v_exp_f32 v79, v79
    v_fract_f32 v80, v80
    v_exp_f32 v82, v82
    v_fract_f32 v83, v83
    v_cos_f32 v72, v71
    v_sin_f32 v71, v71
    v_cos_f32 v75, v74
    v_sin_f32 v74, v74
    v_cos_f32 v78, v77
    v_sin_f32 v77, v77
    v_cos_f32 v81, v80
    v_sin_f32 v80, v80
    v_cos_f32 v84, v83
    v_sin_f32 v83, v83
    s_nop 0
    v_mul_f32 v56, v70, v72
    v_mul_f32 v57, v70, v71
    v_mul_f32 v62, v73, v75
    v_mul_f32 v63, v73, v74
    v_mul_f32 v64, v76, v78
    v_mul_f32 v65, v76, v77
    v_mul_f32 v58, v79, v81
    v_mul_f32 v59, v79, v80
    v_mul_f32 v60, v82, v84
    v_mul_f32 v61, v82, v83
    s_nop 0
    v_max_f32_dpp v54, v54, v54 row_ror:8 row_mask:0xf bank_mask:0xf
    s_nop 0
    s_nop 0
    v_max_f32_dpp v54, v54, v54 row_ror:4 row_mask:0xf bank_mask:0xf
    s_nop 0
    s_nop 0
    v_max_f32_dpp v54, v54, v54 row_ror:2 row_mask:0xf bank_mask:0xf
    s_nop 0
    s_nop 0
    v_max_f32_dpp v54, v54, v54 row_ror:1 row_mask:0xf bank_mask:0xf
    s_nop 0
    v_readlane_b32 s8, v54, 0
    v_readlane_b32 s9, v54, 16
    v_readlane_b32 s10, v54, 32
    v_readlane_b32 s11, v54, 48
    s_nop 1
    s_max_u32 s8, s8, s9
    s_max_u32 s10, s10, s11
    s_max_u32 s8, s8, s10
    s_lshr_b32 s8, s8, 23
    s_min_u32 s8, s8, 252
    s_sub_u32 s9, 253, s8
    s_lshl_b32 s9, s9, 23
    s_add_u32 s10, s8, 1
    s_lshl_b32 s10, s10, 23
    v_mul_f32 v52, s9, v52
    v_mul_f32 v53, s9, v53
    v_mov_b32 v54, s10
    v_mov_b32 v55, 15360
    ds_write_b32 v55, v54
    v_cvt_pk_f16_f32 v100, v52, -v53
    ds_write_b32 v3, v100 offset:0
    v_pk_mul_f32 v[66:67], v[52:53], v[56:57] op_sel:[0,0] op_sel_hi:[0,1]
    v_pk_mul_f32 v[68:69], v[52:53], v[58:59] op_sel:[0,0] op_sel_hi:[0,1]
    v_pk_mul_f32 v[70:71], v[52:53], v[60:61] op_sel:[0,0] op_sel_hi:[0,1]
    v_pk_mul_f32 v[72:73], v[52:53], v[64:65] op_sel:[0,0] op_sel_hi:[0,1]
    v_pk_fma_f32 v[66:67], v[52:53], v[56:57], v[66:67] op_sel:[1,1,0] op_sel_hi:[1,0,1] neg_lo:[1,0,0]
    v_pk_fma_f32 v[68:69], v[52:53], v[58:59], v[68:69] op_sel:[1,1,0] op_sel_hi:[1,0,1] neg_lo:[1,0,0]
    v_pk_fma_f32 v[70:71], v[52:53], v[60:61], v[70:71] op_sel:[1,1,0] op_sel_hi:[1,0,1] neg_lo:[1,0,0]
    v_pk_fma_f32 v[72:73], v[52:53], v[64:65], v[72:73] op_sel:[1,1,0] op_sel_hi:[1,0,1] neg_lo:[1,0,0]
    v_cvt_pk_f16_f32 v100, v66, -v67
    v_cvt_pk_f16_f32 v101, v68, -v69
    v_cvt_pk_f16_f32 v102, v70, -v71
    v_cvt_pk_f16_f32 v103, v72, -v73
    ds_write_b32 v3, v100 offset:528
    ds_write_b32 v3, v101 offset:1056
    ds_write_b32 v3, v102 offset:2112
    ds_write_b32 v3, v103 offset:4224
    v_pk_mul_f32 v[74:75], v[68:69], v[56:57] op_sel:[0,0] op_sel_hi:[0,1]
    v_pk_mul_f32 v[76:77], v[70:71], v[56:57] op_sel:[0,0] op_sel_hi:[0,1]
    v_pk_mul_f32 v[78:79], v[70:71], v[58:59] op_sel:[0,0] op_sel_hi:[0,1]
    v_pk_mul_f32 v[80:81], v[72:73], v[64:65] op_sel:[0,0] op_sel_hi:[0,1]
    v_pk_fma_f32 v[74:75], v[68:69], v[56:57], v[74:75] op_sel:[1,1,0] op_sel_hi:[1,0,1] neg_lo:[1,0,0]
    v_pk_fma_f32 v[76:77], v[70:71], v[56:57], v[76:77] op_sel:[1,1,0] op_sel_hi:[1,0,1] neg_lo:[1,0,0]
    v_pk_fma_f32 v[78:79], v[70:71], v[58:59], v[78:79] op_sel:[1,1,0] op_sel_hi:[1,0,1] neg_lo:[1,0,0]
    v_pk_fma_f32 v[80:81], v[72:73], v[64:65], v[80:81] op_sel:[1,1,0] op_sel_hi:[1,0,1] neg_lo:[1,0,0]
    v_cvt_pk_f16_f32 v100, v74, -v75
    v_cvt_pk_f16_f32 v101, v76, -v77
    v_cvt_pk_f16_f32 v102, v78, -v79
    v_cvt_pk_f16_f32 v103, v80, -v81
    ds_write_b32 v3, v100 offset:1584
    ds_write_b32 v3, v101 offset:2640
    ds_write_b32 v3, v102 offset:3168
    ds_write_b32 v3, v103 offset:8448
    v_pk_mul_f32 v[82:83], v[78:79], v[56:57] op_sel:[0,0] op_sel_hi:[0,1]
    v_pk_mul_f32 v[84:85], v[72:73], v[58:59] op_sel:[0,0] op_sel_hi:[0,1]
    v_pk_mul_f32 v[86:87], v[72:73], v[60:61] op_sel:[0,0] op_sel_hi:[0,1]
    v_pk_mul_f32 v[88:89], v[72:73], v[62:63] op_sel:[0,0] op_sel_hi:[0,1]
    v_pk_fma_f32 v[82:83], v[78:79], v[56:57], v[82:83] op_sel:[1,1,0] op_sel_hi:[1,0,1] neg_lo:[1,0,0]
    v_pk_fma_f32 v[84:85], v[72:73], v[58:59], v[84:85] op_sel:[1,1,0] op_sel_hi:[1,0,1] neg_lo:[1,0,0]
    v_pk_fma_f32 v[86:87], v[72:73], v[60:61], v[86:87] op_sel:[1,1,0] op_sel_hi:[1,0,1] neg_lo:[1,0,0]
    v_pk_fma_f32 v[88:89], v[72:73], v[62:63], v[88:89] op_sel:[1,1,0] op_sel_hi:[1,0,1] neg_lo:[1,0,0]
    v_cvt_pk_f16_f32 v100, v82, -v83
    v_cvt_pk_f16_f32 v101, v84, -v85
    v_cvt_pk_f16_f32 v102, v86, -v87
    v_cvt_pk_f16_f32 v103, v86, -v87
    v_cvt_pk_f16_f32 v104, v88, -v89
    ds_write_b32 v3, v100 offset:3696
    ds_write_b32 v3, v101 offset:4752
    ds_write_b32 v3, v102 offset:5280
    ds_write_b32 v3, v103 offset:6336
    ds_write_b32 v3, v104 offset:7392
    v_pk_mul_f32 v[90:91], v[86:87], v[58:59] op_sel:[0,0] op_sel_hi:[0,1]
    v_pk_mul_f32 v[92:93], v[80:81], v[64:65] op_sel:[0,0] op_sel_hi:[0,1]
    v_pk_fma_f32 v[90:91], v[86:87], v[58:59], v[90:91] op_sel:[1,1,0] op_sel_hi:[1,0,1] neg_lo:[1,0,0]
    v_pk_fma_f32 v[92:93], v[80:81], v[64:65], v[92:93] op_sel:[1,1,0] op_sel_hi:[1,0,1] neg_lo:[1,0,0]
    v_cvt_pk_f16_f32 v100, v90, -v91
    v_cvt_pk_f16_f32 v101, v92, -v93
    ds_write_b32 v3, v100 offset:6864
    ds_write_b32 v3, v101 offset:10560
    v_pk_mul_f32 v[66:67], v[80:81], v[60:61] op_sel:[0,0] op_sel_hi:[0,1]
    v_pk_mul_f32 v[68:69], v[80:81], v[62:63] op_sel:[0,0] op_sel_hi:[0,1]
    v_pk_mul_f32 v[70:71], v[92:93], v[64:65] op_sel:[0,0] op_sel_hi:[0,1]
    v_pk_fma_f32 v[66:67], v[80:81], v[60:61], v[66:67] op_sel:[1,1,0] op_sel_hi:[1,0,1] neg_lo:[1,0,0]
    v_pk_fma_f32 v[68:69], v[80:81], v[62:63], v[68:69] op_sel:[1,1,0] op_sel_hi:[1,0,1] neg_lo:[1,0,0]
    v_pk_fma_f32 v[70:71], v[92:93], v[64:65], v[70:71] op_sel:[1,1,0] op_sel_hi:[1,0,1] neg_lo:[1,0,0]
    v_cvt_pk_f16_f32 v100, v66, -v67
    v_cvt_pk_f16_f32 v101, v68, -v69
    v_cvt_pk_f16_f32 v102, v70, -v71
    ds_write_b32 v3, v100 offset:8976
    ds_write_b32 v3, v101 offset:9504
    ds_write_b32 v3, v102 offset:12672
    v_pk_mul_f32 v[72:73], v[92:93], v[60:61] op_sel:[0,0] op_sel_hi:[0,1]
    v_pk_mul_f32 v[74:75], v[92:93], v[62:63] op_sel:[0,0] op_sel_hi:[0,1]
    v_pk_mul_f32 v[76:77], v[70:71], v[62:63] op_sel:[0,0] op_sel_hi:[0,1]
    v_pk_mul_f32 v[78:79], v[70:71], v[64:65] op_sel:[0,0] op_sel_hi:[0,1]
    v_pk_fma_f32 v[72:73], v[92:93], v[60:61], v[72:73] op_sel:[1,1,0] op_sel_hi:[1,0,1] neg_lo:[1,0,0]
    v_pk_fma_f32 v[74:75], v[92:93], v[62:63], v[74:75] op_sel:[1,1,0] op_sel_hi:[1,0,1] neg_lo:[1,0,0]
    v_pk_fma_f32 v[76:77], v[70:71], v[62:63], v[76:77] op_sel:[1,1,0] op_sel_hi:[1,0,1] neg_lo:[1,0,0]
    v_pk_fma_f32 v[78:79], v[70:71], v[64:65], v[78:79] op_sel:[1,1,0] op_sel_hi:[1,0,1] neg_lo:[1,0,0]
    v_cvt_pk_f16_f32 v100, v72, -v73
    v_cvt_pk_f16_f32 v101, v74, -v75
    v_cvt_pk_f16_f32 v102, v76, -v77
    v_cvt_pk_f16_f32 v103, v78, -v79
    ds_write_b32 v3, v100 offset:11088
    ds_write_b32 v3, v101 offset:11616
    ds_write_b32 v3, v102 offset:13200
    ds_write_b32 v3, v103 offset:13728
    v_pk_mul_f32 v[80:81], v[78:79], v[62:63] op_sel:[0,0] op_sel_hi:[0,1]
    v_pk_mul_f32 v[82:83], v[78:79], v[64:65] op_sel:[0,0] op_sel_hi:[0,1]
    v_pk_fma_f32 v[80:81], v[78:79], v[62:63], v[80:81] op_sel:[1,1,0] op_sel_hi:[1,0,1] neg_lo:[1,0,0]
    v_pk_fma_f32 v[82:83], v[78:79], v[64:65], v[82:83] op_sel:[1,1,0] op_sel_hi:[1,0,1] neg_lo:[1,0,0]
    v_cvt_pk_f16_f32 v100, v80, -v81
    v_cvt_pk_f16_f32 v101, v82, -v83
    ds_write_b32 v3, v100 offset:14256
    ds_write_b32 v3, v101 offset:14784
    v_pk_mul_f32 v[84:85], v[82:83], v[62:63] op_sel:[0,0] op_sel_hi:[0,1]
    v_pk_mul_f32 v[86:87], v[82:83], v[64:65] op_sel:[0,0] op_sel_hi:[0,1]
    v_pk_fma_f32 v[84:85], v[82:83], v[62:63], v[84:85] op_sel:[1,1,0] op_sel_hi:[1,0,1] neg_lo:[1,0,0]
    v_pk_fma_f32 v[86:87], v[82:83], v[64:65], v[86:87] op_sel:[1,1,0] op_sel_hi:[1,0,1] neg_lo:[1,0,0]
    v_cvt_pk_f16_f32 v100, v84, -v85
    v_cvt_pk_f16_f32 v101, v86, -v87
    ds_write_b32 v3, v100 offset:15312
    ds_write_b32 v3, v101 offset:15840
    v_pk_mul_f32 v[88:89], v[86:87], v[62:63] op_sel:[0,0] op_sel_hi:[0,1]
    v_pk_fma_f32 v[88:89], v[86:87], v[62:63], v[88:89] op_sel:[1,1,0] op_sel_hi:[1,0,1] neg_lo:[1,0,0]
    v_cvt_pk_f16_f32 v100, v88, -v89
    ds_write_b32 v3, v100 offset:16368
kg2_Tdone_21:
    s_waitcnt lgkmcnt(0)
    s_barrier
    v_mov_b32 v53, 15360
    ds_read_b32 v54, v53
    ds_read_b128 v[96:99], v4 offset:0
    ds_read_b128 v[100:103], v5 offset:0
    ds_read_b128 v[104:107], v4 offset:64
    ds_read_b128 v[108:111], v5 offset:64
    ds_read_b128 v[112:115], v4 offset:128
    ds_read_b128 v[116:119], v5 offset:128
    ds_read_b128 v[120:123], v4 offset:192
    ds_read_b128 v[124:127], v5 offset:192
    ds_read_b128 v[128:131], v4 offset:256
    ds_read_b128 v[132:135], v5 offset:256
    ds_read_b128 v[136:139], v4 offset:320
    ds_read_b128 v[140:143], v5 offset:320
    v_mov_b32 v64, 0
    v_mov_b32 v65, 0
    v_mov_b32 v66, 0
    v_mov_b32 v67, 0
    s_nop 0
    s_waitcnt lgkmcnt(10)
    v_mfma_f32_16x16x32_f16 v[64:67], v[96:99], v[100:103], v[64:67]
    ds_read_b128 v[96:99], v4 offset:384
    ds_read_b128 v[100:103], v5 offset:384
    s_waitcnt lgkmcnt(10)
    v_mfma_f32_16x16x32_f16 v[64:67], v[104:107], v[108:111], v[64:67]
    ds_read_b128 v[104:107], v4 offset:448
    ds_read_b128 v[108:111], v5 offset:448
    s_waitcnt lgkmcnt(10)
    v_mfma_f32_16x16x32_f16 v[64:67], v[112:115], v[116:119], v[64:67]
    s_waitcnt lgkmcnt(8)
    v_mfma_f32_16x16x32_f16 v[64:67], v[120:123], v[124:127], v[64:67]
    s_waitcnt lgkmcnt(6)
    v_mfma_f32_16x16x32_f16 v[64:67], v[128:131], v[132:135], v[64:67]
    s_waitcnt lgkmcnt(4)
    v_mfma_f32_16x16x32_f16 v[64:67], v[136:139], v[140:143], v[64:67]
    s_waitcnt lgkmcnt(2)
    v_mfma_f32_16x16x32_f16 v[64:67], v[96:99], v[100:103], v[64:67]
    s_waitcnt lgkmcnt(0)
    v_mfma_f32_16x16x32_f16 v[64:67], v[104:107], v[108:111], v[64:67]
    s_nop 7
    v_mul_f32 v64, v54, v64
    v_mul_f32 v65, v54, v65
    v_mul_f32 v66, v54, v66
    v_mul_f32 v67, v54, v67
    s_cmp_ge_u32 s3, 2
    s_cbranch_scc1 kg2_R1_22
    v_cndmask_b32 v70, v65, v64, s[94:95]
    v_cndmask_b32 v71, v66, v65, s[94:95]
    v_cndmask_b32 v72, v67, v66, s[94:95]
    v_cvt_pk_bf16_f32 v80, v64, v70
    v_cvt_pk_bf16_f32 v81, v71, v72
    ds_write_b64 v17, v[80:81]
    s_branch kg2_K2_23
kg2_R1_22:
    v_cndmask_b32 v70, v65, v64, s[94:95]
    v_cndmask_b32 v71, v64, v65, s[96:97]
    v_cndmask_b32 v71, v65, v71, s[94:95]
    v_cndmask_b32 v72, v66, v65, s[94:95]
    v_cndmask_b32 v73, v66, v67, s[96:97]
    v_cvt_pk_bf16_f32 v80, v64, v64
    v_cvt_pk_bf16_f32 v81, v64, v70
    v_cvt_pk_bf16_f32 v82, v71, v65
    v_cvt_pk_bf16_f32 v83, v72, v72
    v_cvt_pk_bf16_f32 v84, v66, v66
    v_cvt_pk_bf16_f32 v86, v73, v67
    v_cvt_pk_bf16_f32 v87, v67, v67
    v_mov_b32 v85, v84
    v_add_u32 v74, 75264, v21
    v_cndmask_b32 v74, v74, v13, s[94:95]
    ds_write_b128 v17, v[80:83]
    ds_write_b128 v74, v[84:87]
kg2_K2_23:
    s_waitcnt lgkmcnt(0)
    v_add_u32 v17, 5120, v17
    v_add_u32 v13, 5120, v13
    s_waitcnt lgkmcnt(0)
    s_barrier
    s_branch kg2done_19
nokg2_18:
kg2done_19:
    v_mov_b32 v26, 0
    v_mov_b32 v27, 0
    v_mov_b32 v28, 0
    v_mov_b32 v29, 0
    v_and_b32 v25, 7, v0
    v_mul_u32_u24 v25, 4160, v25
    v_add_u32 v25, 52736, v25
    ds_write_b128 v25, v[26:29]
    s_lshr_b32 s9, s2, 5
    s_lshl_b32 s9, s9, 7
    s_add_u32 s9, s9, 256
    s_cmp_lg_u32 s3, 0
    s_cbranch_scc1 pollw_24
    s_add_u32 s12, s46, 16842752
    s_addc_u32 s13, s47, 0
    s_mov_b32 s14, 8192
    s_mov_b32 s15, 0x00020000
    v_lshlrev_b32 v25, 2, v0
    s_mov_b32 s10, 400000
poll_25:
    buffer_load_dword v24, v25, s[12:15], s9 offen sc1
    s_waitcnt vmcnt(0)
    v_cmp_eq_u32 vcc, s101, v24
    s_sub_u32 s10, s10, 1
    s_cmp_eq_u32 s10, 0
    s_cbranch_scc1 pollto_27
    s_and_b32 s11, vcc_lo, 0xffffffff
    s_cmp_eq_u32 s11, 0xffffffff
    s_cbranch_scc1 polld_26
    s_sleep 1
    s_branch poll_25
pollto_27:
polld_26:
pollw_24:
    s_barrier
    s_mov_b32 s74, s98
    s_setprio 1
    s_lshl_b32 s5, s74, 12
    s_add_u32 s64, s46, s5
    s_addc_u32 s65, s47, 0
    buffer_load_dwordx4 v[40:43], v8, s[64:67], 0 offen sc1
    buffer_load_dwordx4 v[44:47], v8, s[64:67], 0 offen offset:16 sc1
    s_lshl_b32 s5, s74, 1
    buffer_load_ushort v50, v2, s[84:87], s5 offen
    s_waitcnt vmcnt(0)
    s_branch cv_cl1
cv_cl:
    s_waitcnt vmcnt(1)
cv_cl1:
    v_mov_b32 v52, v41
    v_mov_b32 v53, v42
    v_mov_b32 v54, v43
    v_mov_b32 v55, v44
    v_mov_b32 v56, v45
    v_mov_b32 v57, v46
    v_alignbit_b32 v58, v41, v40, 16
    v_alignbit_b32 v59, v42, v41, 16
    v_alignbit_b32 v60, v43, v42, 16
    v_alignbit_b32 v61, v44, v43, 16
    v_alignbit_b32 v62, v45, v44, 16
    v_alignbit_b32 v63, v46, v45, 16
    v_alignbit_b32 v64, v42, v41, 16
    v_alignbit_b32 v65, v43, v42, 16
    v_alignbit_b32 v66, v44, v43, 16
    v_alignbit_b32 v67, v45, v44, 16
    v_alignbit_b32 v68, v46, v45, 16
    v_alignbit_b32 v69, v47, v46, 16
    ds_write_b128 v9, v[40:43] offset:29120
    ds_write_b128 v9, v[42:45] offset:12480
    ds_write_b128 v9, v[52:55] offset:20800
    ds_write_b128 v9, v[54:57] offset:4160
    ds_write_b128 v9, v[58:61] offset:24960
    ds_write_b128 v9, v[60:63] offset:8320
    ds_write_b128 v9, v[64:67] offset:16640
    ds_write_b128 v9, v[66:69] offset:0
    v_lshlrev_b32 v16, 16, v50
    s_add_u32 s74, s74, 1
    s_cmp_lt_u32 s74, s75
    s_cbranch_scc0 cv_np_28
    s_waitcnt lgkmcnt(0)
    s_lshl_b32 s5, s74, 12
    s_add_u32 s64, s46, s5
    s_addc_u32 s65, s47, 0
    buffer_load_dwordx4 v[40:43], v8, s[64:67], 0 offen sc1
    buffer_load_dwordx4 v[44:47], v8, s[64:67], 0 offen offset:16 sc1
    s_lshl_b32 s5, s74, 1
    buffer_load_ushort v50, v2, s[84:87], s5 offen
cv_np_28:
    s_waitcnt lgkmcnt(0)
    s_barrier
    s_cmp_eq_u32 s3, 1
    s_cbranch_scc1 cv_cv1_30
    s_cmp_eq_u32 s3, 2
    s_cbranch_scc1 cv_cv2_31
    s_cmp_eq_u32 s3, 3
    s_cbranch_scc1 cv_cv3_32
cv_cv0_29:
    ds_read_b128 v[96:99], v6 offset:4032
    ds_read_b128 v[100:103], v7 offset:2048
    ds_read_b128 v[104:107], v6 offset:3008
    ds_read_b128 v[108:111], v7 offset:1536
    ds_read_b128 v[112:115], v7 offset:512
    ds_read_b128 v[120:123], v6 offset:3968
    ds_read_b128 v[124:127], v7 offset:2016
    ds_read_b128 v[128:131], v6 offset:2944
    ds_read_b128 v[132:135], v7 offset:1504
    ds_read_b128 v[136:139], v7 offset:480
    v_mov_b32 v64, 0
    v_mov_b32 v65, 0
    v_mov_b32 v66, 0
    v_mov_b32 v67, 0
    v_mov_b32 v68, 0
    v_mov_b32 v69, 0
    v_mov_b32 v70, 0
    v_mov_b32 v71, 0
    v_mov_b32 v72, 0
    v_mov_b32 v73, 0
    v_mov_b32 v74, 0
    v_mov_b32 v75, 0
    v_mov_b32 v76, 0
    v_mov_b32 v77, 0
    v_mov_b32 v78, 0
    v_mov_b32 v79, 0
    v_mov_b32 v80, 0
    v_mov_b32 v81, 0
    v_mov_b32 v82, 0
    v_mov_b32 v83, 0
    v_mov_b32 v84, 0
    v_mov_b32 v85, 0
    v_mov_b32 v86, 0
    v_mov_b32 v87, 0
    v_mov_b32 v88, 0
    v_mov_b32 v89, 0
    v_mov_b32 v90, 0
    v_mov_b32 v91, 0
    v_mov_b32 v92, 0
    v_mov_b32 v93, 0
    v_mov_b32 v94, 0
    v_mov_b32 v95, 0
    s_nop 0
    s_waitcnt lgkmcnt(8)
    v_mfma_f32_32x32x16_bf16 v[80:95], v[96:99], v[100:103], v[80:95]
    ds_read_b128 v[144:147], v6 offset:3904
    ds_read_b128 v[148:151], v7 offset:1984
    s_waitcnt lgkmcnt(8)
    v_mfma_f32_32x32x16_bf16 v[80:95], v[104:107], v[108:111], v[80:95]
    ds_read_b128 v[152:155], v6 offset:2880
    ds_read_b128 v[156:159], v7 offset:1472
    s_waitcnt lgkmcnt(9)
    v_mfma_f32_32x32x16_bf16 v[64:79], v[96:99], v[112:115], v[64:79]
    ds_read_b128 v[160:163], v7 offset:448
    s_waitcnt lgkmcnt(8)
    v_mfma_f32_32x32x16_bf16 v[80:95], v[120:123], v[124:127], v[80:95]
    ds_read_b128 v[96:99], v6 offset:3840
    ds_read_b128 v[100:103], v7 offset:1952
    s_waitcnt lgkmcnt(8)
    v_mfma_f32_32x32x16_bf16 v[80:95], v[128:131], v[132:135], v[80:95]
    ds_read_b128 v[104:107], v6 offset:2816
    ds_read_b128 v[108:111], v7 offset:1440
    s_waitcnt lgkmcnt(9)
    v_mfma_f32_32x32x16_bf16 v[64:79], v[120:123], v[136:139], v[64:79]
    ds_read_b128 v[112:115], v7 offset:416
    s_waitcnt lgkmcnt(8)
    v_mfma_f32_32x32x16_bf16 v[80:95], v[144:147], v[148:151], v[80:95]
    ds_read_b128 v[120:123], v6 offset:3776
    ds_read_b128 v[124:127], v7 offset:1920
    s_waitcnt lgkmcnt(8)
    v_mfma_f32_32x32x16_bf16 v[80:95], v[152:155], v[156:159], v[80:95]
    ds_read_b128 v[128:131], v6 offset:2752
    ds_read_b128 v[132:135], v7 offset:1408
    s_waitcnt lgkmcnt(9)
    v_mfma_f32_32x32x16_bf16 v[64:79], v[144:147], v[160:163], v[64:79]
    ds_read_b128 v[136:139], v7 offset:384
    s_waitcnt lgkmcnt(8)
    v_mfma_f32_32x32x16_bf16 v[80:95], v[96:99], v[100:103], v[80:95]
    ds_read_b128 v[144:147], v6 offset:3712
    ds_read_b128 v[148:151], v7 offset:1888
    s_waitcnt lgkmcnt(8)
    v_mfma_f32_32x32x16_bf16 v[80:95], v[104:107], v[108:111], v[80:95]
    ds_read_b128 v[152:155], v6 offset:2688
    ds_read_b128 v[156:159], v7 offset:1376
    s_waitcnt lgkmcnt(9)
    v_mfma_f32_32x32x16_bf16 v[64:79], v[96:99], v[112:115], v[64:79]
    ds_read_b128 v[160:163], v7 offset:352
    s_waitcnt lgkmcnt(8)
    v_mfma_f32_32x32x16_bf16 v[80:95], v[120:123], v[124:127], v[80:95]
    ds_read_b128 v[96:99], v6 offset:3648
    ds_read_b128 v[100:103], v7 offset:1856
    s_waitcnt lgkmcnt(8)
    v_mfma_f32_32x32x16_bf16 v[80:95], v[128:131], v[132:135], v[80:95]
    ds_read_b128 v[104:107], v6 offset:2624
    ds_read_b128 v[108:111], v7 offset:1344
    s_waitcnt lgkmcnt(9)
    v_mfma_f32_32x32x16_bf16 v[64:79], v[120:123], v[136:139], v[64:79]
    ds_read_b128 v[112:115], v7 offset:320
    s_waitcnt lgkmcnt(8)
    v_mfma_f32_32x32x16_bf16 v[80:95], v[144:147], v[148:151], v[80:95]
    ds_read_b128 v[120:123], v6 offset:3584
    ds_read_b128 v[124:127], v7 offset:1824
    s_waitcnt lgkmcnt(8)
    v_mfma_f32_32x32x16_bf16 v[80:95], v[152:155], v[156:159], v[80:95]
    ds_read_b128 v[128:131], v6 offset:2560
    ds_read_b128 v[132:135], v7 offset:1312
    s_waitcnt lgkmcnt(9)
    v_mfma_f32_32x32x16_bf16 v[64:79], v[144:147], v[160:163], v[64:79]
    ds_read_b128 v[136:139], v7 offset:288
    s_waitcnt lgkmcnt(8)
    v_mfma_f32_32x32x16_bf16 v[80:95], v[96:99], v[100:103], v[80:95]
    ds_read_b128 v[144:147], v6 offset:3520
    ds_read_b128 v[148:151], v7 offset:1792
    s_waitcnt lgkmcnt(8)
    v_mfma_f32_32x32x16_bf16 v[80:95], v[104:107], v[108:111], v[80:95]
    ds_read_b128 v[152:155], v6 offset:2496
    ds_read_b128 v[156:159], v7 offset:1280
    s_waitcnt lgkmcnt(9)
    v_mfma_f32_32x32x16_bf16 v[64:79], v[96:99], v[112:115], v[64:79]
    ds_read_b128 v[160:163], v7 offset:256
    s_waitcnt lgkmcnt(8)
    v_mfma_f32_32x32x16_bf16 v[80:95], v[120:123], v[124:127], v[80:95]
    ds_read_b128 v[96:99], v6 offset:3456
    ds_read_b128 v[100:103], v7 offset:1760
    s_waitcnt lgkmcnt(8)
    v_mfma_f32_32x32x16_bf16 v[80:95], v[128:131], v[132:135], v[80:95]
    ds_read_b128 v[104:107], v6 offset:2432
    ds_read_b128 v[108:111], v7 offset:1248
    s_waitcnt lgkmcnt(9)
    v_mfma_f32_32x32x16_bf16 v[64:79], v[120:123], v[136:139], v[64:79]
    ds_read_b128 v[112:115], v7 offset:224
    s_waitcnt lgkmcnt(8)
    v_mfma_f32_32x32x16_bf16 v[80:95], v[144:147], v[148:151], v[80:95]
    ds_read_b128 v[120:123], v6 offset:3392
    ds_read_b128 v[124:127], v7 offset:1728
    s_waitcnt lgkmcnt(8)
    v_mfma_f32_32x32x16_bf16 v[80:95], v[152:155], v[156:159], v[80:95]
    ds_read_b128 v[128:131], v6 offset:2368
    ds_read_b128 v[132:135], v7 offset:1216
    s_waitcnt lgkmcnt(9)
    v_mfma_f32_32x32x16_bf16 v[64:79], v[144:147], v[160:163], v[64:79]
    ds_read_b128 v[136:139], v7 offset:192
    s_waitcnt lgkmcnt(8)
    v_mfma_f32_32x32x16_bf16 v[80:95], v[96:99], v[100:103], v[80:95]
    ds_read_b128 v[144:147], v6 offset:3328
    ds_read_b128 v[148:151], v7 offset:1696
    s_waitcnt lgkmcnt(8)
    v_mfma_f32_32x32x16_bf16 v[80:95], v[104:107], v[108:111], v[80:95]
    ds_read_b128 v[152:155], v6 offset:2304
    ds_read_b128 v[156:159], v7 offset:1184
    s_waitcnt lgkmcnt(9)
    v_mfma_f32_32x32x16_bf16 v[64:79], v[96:99], v[112:115], v[64:79]
    ds_read_b128 v[160:163], v7 offset:160
    s_waitcnt lgkmcnt(8)
    v_mfma_f32_32x32x16_bf16 v[80:95], v[120:123], v[124:127], v[80:95]
    ds_read_b128 v[96:99], v6 offset:3264
    ds_read_b128 v[100:103], v7 offset:1664
    s_waitcnt lgkmcnt(8)
    v_mfma_f32_32x32x16_bf16 v[80:95], v[128:131], v[132:135], v[80:95]
    ds_read_b128 v[104:107], v6 offset:2240
    ds_read_b128 v[108:111], v7 offset:1152
    s_waitcnt lgkmcnt(9)
    v_mfma_f32_32x32x16_bf16 v[64:79], v[120:123], v[136:139], v[64:79]
    ds_read_b128 v[112:115], v7 offset:128
    s_waitcnt lgkmcnt(8)
    v_mfma_f32_32x32x16_bf16 v[80:95], v[144:147], v[148:151], v[80:95]
    ds_read_b128 v[120:123], v6 offset:3200
    ds_read_b128 v[124:127], v7 offset:1632
    s_waitcnt lgkmcnt(8)
    v_mfma_f32_32x32x16_bf16 v[80:95], v[152:155], v[156:159], v[80:95]
    ds_read_b128 v[128:131], v6 offset:2176
    ds_read_b128 v[132:135], v7 offset:1120
    s_waitcnt lgkmcnt(9)
    v_mfma_f32_32x32x16_bf16 v[64:79], v[144:147], v[160:163], v[64:79]
    ds_read_b128 v[136:139], v7 offset:96
    s_waitcnt lgkmcnt(8)
    v_mfma_f32_32x32x16_bf16 v[80:95], v[96:99], v[100:103], v[80:95]
    ds_read_b128 v[144:147], v6 offset:3136
    ds_read_b128 v[148:151], v7 offset:1600
    s_waitcnt lgkmcnt(8)
    v_mfma_f32_32x32x16_bf16 v[80:95], v[104:107], v[108:111], v[80:95]
    ds_read_b128 v[152:155], v6 offset:2112
    ds_read_b128 v[156:159], v7 offset:1088
    s_waitcnt lgkmcnt(9)
    v_mfma_f32_32x32x16_bf16 v[64:79], v[96:99], v[112:115], v[64:79]
    ds_read_b128 v[160:163], v7 offset:64
    s_waitcnt lgkmcnt(8)
    v_mfma_f32_32x32x16_bf16 v[80:95], v[120:123], v[124:127], v[80:95]
    ds_read_b128 v[96:99], v6 offset:3072
    ds_read_b128 v[100:103], v7 offset:1568
    s_waitcnt lgkmcnt(8)
    v_mfma_f32_32x32x16_bf16 v[80:95], v[128:131], v[132:135], v[80:95]
    ds_read_b128 v[104:107], v6 offset:2048
    ds_read_b128 v[108:111], v7 offset:1056
    s_waitcnt lgkmcnt(9)
    v_mfma_f32_32x32x16_bf16 v[64:79], v[120:123], v[136:139], v[64:79]
    ds_read_b128 v[112:115], v7 offset:32
    s_waitcnt lgkmcnt(8)
    v_mfma_f32_32x32x16_bf16 v[80:95], v[144:147], v[148:151], v[80:95]
    s_waitcnt lgkmcnt(6)
    v_mfma_f32_32x32x16_bf16 v[80:95], v[152:155], v[156:159], v[80:95]
    s_waitcnt lgkmcnt(5)
    v_mfma_f32_32x32x16_bf16 v[64:79], v[144:147], v[160:163], v[64:79]
    s_waitcnt lgkmcnt(3)
    v_mfma_f32_32x32x16_bf16 v[80:95], v[96:99], v[100:103], v[80:95]
    s_waitcnt lgkmcnt(1)
    v_mfma_f32_32x32x16_bf16 v[80:95], v[104:107], v[108:111], v[80:95]
    s_waitcnt lgkmcnt(0)
    v_mfma_f32_32x32x16_bf16 v[64:79], v[96:99], v[112:115], v[64:79]
    ds_read_b64 v[112:113], v19 offset:3088
    ds_read_b64 v[114:115], v19 offset:3072
    s_mov_b32 s8, 0
    s_nop 10
    ds_write_b128 v18, v[88:91] offset:16928
    ds_write_b128 v18, v[92:95] offset:21056
    ds_write_b128 v10, v[80:83] offset:26128
    ds_write_b128 v10, v[84:87] offset:27184
    ds_write_b128 v18, v[72:75] offset:15392
    ds_write_b128 v18, v[76:79] offset:19520
    s_waitcnt lgkmcnt(0)
    s_barrier
    ds_read_b128 v[96:99], v18 offset:15376
    ds_read_b128 v[100:103], v18 offset:19504
    s_waitcnt lgkmcnt(0)
    v_cndmask_b32 v96, v96, 0, s[92:93]
    v_cndmask_b32 v97, v97, 0, s[92:93]
    v_cndmask_b32 v98, v98, 0, s[92:93]
    v_cndmask_b32 v99, v99, 0, s[92:93]
    v_cndmask_b32 v100, v100, 0, s[92:93]
    v_cndmask_b32 v101, v101, 0, s[92:93]
    v_cndmask_b32 v102, v102, 0, s[92:93]
    v_cndmask_b32 v103, v103, 0, s[92:93]
    v_add_f32 v64, v64, v96
    v_add_f32 v65, v65, v97
    v_add_f32 v66, v66, v98
    v_add_f32 v67, v67, v99
    v_add_f32 v68, v68, v100
    v_add_f32 v69, v69, v101
    v_add_f32 v70, v70, v102
    v_add_f32 v71, v71, v103
    s_branch cv_cvdone_33
cv_cv1_30:
    ds_read_b128 v[96:99], v6 offset:1984
    ds_read_b128 v[100:103], v7 offset:1024
    ds_read_b128 v[104:107], v6 offset:960
    ds_read_b128 v[108:111], v7 offset:512
    ds_read_b128 v[120:123], v6 offset:1920
    ds_read_b128 v[124:127], v7 offset:992
    ds_read_b128 v[128:131], v6 offset:896
    ds_read_b128 v[132:135], v7 offset:480
    v_mov_b32 v64, 0
    v_mov_b32 v65, 0
    v_mov_b32 v66, 0
    v_mov_b32 v67, 0
    v_mov_b32 v68, 0
    v_mov_b32 v69, 0
    v_mov_b32 v70, 0
    v_mov_b32 v71, 0
    v_mov_b32 v72, 0
    v_mov_b32 v73, 0
    v_mov_b32 v74, 0
    v_mov_b32 v75, 0
    v_mov_b32 v76, 0
    v_mov_b32 v77, 0
    v_mov_b32 v78, 0
    v_mov_b32 v79, 0
    s_nop 0
    s_waitcnt lgkmcnt(6)
    v_mfma_f32_32x32x16_bf16 v[64:79], v[96:99], v[100:103], v[64:79]
    ds_read_b128 v[144:147], v6 offset:1856
    ds_read_b128 v[148:151], v7 offset:960
    s_waitcnt lgkmcnt(6)
    v_mfma_f32_32x32x16_bf16 v[64:79], v[104:107], v[108:111], v[64:79]
    ds_read_b128 v[152:155], v6 offset:832
    ds_read_b128 v[156:159], v7 offset:448
    s_waitcnt lgkmcnt(6)
    v_mfma_f32_32x32x16_bf16 v[64:79], v[120:123], v[124:127], v[64:79]
    ds_read_b128 v[96:99], v6 offset:1792
    ds_read_b128 v[100:103], v7 offset:928
    s_waitcnt lgkmcnt(6)
    v_mfma_f32_32x32x16_bf16 v[64:79], v[128:131], v[132:135], v[64:79]
    ds_read_b128 v[104:107], v6 offset:768
    ds_read_b128 v[108:111], v7 offset:416
    s_waitcnt lgkmcnt(6)
    v_mfma_f32_32x32x16_bf16 v[64:79], v[144:147], v[148:151], v[64:79]
    ds_read_b128 v[120:123], v6 offset:1728
    ds_read_b128 v[124:127], v7 offset:896
    s_waitcnt lgkmcnt(6)
    v_mfma_f32_32x32x16_bf16 v[64:79], v[152:155], v[156:159], v[64:79]
    ds_read_b128 v[128:131], v6 offset:704
    ds_read_b128 v[132:135], v7 offset:384
    s_waitcnt lgkmcnt(6)
    v_mfma_f32_32x32x16_bf16 v[64:79], v[96:99], v[100:103], v[64:79]
    ds_read_b128 v[144:147], v6 offset:1664
    ds_read_b128 v[148:151], v7 offset:864
    s_waitcnt lgkmcnt(6)
    v_mfma_f32_32x32x16_bf16 v[64:79], v[104:107], v[108:111], v[64:79]
    ds_read_b128 v[152:155], v6 offset:640
    ds_read_b128 v[156:159], v7 offset:352
    s_waitcnt lgkmcnt(6)
    v_mfma_f32_32x32x16_bf16 v[64:79], v[120:123], v[124:127], v[64:79]
    ds_read_b128 v[96:99], v6 offset:1600
    ds_read_b128 v[100:103], v7 offset:832
    s_waitcnt lgkmcnt(6)
    v_mfma_f32_32x32x16_bf16 v[64:79], v[128:131], v[132:135], v[64:79]
    ds_read_b128 v[104:107], v6 offset:576
    ds_read_b128 v[108:111], v7 offset:320
    s_waitcnt lgkmcnt(6)
    v_mfma_f32_32x32x16_bf16 v[64:79], v[144:147], v[148:151], v[64:79]
    ds_read_b128 v[120:123], v6 offset:1536
    ds_read_b128 v[124:127], v7 offset:800
    s_waitcnt lgkmcnt(6)
    v_mfma_f32_32x32x16_bf16 v[64:79], v[152:155], v[156:159], v[64:79]
    ds_read_b128 v[128:131], v6 offset:512
    ds_read_b128 v[132:135], v7 offset:288
    s_waitcnt lgkmcnt(6)
    v_mfma_f32_32x32x16_bf16 v[64:79], v[96:99], v[100:103], v[64:79]
    ds_read_b128 v[144:147], v6 offset:1472
    ds_read_b128 v[148:151], v7 offset:768
    s_waitcnt lgkmcnt(6)
    v_mfma_f32_32x32x16_bf16 v[64:79], v[104:107], v[108:111], v[64:79]
    ds_read_b128 v[152:155], v6 offset:448
    ds_read_b128 v[156:159], v7 offset:256
    s_waitcnt lgkmcnt(6)
    v_mfma_f32_32x32x16_bf16 v[64:79], v[120:123], v[124:127], v[64:79]
    ds_read_b128 v[96:99], v6 offset:1408
    ds_read_b128 v[100:103], v7 offset:736
    s_waitcnt lgkmcnt(6)
    v_mfma_f32_32x32x16_bf16 v[64:79], v[128:131], v[132:135], v[64:79]
    ds_read_b128 v[104:107], v6 offset:384
    ds_read_b128 v[108:111], v7 offset:224
    s_waitcnt lgkmcnt(6)
    v_mfma_f32_32x32x16_bf16 v[64:79], v[144:147], v[148:151], v[64:79]
    ds_read_b128 v[120:123], v6 offset:1344
    ds_read_b128 v[124:127], v7 offset:704
    s_waitcnt lgkmcnt(6)
    v_mfma_f32_32x32x16_bf16 v[64:79], v[152:155], v[156:159], v[64:79]
    ds_read_b128 v[128:131], v6 offset:320
    ds_read_b128 v[132:135], v7 offset:192
    s_waitcnt lgkmcnt(6)
    v_mfma_f32_32x32x16_bf16 v[64:79], v[96:99], v[100:103], v[64:79]
    ds_read_b128 v[144:147], v6 offset:1280
    ds_read_b128 v[148:151], v7 offset:672
    s_waitcnt lgkmcnt(6)
    v_mfma_f32_32x32x16_bf16 v[64:79], v[104:107], v[108:111], v[64:79]
    ds_read_b128 v[152:155], v6 offset:256
    ds_read_b128 v[156:159], v7 offset:160
    s_waitcnt lgkmcnt(6)
    v_mfma_f32_32x32x16_bf16 v[64:79], v[120:123], v[124:127], v[64:79]
    ds_read_b128 v[96:99], v6 offset:1216
    ds_read_b128 v[100:103], v7 offset:640
    s_waitcnt lgkmcnt(6)
    v_mfma_f32_32x32x16_bf16 v[64:79], v[128:131], v[132:135], v[64:79]
    ds_read_b128 v[104:107], v6 offset:192
    ds_read_b128 v[108:111], v7 offset:128
    s_waitcnt lgkmcnt(6)
    v_mfma_f32_32x32x16_bf16 v[64:79], v[144:147], v[148:151], v[64:79]
    ds_read_b128 v[120:123], v6 offset:1152
    ds_read_b128 v[124:127], v7 offset:608
    s_waitcnt lgkmcnt(6)
    v_mfma_f32_32x32x16_bf16 v[64:79], v[152:155], v[156:159], v[64:79]
    ds_read_b128 v[128:131], v6 offset:128
    ds_read_b128 v[132:135], v7 offset:96
    s_waitcnt lgkmcnt(6)
    v_mfma_f32_32x32x16_bf16 v[64:79], v[96:99], v[100:103], v[64:79]
    ds_read_b128 v[144:147], v6 offset:1088
    ds_read_b128 v[148:151], v7 offset:576
    s_waitcnt lgkmcnt(6)
    v_mfma_f32_32x32x16_bf16 v[64:79], v[104:107], v[108:111], v[64:79]
    ds_read_b128 v[152:155], v6 offset:64
    ds_read_b128 v[156:159], v7 offset:64
    s_waitcnt lgkmcnt(6)
    v_mfma_f32_32x32x16_bf16 v[64:79], v[120:123], v[124:127], v[64:79]
    ds_read_b128 v[96:99], v6 offset:1024
    ds_read_b128 v[100:103], v7 offset:544
    s_waitcnt lgkmcnt(6)
    v_mfma_f32_32x32x16_bf16 v[64:79], v[128:131], v[132:135], v[64:79]
    ds_read_b128 v[104:107], v6 offset:0
    ds_read_b128 v[108:111], v7 offset:32
    s_waitcnt lgkmcnt(6)
    v_mfma_f32_32x32x16_bf16 v[64:79], v[144:147], v[148:151], v[64:79]
    s_waitcnt lgkmcnt(4)
    v_mfma_f32_32x32x16_bf16 v[64:79], v[152:155], v[156:159], v[64:79]
    s_waitcnt lgkmcnt(2)
    v_mfma_f32_32x32x16_bf16 v[64:79], v[96:99], v[100:103], v[64:79]
    s_waitcnt lgkmcnt(0)
    v_mfma_f32_32x32x16_bf16 v[64:79], v[104:107], v[108:111], v[64:79]
    ds_read_b64 v[112:113], v19 offset:16
    ds_read_b64 v[114:115], v19 offset:0
    s_mov_b32 s8, 3
    s_nop 10
    ds_write_b128 v10, v[72:75] offset:23840
    ds_write_b128 v10, v[76:79] offset:24896
    s_waitcnt lgkmcnt(0)
    s_barrier
    ds_read_b128 v[96:99], v18 offset:16912
    ds_read_b128 v[100:103], v18 offset:21040
    ds_read_b128 v[88:91], v10 offset:23824
    ds_read_b128 v[92:95], v10 offset:24880
    ds_read_b128 v[104:107], v10 offset:26128
    ds_read_b128 v[108:111], v10 offset:27184
    s_waitcnt lgkmcnt(0)
    v_cndmask_b32 v88, v88, 0, s[92:93]
    v_cndmask_b32 v89, v89, 0, s[92:93]
    v_cndmask_b32 v90, v90, 0, s[92:93]
    v_cndmask_b32 v91, v91, 0, s[92:93]
    v_cndmask_b32 v92, v92, 0, s[92:93]
    v_cndmask_b32 v93, v93, 0, s[92:93]
    v_cndmask_b32 v94, v94, 0, s[92:93]
    v_cndmask_b32 v95, v95, 0, s[92:93]
    v_add_f32 v64, v64, v104
    v_add_f32 v65, v65, v105
    v_add_f32 v66, v66, v106
    v_add_f32 v67, v67, v107
    v_add_f32 v68, v68, v108
    v_add_f32 v69, v69, v109
    v_add_f32 v70, v70, v110
    v_add_f32 v71, v71, v111
    v_add_f32 v96, v96, v88
    v_add_f32 v97, v97, v89
    v_add_f32 v98, v98, v90
    v_add_f32 v99, v99, v91
    v_add_f32 v100, v100, v92
    v_add_f32 v101, v101, v93
    v_add_f32 v102, v102, v94
    v_add_f32 v103, v103, v95
    v_add_f32 v64, v64, v96
    v_add_f32 v65, v65, v97
    v_add_f32 v66, v66, v98
    v_add_f32 v67, v67, v99
    v_add_f32 v68, v68, v100
    v_add_f32 v69, v69, v101
    v_add_f32 v70, v70, v102
    v_add_f32 v71, v71, v103
    s_branch cv_cvdone_33
cv_cv2_31:
    ds_read_b128 v[96:99], v6 offset:4032
    ds_read_b128 v[100:103], v7 offset:1536
    ds_read_b128 v[104:107], v6 offset:3008
    ds_read_b128 v[108:111], v7 offset:1024
    ds_read_b128 v[112:115], v6 offset:1984
    ds_read_b128 v[116:119], v7 offset:512
    ds_read_b128 v[120:123], v6 offset:3968
    ds_read_b128 v[124:127], v7 offset:1504
    ds_read_b128 v[128:131], v6 offset:2944
    ds_read_b128 v[132:135], v7 offset:992
    ds_read_b128 v[136:139], v6 offset:1920
    ds_read_b128 v[140:143], v7 offset:480
    v_mov_b32 v64, 0
    v_mov_b32 v65, 0
    v_mov_b32 v66, 0
    v_mov_b32 v67, 0
    v_mov_b32 v68, 0
    v_mov_b32 v69, 0
    v_mov_b32 v70, 0
    v_mov_b32 v71, 0
    v_mov_b32 v72, 0
    v_mov_b32 v73, 0
    v_mov_b32 v74, 0
    v_mov_b32 v75, 0
    v_mov_b32 v76, 0
    v_mov_b32 v77, 0
    v_mov_b32 v78, 0
    v_mov_b32 v79, 0
    s_nop 0
    s_waitcnt lgkmcnt(10)
    v_mfma_f32_32x32x16_bf16 v[64:79], v[96:99], v[100:103], v[64:79]
    ds_read_b128 v[144:147], v6 offset:3904
    ds_read_b128 v[148:151], v7 offset:1472
    s_waitcnt lgkmcnt(10)
    v_mfma_f32_32x32x16_bf16 v[64:79], v[104:107], v[108:111], v[64:79]
    ds_read_b128 v[152:155], v6 offset:2880
    ds_read_b128 v[156:159], v7 offset:960
    s_waitcnt lgkmcnt(10)
    v_mfma_f32_32x32x16_bf16 v[64:79], v[112:115], v[116:119], v[64:79]
    ds_read_b128 v[160:163], v6 offset:1856
    ds_read_b128 v[164:167], v7 offset:448
    s_waitcnt lgkmcnt(10)
    v_mfma_f32_32x32x16_bf16 v[64:79], v[120:123], v[124:127], v[64:79]
    ds_read_b128 v[96:99], v6 offset:3840
    ds_read_b128 v[100:103], v7 offset:1440
    s_waitcnt lgkmcnt(10)
    v_mfma_f32_32x32x16_bf16 v[64:79], v[128:131], v[132:135], v[64:79]
    ds_read_b128 v[104:107], v6 offset:2816
    ds_read_b128 v[108:111], v7 offset:928
    s_waitcnt lgkmcnt(10)
    v_mfma_f32_32x32x16_bf16 v[64:79], v[136:139], v[140:143], v[64:79]
    ds_read_b128 v[112:115], v6 offset:1792
    ds_read_b128 v[116:119], v7 offset:416
    s_waitcnt lgkmcnt(10)
    v_mfma_f32_32x32x16_bf16 v[64:79], v[144:147], v[148:151], v[64:79]
    ds_read_b128 v[120:123], v6 offset:3776
    ds_read_b128 v[124:127], v7 offset:1408
    s_waitcnt lgkmcnt(10)
    v_mfma_f32_32x32x16_bf16 v[64:79], v[152:155], v[156:159], v[64:79]
    ds_read_b128 v[128:131], v6 offset:2752
    ds_read_b128 v[132:135], v7 offset:896
    s_waitcnt lgkmcnt(10)
    v_mfma_f32_32x32x16_bf16 v[64:79], v[160:163], v[164:167], v[64:79]
    ds_read_b128 v[136:139], v6 offset:1728
    ds_read_b128 v[140:143], v7 offset:384
    s_waitcnt lgkmcnt(10)
    v_mfma_f32_32x32x16_bf16 v[64:79], v[96:99], v[100:103], v[64:79]
    ds_read_b128 v[144:147], v6 offset:3712
    ds_read_b128 v[148:151], v7 offset:1376
    s_waitcnt lgkmcnt(10)
    v_mfma_f32_32x32x16_bf16 v[64:79], v[104:107], v[108:111], v[64:79]
    ds_read_b128 v[152:155], v6 offset:2688
    ds_read_b128 v[156:159], v7 offset:864
    s_waitcnt lgkmcnt(10)
    v_mfma_f32_32x32x16_bf16 v[64:79], v[112:115], v[116:119], v[64:79]
    ds_read_b128 v[160:163], v6 offset:1664
    ds_read_b128 v[164:167], v7 offset:352
    s_waitcnt lgkmcnt(10)
    v_mfma_f32_32x32x16_bf16 v[64:79], v[120:123], v[124:127], v[64:79]
    ds_read_b128 v[96:99], v6 offset:3648
    ds_read_b128 v[100:103], v7 offset:1344
    s_waitcnt lgkmcnt(10)
    v_mfma_f32_32x32x16_bf16 v[64:79], v[128:131], v[132:135], v[64:79]
    ds_read_b128 v[104:107], v6 offset:2624
    ds_read_b128 v[108:111], v7 offset:832
    s_waitcnt lgkmcnt(10)
    v_mfma_f32_32x32x16_bf16 v[64:79], v[136:139], v[140:143], v[64:79]
    ds_read_b128 v[112:115], v6 offset:1600
    ds_read_b128 v[116:119], v7 offset:320
    s_waitcnt lgkmcnt(10)
    v_mfma_f32_32x32x16_bf16 v[64:79], v[144:147], v[148:151], v[64:79]
    ds_read_b128 v[120:123], v6 offset:3584
    ds_read_b128 v[124:127], v7 offset:1312
    s_waitcnt lgkmcnt(10)
    v_mfma_f32_32x32x16_bf16 v[64:79], v[152:155], v[156:159], v[64:79]
    ds_read_b128 v[128:131], v6 offset:2560
    ds_read_b128 v[132:135], v7 offset:800
    s_waitcnt lgkmcnt(10)
    v_mfma_f32_32x32x16_bf16 v[64:79], v[160:163], v[164:167], v[64:79]
    ds_read_b128 v[136:139], v6 offset:1536
    ds_read_b128 v[140:143], v7 offset:288
    s_waitcnt lgkmcnt(10)
    v_mfma_f32_32x32x16_bf16 v[64:79], v[96:99], v[100:103], v[64:79]
    ds_read_b128 v[144:147], v6 offset:3520
    ds_read_b128 v[148:151], v7 offset:1280
    s_waitcnt lgkmcnt(10)
    v_mfma_f32_32x32x16_bf16 v[64:79], v[104:107], v[108:111], v[64:79]
    ds_read_b128 v[152:155], v6 offset:2496
    ds_read_b128 v[156:159], v7 offset:768
    s_waitcnt lgkmcnt(10)
    v_mfma_f32_32x32x16_bf16 v[64:79], v[112:115], v[116:119], v[64:79]
    ds_read_b128 v[160:163], v6 offset:1472
    ds_read_b128 v[164:167], v7 offset:256
    s_waitcnt lgkmcnt(10)
    v_mfma_f32_32x32x16_bf16 v[64:79], v[120:123], v[124:127], v[64:79]
    ds_read_b128 v[96:99], v6 offset:3456
    ds_read_b128 v[100:103], v7 offset:1248
    s_waitcnt lgkmcnt(10)
    v_mfma_f32_32x32x16_bf16 v[64:79], v[128:131], v[132:135], v[64:79]
    ds_read_b128 v[104:107], v6 offset:2432
    ds_read_b128 v[108:111], v7 offset:736
    s_waitcnt lgkmcnt(10)
    v_mfma_f32_32x32x16_bf16 v[64:79], v[136:139], v[140:143], v[64:79]
    ds_read_b128 v[112:115], v6 offset:1408
    ds_read_b128 v[116:119], v7 offset:224
    s_waitcnt lgkmcnt(10)
    v_mfma_f32_32x32x16_bf16 v[64:79], v[144:147], v[148:151], v[64:79]
    ds_read_b128 v[120:123], v6 offset:3392
    ds_read_b128 v[124:127], v7 offset:1216
    s_waitcnt lgkmcnt(10)
    v_mfma_f32_32x32x16_bf16 v[64:79], v[152:155], v[156:159], v[64:79]
    ds_read_b128 v[128:131], v6 offset:2368
    ds_read_b128 v[132:135], v7 offset:704
    s_waitcnt lgkmcnt(10)
    v_mfma_f32_32x32x16_bf16 v[64:79], v[160:163], v[164:167], v[64:79]
    ds_read_b128 v[136:139], v6 offset:1344
    ds_read_b128 v[140:143], v7 offset:192
    s_waitcnt lgkmcnt(10)
    v_mfma_f32_32x32x16_bf16 v[64:79], v[96:99], v[100:103], v[64:79]
    ds_read_b128 v[144:147], v6 offset:3328
    ds_read_b128 v[148:151], v7 offset:1184
    s_waitcnt lgkmcnt(10)
    v_mfma_f32_32x32x16_bf16 v[64:79], v[104:107], v[108:111], v[64:79]
    ds_read_b128 v[152:155], v6 offset:2304
    ds_read_b128 v[156:159], v7 offset:672
    s_waitcnt lgkmcnt(10)
    v_mfma_f32_32x32x16_bf16 v[64:79], v[112:115], v[116:119], v[64:79]
    ds_read_b128 v[160:163], v6 offset:1280
    ds_read_b128 v[164:167], v7 offset:160
    s_waitcnt lgkmcnt(10)
    v_mfma_f32_32x32x16_bf16 v[64:79], v[120:123], v[124:127], v[64:79]
    ds_read_b128 v[96:99], v6 offset:3264
    ds_read_b128 v[100:103], v7 offset:1152
    s_waitcnt lgkmcnt(10)
    v_mfma_f32_32x32x16_bf16 v[64:79], v[128:131], v[132:135], v[64:79]
    ds_read_b128 v[104:107], v6 offset:2240
    ds_read_b128 v[108:111], v7 offset:640
    s_waitcnt lgkmcnt(10)
    v_mfma_f32_32x32x16_bf16 v[64:79], v[136:139], v[140:143], v[64:79]
    ds_read_b128 v[112:115], v6 offset:1216
    ds_read_b128 v[116:119], v7 offset:128
    s_waitcnt lgkmcnt(10)
    v_mfma_f32_32x32x16_bf16 v[64:79], v[144:147], v[148:151], v[64:79]
    ds_read_b128 v[120:123], v6 offset:3200
    ds_read_b128 v[124:127], v7 offset:1120
    s_waitcnt lgkmcnt(10)
    v_mfma_f32_32x32x16_bf16 v[64:79], v[152:155], v[156:159], v[64:79]
    ds_read_b128 v[128:131], v6 offset:2176
    ds_read_b128 v[132:135], v7 offset:608
    s_waitcnt lgkmcnt(10)
    v_mfma_f32_32x32x16_bf16 v[64:79], v[160:163], v[164:167], v[64:79]
    ds_read_b128 v[136:139], v6 offset:1152
    ds_read_b128 v[140:143], v7 offset:96
    s_waitcnt lgkmcnt(10)
    v_mfma_f32_32x32x16_bf16 v[64:79], v[96:99], v[100:103], v[64:79]
    ds_read_b128 v[144:147], v6 offset:3136
    ds_read_b128 v[148:151], v7 offset:1088
    s_waitcnt lgkmcnt(10)
    v_mfma_f32_32x32x16_bf16 v[64:79], v[104:107], v[108:111], v[64:79]
    ds_read_b128 v[152:155], v6 offset:2112
    ds_read_b128 v[156:159], v7 offset:576
    s_waitcnt lgkmcnt(10)
    v_mfma_f32_32x32x16_bf16 v[64:79], v[112:115], v[116:119], v[64:79]
    ds_read_b128 v[160:163], v6 offset:1088
    ds_read_b128 v[164:167], v7 offset:64
    s_waitcnt lgkmcnt(10)
    v_mfma_f32_32x32x16_bf16 v[64:79], v[120:123], v[124:127], v[64:79]
    ds_read_b128 v[96:99], v6 offset:3072
    ds_read_b128 v[100:103], v7 offset:1056
    s_waitcnt lgkmcnt(10)
    v_mfma_f32_32x32x16_bf16 v[64:79], v[128:131], v[132:135], v[64:79]
    ds_read_b128 v[104:107], v6 offset:2048
    ds_read_b128 v[108:111], v7 offset:544
    s_waitcnt lgkmcnt(10)
    v_mfma_f32_32x32x16_bf16 v[64:79], v[136:139], v[140:143], v[64:79]
    ds_read_b128 v[112:115], v6 offset:1024
    ds_read_b128 v[116:119], v7 offset:32
    s_waitcnt lgkmcnt(10)
    v_mfma_f32_32x32x16_bf16 v[64:79], v[144:147], v[148:151], v[64:79]
    s_waitcnt lgkmcnt(8)
    v_mfma_f32_32x32x16_bf16 v[64:79], v[152:155], v[156:159], v[64:79]
    s_waitcnt lgkmcnt(6)
    v_mfma_f32_32x32x16_bf16 v[64:79], v[160:163], v[164:167], v[64:79]
    s_waitcnt lgkmcnt(4)
    v_mfma_f32_32x32x16_bf16 v[64:79], v[96:99], v[100:103], v[64:79]
    s_waitcnt lgkmcnt(2)
    v_mfma_f32_32x32x16_bf16 v[64:79], v[104:107], v[108:111], v[64:79]
    s_waitcnt lgkmcnt(0)
    v_mfma_f32_32x32x16_bf16 v[64:79], v[112:115], v[116:119], v[64:79]
    ds_read_b64 v[112:113], v19 offset:1040
    ds_read_b64 v[114:115], v19 offset:1024
    s_mov_b32 s8, 2
    s_nop 10
    ds_write_b128 v18, v[72:75] offset:16416
    ds_write_b128 v18, v[76:79] offset:20544
    s_waitcnt lgkmcnt(0)
    s_barrier
    ds_read_b128 v[96:99], v18 offset:16400
    ds_read_b128 v[100:103], v18 offset:20528
    s_waitcnt lgkmcnt(0)
    v_add_f32 v64, v64, v96
    v_add_f32 v65, v65, v97
    v_add_f32 v66, v66, v98
    v_add_f32 v67, v67, v99
    v_add_f32 v68, v68, v100
    v_add_f32 v69, v69, v101
    v_add_f32 v70, v70, v102
    v_add_f32 v71, v71, v103
    s_branch cv_cvdone_33
cv_cv3_32:
    ds_read_b128 v[96:99], v6 offset:4032
    ds_read_b128 v[100:103], v7 offset:1024
    ds_read_b128 v[104:107], v6 offset:3008
    ds_read_b128 v[108:111], v7 offset:512
    ds_read_b128 v[120:123], v6 offset:3968
    ds_read_b128 v[124:127], v7 offset:992
    ds_read_b128 v[128:131], v6 offset:2944
    ds_read_b128 v[132:135], v7 offset:480
    v_mov_b32 v64, 0
    v_mov_b32 v65, 0
    v_mov_b32 v66, 0
    v_mov_b32 v67, 0
    v_mov_b32 v68, 0
    v_mov_b32 v69, 0
    v_mov_b32 v70, 0
    v_mov_b32 v71, 0
    v_mov_b32 v72, 0
    v_mov_b32 v73, 0
    v_mov_b32 v74, 0
    v_mov_b32 v75, 0
    v_mov_b32 v76, 0
    v_mov_b32 v77, 0
    v_mov_b32 v78, 0
    v_mov_b32 v79, 0
    s_nop 0
    s_waitcnt lgkmcnt(6)
    v_mfma_f32_32x32x16_bf16 v[64:79], v[96:99], v[100:103], v[64:79]
    ds_read_b128 v[144:147], v6 offset:3904
    ds_read_b128 v[148:151], v7 offset:960
    s_waitcnt lgkmcnt(6)
    v_mfma_f32_32x32x16_bf16 v[64:79], v[104:107], v[108:111], v[64:79]
    ds_read_b128 v[152:155], v6 offset:2880
    ds_read_b128 v[156:159], v7 offset:448
    s_waitcnt lgkmcnt(6)
    v_mfma_f32_32x32x16_bf16 v[64:79], v[120:123], v[124:127], v[64:79]
    ds_read_b128 v[96:99], v6 offset:3840
    ds_read_b128 v[100:103], v7 offset:928
    s_waitcnt lgkmcnt(6)
    v_mfma_f32_32x32x16_bf16 v[64:79], v[128:131], v[132:135], v[64:79]
    ds_read_b128 v[104:107], v6 offset:2816
    ds_read_b128 v[108:111], v7 offset:416
    s_waitcnt lgkmcnt(6)
    v_mfma_f32_32x32x16_bf16 v[64:79], v[144:147], v[148:151], v[64:79]
    ds_read_b128 v[120:123], v6 offset:3776
    ds_read_b128 v[124:127], v7 offset:896
    s_waitcnt lgkmcnt(6)
    v_mfma_f32_32x32x16_bf16 v[64:79], v[152:155], v[156:159], v[64:79]
    ds_read_b128 v[128:131], v6 offset:2752
    ds_read_b128 v[132:135], v7 offset:384
    s_waitcnt lgkmcnt(6)
    v_mfma_f32_32x32x16_bf16 v[64:79], v[96:99], v[100:103], v[64:79]
    ds_read_b128 v[144:147], v6 offset:3712
    ds_read_b128 v[148:151], v7 offset:864
    s_waitcnt lgkmcnt(6)
    v_mfma_f32_32x32x16_bf16 v[64:79], v[104:107], v[108:111], v[64:79]
    ds_read_b128 v[152:155], v6 offset:2688
    ds_read_b128 v[156:159], v7 offset:352
    s_waitcnt lgkmcnt(6)
    v_mfma_f32_32x32x16_bf16 v[64:79], v[120:123], v[124:127], v[64:79]
    ds_read_b128 v[96:99], v6 offset:3648
    ds_read_b128 v[100:103], v7 offset:832
    s_waitcnt lgkmcnt(6)
    v_mfma_f32_32x32x16_bf16 v[64:79], v[128:131], v[132:135], v[64:79]
    ds_read_b128 v[104:107], v6 offset:2624
    ds_read_b128 v[108:111], v7 offset:320
    s_waitcnt lgkmcnt(6)
    v_mfma_f32_32x32x16_bf16 v[64:79], v[144:147], v[148:151], v[64:79]
    ds_read_b128 v[120:123], v6 offset:3584
    ds_read_b128 v[124:127], v7 offset:800
    s_waitcnt lgkmcnt(6)
    v_mfma_f32_32x32x16_bf16 v[64:79], v[152:155], v[156:159], v[64:79]
    ds_read_b128 v[128:131], v6 offset:2560
    ds_read_b128 v[132:135], v7 offset:288
    s_waitcnt lgkmcnt(6)
    v_mfma_f32_32x32x16_bf16 v[64:79], v[96:99], v[100:103], v[64:79]
    ds_read_b128 v[144:147], v6 offset:3520
    ds_read_b128 v[148:151], v7 offset:768
    s_waitcnt lgkmcnt(6)
    v_mfma_f32_32x32x16_bf16 v[64:79], v[104:107], v[108:111], v[64:79]
    ds_read_b128 v[152:155], v6 offset:2496
    ds_read_b128 v[156:159], v7 offset:256
    s_waitcnt lgkmcnt(6)
    v_mfma_f32_32x32x16_bf16 v[64:79], v[120:123], v[124:127], v[64:79]
    ds_read_b128 v[96:99], v6 offset:3456
    ds_read_b128 v[100:103], v7 offset:736
    s_waitcnt lgkmcnt(6)
    v_mfma_f32_32x32x16_bf16 v[64:79], v[128:131], v[132:135], v[64:79]
    ds_read_b128 v[104:107], v6 offset:2432
    ds_read_b128 v[108:111], v7 offset:224
    s_waitcnt lgkmcnt(6)
    v_mfma_f32_32x32x16_bf16 v[64:79], v[144:147], v[148:151], v[64:79]
    ds_read_b128 v[120:123], v6 offset:3392
    ds_read_b128 v[124:127], v7 offset:704
    s_waitcnt lgkmcnt(6)
    v_mfma_f32_32x32x16_bf16 v[64:79], v[152:155], v[156:159], v[64:79]
    ds_read_b128 v[128:131], v6 offset:2368
    ds_read_b128 v[132:135], v7 offset:192
    s_waitcnt lgkmcnt(6)
    v_mfma_f32_32x32x16_bf16 v[64:79], v[96:99], v[100:103], v[64:79]
    ds_read_b128 v[144:147], v6 offset:3328
    ds_read_b128 v[148:151], v7 offset:672
    s_waitcnt lgkmcnt(6)
    v_mfma_f32_32x32x16_bf16 v[64:79], v[104:107], v[108:111], v[64:79]
    ds_read_b128 v[152:155], v6 offset:2304
    ds_read_b128 v[156:159], v7 offset:160
    s_waitcnt lgkmcnt(6)
    v_mfma_f32_32x32x16_bf16 v[64:79], v[120:123], v[124:127], v[64:79]
    ds_read_b128 v[96:99], v6 offset:3264
    ds_read_b128 v[100:103], v7 offset:640
    s_waitcnt lgkmcnt(6)
    v_mfma_f32_32x32x16_bf16 v[64:79], v[128:131], v[132:135], v[64:79]
    ds_read_b128 v[104:107], v6 offset:2240
    ds_read_b128 v[108:111], v7 offset:128
    s_waitcnt lgkmcnt(6)
    v_mfma_f32_32x32x16_bf16 v[64:79], v[144:147], v[148:151], v[64:79]
    ds_read_b128 v[120:123], v6 offset:3200
    ds_read_b128 v[124:127], v7 offset:608
    s_waitcnt lgkmcnt(6)
    v_mfma_f32_32x32x16_bf16 v[64:79], v[152:155], v[156:159], v[64:79]
    ds_read_b128 v[128:131], v6 offset:2176
    ds_read_b128 v[132:135], v7 offset:96
    s_waitcnt lgkmcnt(6)
    v_mfma_f32_32x32x16_bf16 v[64:79], v[96:99], v[100:103], v[64:79]
    ds_read_b128 v[144:147], v6 offset:3136
    ds_read_b128 v[148:151], v7 offset:576
    s_waitcnt lgkmcnt(6)
    v_mfma_f32_32x32x16_bf16 v[64:79], v[104:107], v[108:111], v[64:79]
    ds_read_b128 v[152:155], v6 offset:2112
    ds_read_b128 v[156:159], v7 offset:64
    s_waitcnt lgkmcnt(6)
    v_mfma_f32_32x32x16_bf16 v[64:79], v[120:123], v[124:127], v[64:79]
    ds_read_b128 v[96:99], v6 offset:3072
    ds_read_b128 v[100:103], v7 offset:544
    s_waitcnt lgkmcnt(6)
    v_mfma_f32_32x32x16_bf16 v[64:79], v[128:131], v[132:135], v[64:79]
    ds_read_b128 v[104:107], v6 offset:2048
    ds_read_b128 v[108:111], v7 offset:32
    s_waitcnt lgkmcnt(6)
    v_mfma_f32_32x32x16_bf16 v[64:79], v[144:147], v[148:151], v[64:79]
    s_waitcnt lgkmcnt(4)
    v_mfma_f32_32x32x16_bf16 v[64:79], v[152:155], v[156:159], v[64:79]
    s_waitcnt lgkmcnt(2)
    v_mfma_f32_32x32x16_bf16 v[64:79], v[96:99], v[100:103], v[64:79]
    s_waitcnt lgkmcnt(0)
    v_mfma_f32_32x32x16_bf16 v[64:79], v[104:107], v[108:111], v[64:79]
    ds_read_b64 v[112:113], v19 offset:2064
    ds_read_b64 v[114:115], v19 offset:2048
    s_mov_b32 s8, 1
    s_nop 10
    ds_write_b128 v18, v[72:75] offset:15904
    ds_write_b128 v18, v[76:79] offset:20032
    s_waitcnt lgkmcnt(0)
    s_barrier
    ds_read_b128 v[96:99], v18 offset:15888
    ds_read_b128 v[100:103], v18 offset:20016
    s_waitcnt lgkmcnt(0)
    v_add_f32 v64, v64, v96
    v_add_f32 v65, v65, v97
    v_add_f32 v66, v66, v98
    v_add_f32 v67, v67, v99
    v_add_f32 v68, v68, v100
    v_add_f32 v69, v69, v101
    v_add_f32 v70, v70, v102
    v_add_f32 v71, v71, v103
cv_cvdone_33:
    s_barrier
    v_add_u32 v7, 5120, v7
    s_mov_b32 s11, 0xffff0000
    v_and_b32 v80, s11, v113
    v_lshlrev_b32 v81, 16, v113
    v_and_b32 v82, s11, v112
    v_lshlrev_b32 v83, 16, v112
    v_mul_f32 v80, v16, v80
    v_mul_f32 v81, v16, v81
    v_mul_f32 v82, v16, v82
    v_mul_f32 v83, v16, v83
    v_cvt_pk_bf16_f32 v84, v80, v81
    v_cvt_pk_bf16_f32 v85, v82, v83
    v_cvt_pk_bf16_f32 v86, v64, v65
    v_cvt_pk_bf16_f32 v87, v66, v67
    v_lshlrev_b32 v80, 16, v84
    v_and_b32 v81, s11, v84
    v_lshlrev_b32 v82, 16, v85
    v_and_b32 v83, s11, v85
    v_lshlrev_b32 v64, 16, v86
    v_and_b32 v65, s11, v86
    v_lshlrev_b32 v66, 16, v87
    v_and_b32 v67, s11, v87
    v_add_f32 v80, v64, v80
    v_add_f32 v81, v65, v81
    v_add_f32 v82, v66, v82
    v_add_f32 v83, v67, v83
    v_cvt_pk_bf16_f32 v96, v80, v81
    v_cvt_pk_bf16_f32 v97, v82, v83
    v_and_b32 v88, s11, v115
    v_lshlrev_b32 v89, 16, v115
    v_and_b32 v90, s11, v114
    v_lshlrev_b32 v91, 16, v114
    v_mul_f32 v88, v16, v88
    v_mul_f32 v89, v16, v89
    v_mul_f32 v90, v16, v90
    v_mul_f32 v91, v16, v91
    v_cvt_pk_bf16_f32 v92, v88, v89
    v_cvt_pk_bf16_f32 v93, v90, v91
    v_cvt_pk_bf16_f32 v94, v68, v69
    v_cvt_pk_bf16_f32 v95, v70, v71
    v_lshlrev_b32 v88, 16, v92
    v_and_b32 v89, s11, v92
    v_lshlrev_b32 v90, 16, v93
    v_and_b32 v91, s11, v93
    v_lshlrev_b32 v68, 16, v94
    v_and_b32 v69, s11, v94
    v_lshlrev_b32 v70, 16, v95
    v_and_b32 v71, s11, v95
    v_add_f32 v88, v68, v88
    v_add_f32 v89, v69, v89
    v_add_f32 v90, v70, v90
    v_add_f32 v91, v71, v91
    v_cvt_pk_bf16_f32 v98, v88, v89
    v_cvt_pk_bf16_f32 v99, v90, v91
    s_sub_u32 s9, s74, 1
    s_lshl_b32 s9, s9, 12
    s_lshl_b32 s8, s8, 10
    s_add_u32 s9, s9, s8
    v_permlane32_swap_b32 v96, v98
    v_permlane32_swap_b32 v97, v99
    s_nop 0
    buffer_store_dwordx4 v[96:99], v20, s[88:91], s9 offen sc1
    s_cmp_lt_u32 s74, s75
    s_cbranch_scc1 cv_cl
fz_sfin:
    s_lshr_b32 s9, s2, 5
    s_lshl_b32 s9, s9, 7
    s_and_b32 s10, s2, 31
    s_lshl_b32 s10, s10, 2
    s_add_u32 s9, s9, s10
    s_add_u32 s9, s9, 4096
    s_waitcnt vmcnt(0)
    s_barrier
    s_cmp_lg_u32 s3, 0
    s_cbranch_scc1 sig_34
    s_add_u32 s12, s46, 16842752
    s_addc_u32 s13, s47, 0
    s_mov_b32 s14, 8192
    s_mov_b32 s15, 0x00020000
    v_mov_b32 v24, s101
    v_mov_b32 v25, 0
    s_mov_b64 exec, 1
    buffer_store_dword v24, v25, s[12:15], s9 offen sc1
    s_mov_b64 exec, -1
sig_34:
    s_endpgm
fz_G:
    s_and_b32 s92, s2, 7
    s_lshr_b32 s93, s2, 3
    s_sub_u32 s93, s93, 32
    s_cmp_ge_u32 s93, 28
    s_cbranch_scc1 fz_gate
    s_and_b32 s14, s93, 3
    s_lshr_b32 s15, s93, 2
    s_lshr_b32 s98, s92, 1
    s_lshl_b32 s98, s98, 2
    s_add_u32 s98, s98, s14
    s_and_b32 s99, s92, 1
    s_mul_i32 s99, s99, 7
    s_add_u32 s99, s99, s15
    s_mov_b32 s97, 0
    s_setprio 3
    s_mov_b32 s48, s16
    s_mov_b32 s49, s17
    s_mov_b32 s50, 2621440
    s_mov_b32 s51, 0x00020000
    s_mov_b32 s52, s32
    s_mov_b32 s53, s33
    s_mov_b32 s54, 2211840
    s_mov_b32 s55, 0x00020000
    s_mov_b32 s56, s34
    s_mov_b32 s57, s35
    s_mov_b32 s58, 3456
    s_mov_b32 s59, 0x00020000
    s_add_u32 s60, s46, 3145728
    s_addc_u32 s61, s47, 0
    s_mov_b32 s62, 7077888
    s_mov_b32 s63, 0x00020000
    s_lshl_b32 s4, s99, 3
    s_min_u32 s4, s4, 100
    s_lshl_b32 s5, s4, 5
    v_lshrrev_b32 v1, 3, v0
    v_mul_u32_u24 v1, 1280, v1
    v_and_b32 v2, 7, v0
    v_lshrrev_b32 v3, 4, v0
    v_xor_b32 v2, v2, v3
    v_lshl_add_u32 v14, v2, 4, v1
    v_xor_b32 v15, 64, v14
    v_add_u32 v15, 9216, v15
    v_add_u32 v16, 18432, v14
    v_add_u32 v17, 18432, v15
    s_lshl_b32 s6, s98, 7
    s_lshl_b32 s7, s3, 5
    s_add_u32 s6, s6, s7
    s_mul_i32 s6, s6, 1280
    s_lshl_b32 s7, s3, 12
    v_bfe_u32 v4, v0, 1, 3
    v_lshlrev_b32 v5, 1, v3
    v_xor_b32 v4, v4, v5
    v_lshlrev_b32 v4, 5, v4
    v_and_b32 v5, 1, v0
    v_lshl_add_u32 v4, v5, 4, v4
    v_mul_u32_u24 v3, 3456, v3
    v_add_u32 v18, v3, v4
    v_add_u32 v19, 12800, v18
    v_add_u32 v20, 110592, v18
    v_add_u32 v21, 110592, v19
    s_mul_i32 s8, s3, 27648
    s_add_u32 s8, s8, s5
    s_lshl_b32 s9, s3, 11
    s_add_u32 s9, s9, 49152
    s_mov_b32 s90, s97
    s_lshl_b32 s10, s90, 7
    s_add_u32 s64, s10, s6
    s_mul_i32 s10, s90, 221184
    s_add_u32 s80, s10, s8
    s_add_u32 s90, s90, 1
    s_cmp_ge_u32 s90, 10
    s_cselect_b32 s90, 0, s90
    s_add_u32 m0, s7, 0
    s_nop 0
    buffer_load_dwordx4 v14, s[48:51], s64 offen offset:0 lds
    buffer_load_dwordx4 v15, s[48:51], s64 offen offset:1024 lds
    buffer_load_dwordx4 v16, s[48:51], s64 offen offset:2048 lds
    buffer_load_dwordx4 v17, s[48:51], s64 offen offset:3072 lds
    s_add_u32 m0, s9, 0
    s_nop 0
    buffer_load_dwordx4 v18, s[52:55], s80 offen offset:0 lds
    buffer_load_dwordx4 v19, s[52:55], s80 offen offset:1024 lds
    s_add_u32 m0, s9, 8192
    s_nop 0
    buffer_load_dwordx4 v20, s[52:55], s80 offen offset:0 lds
    buffer_load_dwordx4 v21, s[52:55], s80 offen offset:1024 lds
    s_lshl_b32 s10, s90, 7
    s_add_u32 s65, s10, s6
    s_mul_i32 s10, s90, 221184
    s_add_u32 s81, s10, s8
    s_add_u32 s90, s90, 1
    s_cmp_ge_u32 s90, 10
    s_cselect_b32 s90, 0, s90
    s_lshl_b32 s10, s90, 7
    s_add_u32 s66, s10, s6
    s_mul_i32 s10, s90, 221184
    s_add_u32 s82, s10, s8
    s_add_u32 s90, s90, 1
    s_cmp_ge_u32 s90, 10
    s_cselect_b32 s90, 0, s90
    s_lshl_b32 s10, s90, 7
    s_add_u32 s67, s10, s6
    s_mul_i32 s10, s90, 221184
    s_add_u32 s83, s10, s8
    s_add_u32 s90, s90, 1
    s_cmp_ge_u32 s90, 10
    s_cselect_b32 s90, 0, s90
    s_lshl_b32 s10, s90, 7
    s_add_u32 s68, s10, s6
    s_mul_i32 s10, s90, 221184
    s_add_u32 s84, s10, s8
    s_add_u32 s90, s90, 1
    s_cmp_ge_u32 s90, 10
    s_cselect_b32 s90, 0, s90
    s_lshl_b32 s10, s90, 7
    s_add_u32 s69, s10, s6
    s_mul_i32 s10, s90, 221184
    s_add_u32 s85, s10, s8
    s_add_u32 s90, s90, 1
    s_cmp_ge_u32 s90, 10
    s_cselect_b32 s90, 0, s90
    s_lshl_b32 s10, s90, 7
    s_add_u32 s70, s10, s6
    s_mul_i32 s10, s90, 221184
    s_add_u32 s86, s10, s8
    s_add_u32 s90, s90, 1
    s_cmp_ge_u32 s90, 10
    s_cselect_b32 s90, 0, s90
    s_lshl_b32 s10, s90, 7
    s_add_u32 s71, s10, s6
    s_mul_i32 s10, s90, 221184
    s_add_u32 s87, s10, s8
    s_add_u32 s90, s90, 1
    s_cmp_ge_u32 s90, 10
    s_cselect_b32 s90, 0, s90
    s_lshl_b32 s10, s90, 7
    s_add_u32 s72, s10, s6
    s_mul_i32 s10, s90, 221184
    s_add_u32 s88, s10, s8
    s_add_u32 s90, s90, 1
    s_cmp_ge_u32 s90, 10
    s_cselect_b32 s90, 0, s90
    s_lshl_b32 s10, s90, 7
    s_add_u32 s73, s10, s6
    s_mul_i32 s10, s90, 221184
    s_add_u32 s89, s10, s8
    s_add_u32 s90, s90, 1
    s_cmp_ge_u32 s90, 10
    s_cselect_b32 s90, 0, s90
    v_lshrrev_b32 v2, 5, v0
    v_lshlrev_b32 v3, 3, v2
    s_and_b32 s10, s3, 1
    s_lshl_b32 s10, s10, 7
    s_add_u32 s10, s10, s5
    buffer_load_dwordx2 v[192:193], v3, s[56:59], s10 offen offset:0
    buffer_load_dwordx2 v[194:195], v3, s[56:59], s10 offen offset:16
    buffer_load_dwordx2 v[196:197], v3, s[56:59], s10 offen offset:32
    buffer_load_dwordx2 v[198:199], v3, s[56:59], s10 offen offset:48
    buffer_load_dwordx2 v[200:201], v3, s[56:59], s10 offen offset:64
    buffer_load_dwordx2 v[202:203], v3, s[56:59], s10 offen offset:80
    buffer_load_dwordx2 v[204:205], v3, s[56:59], s10 offen offset:96
    buffer_load_dwordx2 v[206:207], v3, s[56:59], s10 offen offset:112
    v_lshrrev_b32 v1, 4, v0
    v_bfe_u32 v4, v0, 2, 2
    v_lshrrev_b32 v5, 1, v1
    v_lshl_add_u32 v5, v5, 3, v4
    v_lshlrev_b32 v5, 8, v5
    v_and_b32 v6, 3, v0
    v_lshl_add_u32 v5, v6, 3, v5
    v_and_b32 v6, 1, v1
    v_lshl_add_u32 v5, v6, 5, v5
    v_add_u32 v5, 49152, v5
    s_and_b32 s10, s3, 1
    s_lshl_b32 s10, s10, 1
    s_add_u32 s11, s10, 0
    v_xor_b32 v6, s11, v4
    v_lshl_add_u32 v8, v6, 6, v5
    s_add_u32 s11, s10, 1
    v_xor_b32 v6, s11, v4
    v_lshl_add_u32 v9, v6, 6, v5
    v_and_b32 v4, 31, v0
    v_bfe_u32 v5, v0, 1, 3
    v_xor_b32 v5, v5, v2
    v_lshlrev_b32 v5, 4, v5
    v_lshl_add_u32 v5, v4, 7, v5
    s_lshr_b32 s10, s3, 1
    s_lshl_b32 s10, s10, 13
    v_add_u32 v10, s10, v5
    v_xor_b32 v11, 32, v10
    v_xor_b32 v12, 64, v10
    v_xor_b32 v13, 96, v10
    v_mov_b32 v64, 0
    v_mov_b32 v65, 0
    v_mov_b32 v66, 0
    v_mov_b32 v67, 0
    v_mov_b32 v68, 0
    v_mov_b32 v69, 0
    v_mov_b32 v70, 0
    v_mov_b32 v71, 0
    v_mov_b32 v72, 0
    v_mov_b32 v73, 0
    v_mov_b32 v74, 0
    v_mov_b32 v75, 0
    v_mov_b32 v76, 0
    v_mov_b32 v77, 0
    v_mov_b32 v78, 0
    v_mov_b32 v79, 0
    v_mov_b32 v80, 0
    v_mov_b32 v81, 0
    v_mov_b32 v82, 0
    v_mov_b32 v83, 0
    v_mov_b32 v84, 0
    v_mov_b32 v85, 0
    v_mov_b32 v86, 0
    v_mov_b32 v87, 0
    v_mov_b32 v88, 0
    v_mov_b32 v89, 0
    v_mov_b32 v90, 0
    v_mov_b32 v91, 0
    v_mov_b32 v92, 0
    v_mov_b32 v93, 0
    v_mov_b32 v94, 0
    v_mov_b32 v95, 0
    v_mov_b32 v96, 0
    v_mov_b32 v97, 0
    v_mov_b32 v98, 0
    v_mov_b32 v99, 0
    v_mov_b32 v100, 0
    v_mov_b32 v101, 0
    v_mov_b32 v102, 0
    v_mov_b32 v103, 0
    v_mov_b32 v104, 0
    v_mov_b32 v105, 0
    v_mov_b32 v106, 0
    v_mov_b32 v107, 0
    v_mov_b32 v108, 0
    v_mov_b32 v109, 0
    v_mov_b32 v110, 0
    v_mov_b32 v111, 0
    v_mov_b32 v112, 0
    v_mov_b32 v113, 0
    v_mov_b32 v114, 0
    v_mov_b32 v115, 0
    v_mov_b32 v116, 0
    v_mov_b32 v117, 0
    v_mov_b32 v118, 0
    v_mov_b32 v119, 0
    v_mov_b32 v120, 0
    v_mov_b32 v121, 0
    v_mov_b32 v122, 0
    v_mov_b32 v123, 0
    v_mov_b32 v124, 0
    v_mov_b32 v125, 0
    v_mov_b32 v126, 0
    v_mov_b32 v127, 0
    s_waitcnt vmcnt(10)
    s_barrier
    ds_read_b128 v[144:147], v10 offset:0
    ds_read_b128 v[148:151], v10 offset:4096
    ds_read_b64_tr_b16 v[128:129], v8 offset:0
    ds_read_b64_tr_b16 v[130:131], v8 offset:1024
    ds_read_b64_tr_b16 v[132:133], v9 offset:0
    ds_read_b64_tr_b16 v[134:135], v9 offset:1024
    ds_read_b128 v[152:155], v11 offset:0
    ds_read_b128 v[156:159], v11 offset:4096
    ds_read_b64_tr_b16 v[136:137], v8 offset:4096
    ds_read_b64_tr_b16 v[138:139], v8 offset:5120
    ds_read_b64_tr_b16 v[140:141], v9 offset:4096
    ds_read_b64_tr_b16 v[142:143], v9 offset:5120
    s_waitcnt vmcnt(8)
    s_waitcnt lgkmcnt(0)
    s_barrier
    v_mfma_f32_32x32x16_bf16 v[64:79], v[128:131], v[144:147], v[64:79]
    ds_read_b128 v[176:179], v12 offset:0
    ds_read_b128 v[180:183], v12 offset:4096
    ds_read_b64_tr_b16 v[160:161], v8 offset:8192
    ds_read_b64_tr_b16 v[162:163], v8 offset:9216
    v_mfma_f32_32x32x16_bf16 v[80:95], v[128:131], v[148:151], v[80:95]
    s_add_u32 m0, s9, 16384
    ds_read_b64_tr_b16 v[164:165], v9 offset:8192
    ds_read_b64_tr_b16 v[166:167], v9 offset:9216
    ds_read_b128 v[184:187], v13 offset:0
    v_mfma_f32_32x32x16_bf16 v[96:111], v[132:135], v[144:147], v[96:111]
    ds_read_b128 v[188:191], v13 offset:4096
    ds_read_b64_tr_b16 v[168:169], v8 offset:12288
    ds_read_b64_tr_b16 v[170:171], v8 offset:13312
    ds_read_b64_tr_b16 v[172:173], v9 offset:12288
    v_mfma_f32_32x32x16_bf16 v[112:127], v[132:135], v[148:151], v[112:127]
    buffer_load_dwordx4 v18, s[52:55], s81 offen offset:0 lds
    ds_read_b64_tr_b16 v[174:175], v9 offset:13312
    v_mfma_f32_32x32x16_bf16 v[64:79], v[136:139], v[152:155], v[64:79]
    buffer_load_dwordx4 v19, s[52:55], s81 offen offset:1024 lds
    v_mfma_f32_32x32x16_bf16 v[80:95], v[136:139], v[156:159], v[80:95]
    s_add_u32 m0, s7, 16384
    s_nop 0
    buffer_load_dwordx4 v14, s[48:51], s65 offen offset:0 lds
    v_mfma_f32_32x32x16_bf16 v[96:111], v[140:143], v[152:155], v[96:111]
    buffer_load_dwordx4 v15, s[48:51], s65 offen offset:1024 lds
    v_mfma_f32_32x32x16_bf16 v[112:127], v[140:143], v[156:159], v[112:127]
    buffer_load_dwordx4 v16, s[48:51], s65 offen offset:2048 lds
    buffer_load_dwordx4 v17, s[48:51], s65 offen offset:3072 lds
    s_waitcnt vmcnt(0)
    s_waitcnt lgkmcnt(0)
    s_barrier
    v_mfma_f32_32x32x16_bf16 v[64:79], v[160:163], v[176:179], v[64:79]
    ds_read_b128 v[144:147], v10 offset:16384
    ds_read_b128 v[148:151], v10 offset:20480
    ds_read_b64_tr_b16 v[128:129], v8 offset:16384
    ds_read_b64_tr_b16 v[130:131], v8 offset:17408
    v_mfma_f32_32x32x16_bf16 v[80:95], v[160:163], v[180:183], v[80:95]
    s_add_u32 m0, s9, 24576
    ds_read_b64_tr_b16 v[132:133], v9 offset:16384
    ds_read_b64_tr_b16 v[134:135], v9 offset:17408
    ds_read_b128 v[152:155], v11 offset:16384
    v_mfma_f32_32x32x16_bf16 v[96:111], v[164:167], v[176:179], v[96:111]
    ds_read_b128 v[156:159], v11 offset:20480
    ds_read_b64_tr_b16 v[136:137], v8 offset:20480
    ds_read_b64_tr_b16 v[138:139], v8 offset:21504
    ds_read_b64_tr_b16 v[140:141], v9 offset:20480
    v_mfma_f32_32x32x16_bf16 v[112:127], v[164:167], v[180:183], v[112:127]
    buffer_load_dwordx4 v20, s[52:55], s81 offen offset:0 lds
    ds_read_b64_tr_b16 v[142:143], v9 offset:21504
    v_mfma_f32_32x32x16_bf16 v[64:79], v[168:171], v[184:187], v[64:79]
    buffer_load_dwordx4 v21, s[52:55], s81 offen offset:1024 lds
    v_mfma_f32_32x32x16_bf16 v[80:95], v[168:171], v[188:191], v[80:95]
    s_add_u32 m0, s7, 32768
    s_nop 0
    buffer_load_dwordx4 v14, s[48:51], s66 offen offset:0 lds
    v_mfma_f32_32x32x16_bf16 v[96:111], v[172:175], v[184:187], v[96:111]
    buffer_load_dwordx4 v15, s[48:51], s66 offen offset:1024 lds
    v_mfma_f32_32x32x16_bf16 v[112:127], v[172:175], v[188:191], v[112:127]
    buffer_load_dwordx4 v16, s[48:51], s66 offen offset:2048 lds
    buffer_load_dwordx4 v17, s[48:51], s66 offen offset:3072 lds
    s_add_u32 m0, s9, 0
    s_nop 0
    buffer_load_dwordx4 v18, s[52:55], s82 offen offset:0 lds
    buffer_load_dwordx4 v19, s[52:55], s82 offen offset:1024 lds
    s_waitcnt vmcnt(6)
    s_waitcnt lgkmcnt(0)
    s_barrier
    v_mfma_f32_32x32x16_bf16 v[64:79], v[128:131], v[144:147], v[64:79]
    ds_read_b128 v[176:179], v12 offset:16384
    ds_read_b128 v[180:183], v12 offset:20480
    ds_read_b64_tr_b16 v[160:161], v8 offset:24576
    ds_read_b64_tr_b16 v[162:163], v8 offset:25600
    v_mfma_f32_32x32x16_bf16 v[80:95], v[128:131], v[148:151], v[80:95]
    s_add_u32 m0, s9, 8192
    ds_read_b64_tr_b16 v[164:165], v9 offset:24576
    ds_read_b64_tr_b16 v[166:167], v9 offset:25600
    ds_read_b128 v[184:187], v13 offset:16384
    v_mfma_f32_32x32x16_bf16 v[96:111], v[132:135], v[144:147], v[96:111]
    ds_read_b128 v[188:191], v13 offset:20480
    ds_read_b64_tr_b16 v[168:169], v8 offset:28672
    ds_read_b64_tr_b16 v[170:171], v8 offset:29696
    ds_read_b64_tr_b16 v[172:173], v9 offset:28672
    v_mfma_f32_32x32x16_bf16 v[112:127], v[132:135], v[148:151], v[112:127]
    buffer_load_dwordx4 v20, s[52:55], s82 offen offset:0 lds
    ds_read_b64_tr_b16 v[174:175], v9 offset:29696
    v_mfma_f32_32x32x16_bf16 v[64:79], v[136:139], v[152:155], v[64:79]
    buffer_load_dwordx4 v21, s[52:55], s82 offen offset:1024 lds
    v_mfma_f32_32x32x16_bf16 v[80:95], v[136:139], v[156:159], v[80:95]
    s_add_u32 m0, s7, 0
    s_nop 0
    buffer_load_dwordx4 v14, s[48:51], s67 offen offset:0 lds
    v_mfma_f32_32x32x16_bf16 v[96:111], v[140:143], v[152:155], v[96:111]
    buffer_load_dwordx4 v15, s[48:51], s67 offen offset:1024 lds
    v_mfma_f32_32x32x16_bf16 v[112:127], v[140:143], v[156:159], v[112:127]
    buffer_load_dwordx4 v16, s[48:51], s67 offen offset:2048 lds
    buffer_load_dwordx4 v17, s[48:51], s67 offen offset:3072 lds
    s_add_u32 m0, s9, 16384
    s_nop 0
    buffer_load_dwordx4 v18, s[52:55], s83 offen offset:0 lds
    buffer_load_dwordx4 v19, s[52:55], s83 offen offset:1024 lds
    s_waitcnt vmcnt(8)
    s_waitcnt lgkmcnt(0)
    s_barrier
    v_mfma_f32_32x32x16_bf16 v[64:79], v[160:163], v[176:179], v[64:79]
    ds_read_b128 v[144:147], v10 offset:32768
    ds_read_b128 v[148:151], v10 offset:36864
    ds_read_b64_tr_b16 v[128:129], v8 offset:0
    ds_read_b64_tr_b16 v[130:131], v8 offset:1024
    v_mfma_f32_32x32x16_bf16 v[80:95], v[160:163], v[180:183], v[80:95]
    s_add_u32 m0, s9, 24576
    ds_read_b64_tr_b16 v[132:133], v9 offset:0
    ds_read_b64_tr_b16 v[134:135], v9 offset:1024
    ds_read_b128 v[152:155], v11 offset:32768
    v_mfma_f32_32x32x16_bf16 v[96:111], v[164:167], v[176:179], v[96:111]
    ds_read_b128 v[156:159], v11 offset:36864
    ds_read_b64_tr_b16 v[136:137], v8 offset:4096
    ds_read_b64_tr_b16 v[138:139], v8 offset:5120
    ds_read_b64_tr_b16 v[140:141], v9 offset:4096
    v_mfma_f32_32x32x16_bf16 v[112:127], v[164:167], v[180:183], v[112:127]
    buffer_load_dwordx4 v20, s[52:55], s83 offen offset:0 lds
    ds_read_b64_tr_b16 v[142:143], v9 offset:5120
    v_mfma_f32_32x32x16_bf16 v[64:79], v[168:171], v[184:187], v[64:79]
    buffer_load_dwordx4 v21, s[52:55], s83 offen offset:1024 lds
    v_mfma_f32_32x32x16_bf16 v[80:95], v[168:171], v[188:191], v[80:95]
    s_add_u32 m0, s7, 16384
    s_nop 0
    buffer_load_dwordx4 v14, s[48:51], s68 offen offset:0 lds
    v_mfma_f32_32x32x16_bf16 v[96:111], v[172:175], v[184:187], v[96:111]
    buffer_load_dwordx4 v15, s[48:51], s68 offen offset:1024 lds
    v_mfma_f32_32x32x16_bf16 v[112:127], v[172:175], v[188:191], v[112:127]
    buffer_load_dwordx4 v16, s[48:51], s68 offen offset:2048 lds
    buffer_load_dwordx4 v17, s[48:51], s68 offen offset:3072 lds
    s_waitcnt vmcnt(12)
    s_waitcnt lgkmcnt(0)
    s_barrier
    v_mfma_f32_32x32x16_bf16 v[64:79], v[128:131], v[144:147], v[64:79]
    ds_read_b128 v[176:179], v12 offset:32768
    ds_read_b128 v[180:183], v12 offset:36864
    ds_read_b64_tr_b16 v[160:161], v8 offset:8192
    ds_read_b64_tr_b16 v[162:163], v8 offset:9216
    v_mfma_f32_32x32x16_bf16 v[80:95], v[128:131], v[148:151], v[80:95]
    s_add_u32 m0, s9, 0
    ds_read_b64_tr_b16 v[164:165], v9 offset:8192
    ds_read_b64_tr_b16 v[166:167], v9 offset:9216
    ds_read_b128 v[184:187], v13 offset:32768
    v_mfma_f32_32x32x16_bf16 v[96:111], v[132:135], v[144:147], v[96:111]
    ds_read_b128 v[188:191], v13 offset:36864
    ds_read_b64_tr_b16 v[168:169], v8 offset:12288
    ds_read_b64_tr_b16 v[170:171], v8 offset:13312
    ds_read_b64_tr_b16 v[172:173], v9 offset:12288
    v_mfma_f32_32x32x16_bf16 v[112:127], v[132:135], v[148:151], v[112:127]
    buffer_load_dwordx4 v18, s[52:55], s84 offen offset:0 lds
    ds_read_b64_tr_b16 v[174:175], v9 offset:13312
    v_mfma_f32_32x32x16_bf16 v[64:79], v[136:139], v[152:155], v[64:79]
    buffer_load_dwordx4 v19, s[52:55], s84 offen offset:1024 lds
    v_mfma_f32_32x32x16_bf16 v[80:95], v[136:139], v[156:159], v[80:95]
    v_mfma_f32_32x32x16_bf16 v[96:111], v[140:143], v[152:155], v[96:111]
    v_mfma_f32_32x32x16_bf16 v[112:127], v[140:143], v[156:159], v[112:127]
    s_waitcnt vmcnt(8)
    s_waitcnt lgkmcnt(0)
    s_barrier
    v_mfma_f32_32x32x16_bf16 v[64:79], v[160:163], v[176:179], v[64:79]
    ds_read_b128 v[144:147], v10 offset:0
    ds_read_b128 v[148:151], v10 offset:4096
    ds_read_b64_tr_b16 v[128:129], v8 offset:16384
    ds_read_b64_tr_b16 v[130:131], v8 offset:17408
    v_mfma_f32_32x32x16_bf16 v[80:95], v[160:163], v[180:183], v[80:95]
    s_add_u32 m0, s9, 8192
    ds_read_b64_tr_b16 v[132:133], v9 offset:16384
    ds_read_b64_tr_b16 v[134:135], v9 offset:17408
    ds_read_b128 v[152:155], v11 offset:0
    v_mfma_f32_32x32x16_bf16 v[96:111], v[164:167], v[176:179], v[96:111]
    ds_read_b128 v[156:159], v11 offset:4096
    ds_read_b64_tr_b16 v[136:137], v8 offset:20480
    ds_read_b64_tr_b16 v[138:139], v8 offset:21504
    ds_read_b64_tr_b16 v[140:141], v9 offset:20480
    v_mfma_f32_32x32x16_bf16 v[112:127], v[164:167], v[180:183], v[112:127]
    buffer_load_dwordx4 v20, s[52:55], s84 offen offset:0 lds
    ds_read_b64_tr_b16 v[142:143], v9 offset:21504
    v_mfma_f32_32x32x16_bf16 v[64:79], v[168:171], v[184:187], v[64:79]
    buffer_load_dwordx4 v21, s[52:55], s84 offen offset:1024 lds
    v_mfma_f32_32x32x16_bf16 v[80:95], v[168:171], v[188:191], v[80:95]
    s_add_u32 m0, s7, 32768
    s_nop 0
    buffer_load_dwordx4 v14, s[48:51], s69 offen offset:0 lds
    v_mfma_f32_32x32x16_bf16 v[96:111], v[172:175], v[184:187], v[96:111]
    buffer_load_dwordx4 v15, s[48:51], s69 offen offset:1024 lds
    v_mfma_f32_32x32x16_bf16 v[112:127], v[172:175], v[188:191], v[112:127]
    buffer_load_dwordx4 v16, s[48:51], s69 offen offset:2048 lds
    buffer_load_dwordx4 v17, s[48:51], s69 offen offset:3072 lds
    s_waitcnt vmcnt(12)
    s_waitcnt lgkmcnt(0)
    s_barrier
    v_mfma_f32_32x32x16_bf16 v[64:79], v[128:131], v[144:147], v[64:79]
    ds_read_b128 v[176:179], v12 offset:0
    ds_read_b128 v[180:183], v12 offset:4096
    ds_read_b64_tr_b16 v[160:161], v8 offset:24576
    ds_read_b64_tr_b16 v[162:163], v8 offset:25600
    v_mfma_f32_32x32x16_bf16 v[80:95], v[128:131], v[148:151], v[80:95]
    s_add_u32 m0, s9, 16384
    ds_read_b64_tr_b16 v[164:165], v9 offset:24576
    ds_read_b64_tr_b16 v[166:167], v9 offset:25600
    ds_read_b128 v[184:187], v13 offset:0
    v_mfma_f32_32x32x16_bf16 v[96:111], v[132:135], v[144:147], v[96:111]
    ds_read_b128 v[188:191], v13 offset:4096
    ds_read_b64_tr_b16 v[168:169], v8 offset:28672
    ds_read_b64_tr_b16 v[170:171], v8 offset:29696
    ds_read_b64_tr_b16 v[172:173], v9 offset:28672
    v_mfma_f32_32x32x16_bf16 v[112:127], v[132:135], v[148:151], v[112:127]
    buffer_load_dwordx4 v18, s[52:55], s85 offen offset:0 lds
    ds_read_b64_tr_b16 v[174:175], v9 offset:29696
    v_mfma_f32_32x32x16_bf16 v[64:79], v[136:139], v[152:155], v[64:79]
    buffer_load_dwordx4 v19, s[52:55], s85 offen offset:1024 lds
    v_mfma_f32_32x32x16_bf16 v[80:95], v[136:139], v[156:159], v[80:95]
    v_mfma_f32_32x32x16_bf16 v[96:111], v[140:143], v[152:155], v[96:111]
    v_mfma_f32_32x32x16_bf16 v[112:127], v[140:143], v[156:159], v[112:127]
    s_waitcnt vmcnt(8)
    s_waitcnt lgkmcnt(0)
    s_barrier
    v_mfma_f32_32x32x16_bf16 v[64:79], v[160:163], v[176:179], v[64:79]
    ds_read_b128 v[144:147], v10 offset:16384
    ds_read_b128 v[148:151], v10 offset:20480
    ds_read_b64_tr_b16 v[128:129], v8 offset:0
    ds_read_b64_tr_b16 v[130:131], v8 offset:1024
    v_mfma_f32_32x32x16_bf16 v[80:95], v[160:163], v[180:183], v[80:95]
    s_add_u32 m0, s9, 24576
    ds_read_b64_tr_b16 v[132:133], v9 offset:0
    ds_read_b64_tr_b16 v[134:135], v9 offset:1024
    ds_read_b128 v[152:155], v11 offset:16384
    v_mfma_f32_32x32x16_bf16 v[96:111], v[164:167], v[176:179], v[96:111]
    ds_read_b128 v[156:159], v11 offset:20480
    ds_read_b64_tr_b16 v[136:137], v8 offset:4096
    ds_read_b64_tr_b16 v[138:139], v8 offset:5120
    ds_read_b64_tr_b16 v[140:141], v9 offset:4096
    v_mfma_f32_32x32x16_bf16 v[112:127], v[164:167], v[180:183], v[112:127]
    buffer_load_dwordx4 v20, s[52:55], s85 offen offset:0 lds
    ds_read_b64_tr_b16 v[142:143], v9 offset:5120
    v_mfma_f32_32x32x16_bf16 v[64:79], v[168:171], v[184:187], v[64:79]
    buffer_load_dwordx4 v21, s[52:55], s85 offen offset:1024 lds
    v_mfma_f32_32x32x16_bf16 v[80:95], v[168:171], v[188:191], v[80:95]
    s_add_u32 m0, s7, 0
    s_nop 0
    buffer_load_dwordx4 v14, s[48:51], s70 offen offset:0 lds
    v_mfma_f32_32x32x16_bf16 v[96:111], v[172:175], v[184:187], v[96:111]
    buffer_load_dwordx4 v15, s[48:51], s70 offen offset:1024 lds
    v_mfma_f32_32x32x16_bf16 v[112:127], v[172:175], v[188:191], v[112:127]
    buffer_load_dwordx4 v16, s[48:51], s70 offen offset:2048 lds
    buffer_load_dwordx4 v17, s[48:51], s70 offen offset:3072 lds
    s_waitcnt vmcnt(12)
    s_waitcnt lgkmcnt(0)
    s_barrier
    v_mfma_f32_32x32x16_bf16 v[64:79], v[128:131], v[144:147], v[64:79]
    ds_read_b128 v[176:179], v12 offset:16384
    ds_read_b128 v[180:183], v12 offset:20480
    ds_read_b64_tr_b16 v[160:161], v8 offset:8192
    ds_read_b64_tr_b16 v[162:163], v8 offset:9216
    v_mfma_f32_32x32x16_bf16 v[80:95], v[128:131], v[148:151], v[80:95]
    s_add_u32 m0, s9, 0
    ds_read_b64_tr_b16 v[164:165], v9 offset:8192
    ds_read_b64_tr_b16 v[166:167], v9 offset:9216
    ds_read_b128 v[184:187], v13 offset:16384
    v_mfma_f32_32x32x16_bf16 v[96:111], v[132:135], v[144:147], v[96:111]
    ds_read_b128 v[188:191], v13 offset:20480
    ds_read_b64_tr_b16 v[168:169], v8 offset:12288
    ds_read_b64_tr_b16 v[170:171], v8 offset:13312
    ds_read_b64_tr_b16 v[172:173], v9 offset:12288
    v_mfma_f32_32x32x16_bf16 v[112:127], v[132:135], v[148:151], v[112:127]
    buffer_load_dwordx4 v18, s[52:55], s86 offen offset:0 lds
    ds_read_b64_tr_b16 v[174:175], v9 offset:13312
    v_mfma_f32_32x32x16_bf16 v[64:79], v[136:139], v[152:155], v[64:79]
    buffer_load_dwordx4 v19, s[52:55], s86 offen offset:1024 lds
    v_mfma_f32_32x32x16_bf16 v[80:95], v[136:139], v[156:159], v[80:95]
    v_mfma_f32_32x32x16_bf16 v[96:111], v[140:143], v[152:155], v[96:111]
    v_mfma_f32_32x32x16_bf16 v[112:127], v[140:143], v[156:159], v[112:127]
    s_waitcnt vmcnt(8)
    s_waitcnt lgkmcnt(0)
    s_barrier
    v_mfma_f32_32x32x16_bf16 v[64:79], v[160:163], v[176:179], v[64:79]
    ds_read_b128 v[144:147], v10 offset:32768
    ds_read_b128 v[148:151], v10 offset:36864
    ds_read_b64_tr_b16 v[128:129], v8 offset:16384
    ds_read_b64_tr_b16 v[130:131], v8 offset:17408
    v_mfma_f32_32x32x16_bf16 v[80:95], v[160:163], v[180:183], v[80:95]
    s_add_u32 m0, s9, 8192
    ds_read_b64_tr_b16 v[132:133], v9 offset:16384
    ds_read_b64_tr_b16 v[134:135], v9 offset:17408
    ds_read_b128 v[152:155], v11 offset:32768
    v_mfma_f32_32x32x16_bf16 v[96:111], v[164:167], v[176:179], v[96:111]
    ds_read_b128 v[156:159], v11 offset:36864
    ds_read_b64_tr_b16 v[136:137], v8 offset:20480
    ds_read_b64_tr_b16 v[138:139], v8 offset:21504
    ds_read_b64_tr_b16 v[140:141], v9 offset:20480
    v_mfma_f32_32x32x16_bf16 v[112:127], v[164:167], v[180:183], v[112:127]
    buffer_load_dwordx4 v20, s[52:55], s86 offen offset:0 lds
    ds_read_b64_tr_b16 v[142:143], v9 offset:21504
    v_mfma_f32_32x32x16_bf16 v[64:79], v[168:171], v[184:187], v[64:79]
    buffer_load_dwordx4 v21, s[52:55], s86 offen offset:1024 lds
    v_mfma_f32_32x32x16_bf16 v[80:95], v[168:171], v[188:191], v[80:95]
    s_add_u32 m0, s7, 16384
    s_nop 0
    buffer_load_dwordx4 v14, s[48:51], s71 offen offset:0 lds
    v_mfma_f32_32x32x16_bf16 v[96:111], v[172:175], v[184:187], v[96:111]
    buffer_load_dwordx4 v15, s[48:51], s71 offen offset:1024 lds
    v_mfma_f32_32x32x16_bf16 v[112:127], v[172:175], v[188:191], v[112:127]
    buffer_load_dwordx4 v16, s[48:51], s71 offen offset:2048 lds
    buffer_load_dwordx4 v17, s[48:51], s71 offen offset:3072 lds
    s_waitcnt vmcnt(12)
    s_waitcnt lgkmcnt(0)
    s_barrier
    v_mfma_f32_32x32x16_bf16 v[64:79], v[128:131], v[144:147], v[64:79]
    ds_read_b128 v[176:179], v12 offset:32768
    ds_read_b128 v[180:183], v12 offset:36864
    ds_read_b64_tr_b16 v[160:161], v8 offset:24576
    ds_read_b64_tr_b16 v[162:163], v8 offset:25600
    v_mfma_f32_32x32x16_bf16 v[80:95], v[128:131], v[148:151], v[80:95]
    s_add_u32 m0, s9, 16384
    ds_read_b64_tr_b16 v[164:165], v9 offset:24576
    ds_read_b64_tr_b16 v[166:167], v9 offset:25600
    ds_read_b128 v[184:187], v13 offset:32768
    v_mfma_f32_32x32x16_bf16 v[96:111], v[132:135], v[144:147], v[96:111]
    ds_read_b128 v[188:191], v13 offset:36864
    ds_read_b64_tr_b16 v[168:169], v8 offset:28672
    ds_read_b64_tr_b16 v[170:171], v8 offset:29696
    ds_read_b64_tr_b16 v[172:173], v9 offset:28672
    v_mfma_f32_32x32x16_bf16 v[112:127], v[132:135], v[148:151], v[112:127]
    buffer_load_dwordx4 v18, s[52:55], s87 offen offset:0 lds
    ds_read_b64_tr_b16 v[174:175], v9 offset:29696
    v_mfma_f32_32x32x16_bf16 v[64:79], v[136:139], v[152:155], v[64:79]
    buffer_load_dwordx4 v19, s[52:55], s87 offen offset:1024 lds
    v_mfma_f32_32x32x16_bf16 v[80:95], v[136:139], v[156:159], v[80:95]
    v_mfma_f32_32x32x16_bf16 v[96:111], v[140:143], v[152:155], v[96:111]
    v_mfma_f32_32x32x16_bf16 v[112:127], v[140:143], v[156:159], v[112:127]
    s_waitcnt vmcnt(8)
    s_waitcnt lgkmcnt(0)
    s_barrier
    v_mfma_f32_32x32x16_bf16 v[64:79], v[160:163], v[176:179], v[64:79]
    ds_read_b128 v[144:147], v10 offset:0
    ds_read_b128 v[148:151], v10 offset:4096
    ds_read_b64_tr_b16 v[128:129], v8 offset:0
    ds_read_b64_tr_b16 v[130:131], v8 offset:1024
    v_mfma_f32_32x32x16_bf16 v[80:95], v[160:163], v[180:183], v[80:95]
    s_add_u32 m0, s9, 24576
    ds_read_b64_tr_b16 v[132:133], v9 offset:0
    ds_read_b64_tr_b16 v[134:135], v9 offset:1024
    ds_read_b128 v[152:155], v11 offset:0
    v_mfma_f32_32x32x16_bf16 v[96:111], v[164:167], v[176:179], v[96:111]
    ds_read_b128 v[156:159], v11 offset:4096
    ds_read_b64_tr_b16 v[136:137], v8 offset:4096
    ds_read_b64_tr_b16 v[138:139], v8 offset:5120
    ds_read_b64_tr_b16 v[140:141], v9 offset:4096
    v_mfma_f32_32x32x16_bf16 v[112:127], v[164:167], v[180:183], v[112:127]
    buffer_load_dwordx4 v20, s[52:55], s87 offen offset:0 lds
    ds_read_b64_tr_b16 v[142:143], v9 offset:5120
    v_mfma_f32_32x32x16_bf16 v[64:79], v[168:171], v[184:187], v[64:79]
    buffer_load_dwordx4 v21, s[52:55], s87 offen offset:1024 lds
    v_mfma_f32_32x32x16_bf16 v[80:95], v[168:171], v[188:191], v[80:95]
    s_add_u32 m0, s7, 32768
    s_nop 0
    buffer_load_dwordx4 v14, s[48:51], s72 offen offset:0 lds
    v_mfma_f32_32x32x16_bf16 v[96:111], v[172:175], v[184:187], v[96:111]
    buffer_load_dwordx4 v15, s[48:51], s72 offen offset:1024 lds
    v_mfma_f32_32x32x16_bf16 v[112:127], v[172:175], v[188:191], v[112:127]
    buffer_load_dwordx4 v16, s[48:51], s72 offen offset:2048 lds
    buffer_load_dwordx4 v17, s[48:51], s72 offen offset:3072 lds
    s_waitcnt vmcnt(12)
    s_waitcnt lgkmcnt(0)
    s_barrier
    v_mfma_f32_32x32x16_bf16 v[64:79], v[128:131], v[144:147], v[64:79]
    ds_read_b128 v[176:179], v12 offset:0
    ds_read_b128 v[180:183], v12 offset:4096
    ds_read_b64_tr_b16 v[160:161], v8 offset:8192
    ds_read_b64_tr_b16 v[162:163], v8 offset:9216
    v_mfma_f32_32x32x16_bf16 v[80:95], v[128:131], v[148:151], v[80:95]
    s_add_u32 m0, s9, 0
    ds_read_b64_tr_b16 v[164:165], v9 offset:8192
    ds_read_b64_tr_b16 v[166:167], v9 offset:9216
    ds_read_b128 v[184:187], v13 offset:0
    v_mfma_f32_32x32x16_bf16 v[96:111], v[132:135], v[144:147], v[96:111]
    ds_read_b128 v[188:191], v13 offset:4096
    ds_read_b64_tr_b16 v[168:169], v8 offset:12288
    ds_read_b64_tr_b16 v[170:171], v8 offset:13312
    ds_read_b64_tr_b16 v[172:173], v9 offset:12288
    v_mfma_f32_32x32x16_bf16 v[112:127], v[132:135], v[148:151], v[112:127]
    buffer_load_dwordx4 v18, s[52:55], s88 offen offset:0 lds
    ds_read_b64_tr_b16 v[174:175], v9 offset:13312
    v_mfma_f32_32x32x16_bf16 v[64:79], v[136:139], v[152:155], v[64:79]
    buffer_load_dwordx4 v19, s[52:55], s88 offen offset:1024 lds
    v_mfma_f32_32x32x16_bf16 v[80:95], v[136:139], v[156:159], v[80:95]
    v_mfma_f32_32x32x16_bf16 v[96:111], v[140:143], v[152:155], v[96:111]
    v_mfma_f32_32x32x16_bf16 v[112:127], v[140:143], v[156:159], v[112:127]
    s_waitcnt vmcnt(8)
    s_waitcnt lgkmcnt(0)
    s_barrier
    v_mfma_f32_32x32x16_bf16 v[64:79], v[160:163], v[176:179], v[64:79]
    ds_read_b128 v[144:147], v10 offset:16384
    ds_read_b128 v[148:151], v10 offset:20480
    ds_read_b64_tr_b16 v[128:129], v8 offset:16384
    ds_read_b64_tr_b16 v[130:131], v8 offset:17408
    v_mfma_f32_32x32x16_bf16 v[80:95], v[160:163], v[180:183], v[80:95]
    s_add_u32 m0, s9, 8192
    ds_read_b64_tr_b16 v[132:133], v9 offset:16384
    ds_read_b64_tr_b16 v[134:135], v9 offset:17408
    ds_read_b128 v[152:155], v11 offset:16384
    v_mfma_f32_32x32x16_bf16 v[96:111], v[164:167], v[176:179], v[96:111]
    ds_read_b128 v[156:159], v11 offset:20480
    ds_read_b64_tr_b16 v[136:137], v8 offset:20480
    ds_read_b64_tr_b16 v[138:139], v8 offset:21504
    ds_read_b64_tr_b16 v[140:141], v9 offset:20480
    v_mfma_f32_32x32x16_bf16 v[112:127], v[164:167], v[180:183], v[112:127]
    buffer_load_dwordx4 v20, s[52:55], s88 offen offset:0 lds
    ds_read_b64_tr_b16 v[142:143], v9 offset:21504
    v_mfma_f32_32x32x16_bf16 v[64:79], v[168:171], v[184:187], v[64:79]
    buffer_load_dwordx4 v21, s[52:55], s88 offen offset:1024 lds
    v_mfma_f32_32x32x16_bf16 v[80:95], v[168:171], v[188:191], v[80:95]
    s_add_u32 m0, s7, 0
    s_nop 0
    buffer_load_dwordx4 v14, s[48:51], s73 offen offset:0 lds
    v_mfma_f32_32x32x16_bf16 v[96:111], v[172:175], v[184:187], v[96:111]
    buffer_load_dwordx4 v15, s[48:51], s73 offen offset:1024 lds
    v_mfma_f32_32x32x16_bf16 v[112:127], v[172:175], v[188:191], v[112:127]
    buffer_load_dwordx4 v16, s[48:51], s73 offen offset:2048 lds
    buffer_load_dwordx4 v17, s[48:51], s73 offen offset:3072 lds
    s_waitcnt vmcnt(12)
    s_waitcnt lgkmcnt(0)
    s_barrier
    v_mfma_f32_32x32x16_bf16 v[64:79], v[128:131], v[144:147], v[64:79]
    ds_read_b128 v[176:179], v12 offset:16384
    ds_read_b128 v[180:183], v12 offset:20480
    ds_read_b64_tr_b16 v[160:161], v8 offset:24576
    ds_read_b64_tr_b16 v[162:163], v8 offset:25600
    v_mfma_f32_32x32x16_bf16 v[80:95], v[128:131], v[148:151], v[80:95]
    s_add_u32 m0, s9, 16384
    ds_read_b64_tr_b16 v[164:165], v9 offset:24576
    ds_read_b64_tr_b16 v[166:167], v9 offset:25600
    ds_read_b128 v[184:187], v13 offset:16384
    v_mfma_f32_32x32x16_bf16 v[96:111], v[132:135], v[144:147], v[96:111]
    ds_read_b128 v[188:191], v13 offset:20480
    ds_read_b64_tr_b16 v[168:169], v8 offset:28672
    ds_read_b64_tr_b16 v[170:171], v8 offset:29696
    ds_read_b64_tr_b16 v[172:173], v9 offset:28672
    v_mfma_f32_32x32x16_bf16 v[112:127], v[132:135], v[148:151], v[112:127]
    buffer_load_dwordx4 v18, s[52:55], s89 offen offset:0 lds
    ds_read_b64_tr_b16 v[174:175], v9 offset:29696
    v_mfma_f32_32x32x16_bf16 v[64:79], v[136:139], v[152:155], v[64:79]
    buffer_load_dwordx4 v19, s[52:55], s89 offen offset:1024 lds
    v_mfma_f32_32x32x16_bf16 v[80:95], v[136:139], v[156:159], v[80:95]
    s_add_u32 s12, s44, 0
    s_addc_u32 s13, s45, 0
    s_mov_b32 s14, 256
    v_mfma_f32_32x32x16_bf16 v[96:111], v[140:143], v[152:155], v[96:111]
    s_mov_b32 s15, 0x00020000
    v_mov_b32 v23, 0
    buffer_load_dword v22, v23, s[12:15], 0 offen sc1
    v_mfma_f32_32x32x16_bf16 v[112:127], v[140:143], v[156:159], v[112:127]
    s_waitcnt vmcnt(9)
    s_waitcnt lgkmcnt(0)
    s_barrier
    v_mfma_f32_32x32x16_bf16 v[64:79], v[160:163], v[176:179], v[64:79]
    ds_read_b128 v[144:147], v10 offset:32768
    ds_read_b128 v[148:151], v10 offset:36864
    ds_read_b64_tr_b16 v[128:129], v8 offset:0
    ds_read_b64_tr_b16 v[130:131], v8 offset:1024
    v_mfma_f32_32x32x16_bf16 v[80:95], v[160:163], v[180:183], v[80:95]
    s_add_u32 m0, s9, 24576
    ds_read_b64_tr_b16 v[132:133], v9 offset:0
    ds_read_b64_tr_b16 v[134:135], v9 offset:1024
    ds_read_b128 v[152:155], v11 offset:32768
    v_mfma_f32_32x32x16_bf16 v[96:111], v[164:167], v[176:179], v[96:111]
    ds_read_b128 v[156:159], v11 offset:36864
    ds_read_b64_tr_b16 v[136:137], v8 offset:4096
    ds_read_b64_tr_b16 v[138:139], v8 offset:5120
    ds_read_b64_tr_b16 v[140:141], v9 offset:4096
    v_mfma_f32_32x32x16_bf16 v[112:127], v[164:167], v[180:183], v[112:127]
    buffer_load_dwordx4 v20, s[52:55], s89 offen offset:0 lds
    ds_read_b64_tr_b16 v[142:143], v9 offset:5120
    v_mfma_f32_32x32x16_bf16 v[64:79], v[168:171], v[184:187], v[64:79]
    buffer_load_dwordx4 v21, s[52:55], s89 offen offset:1024 lds
    v_mfma_f32_32x32x16_bf16 v[80:95], v[168:171], v[188:191], v[80:95]
    v_mfma_f32_32x32x16_bf16 v[96:111], v[172:175], v[184:187], v[96:111]
    v_mfma_f32_32x32x16_bf16 v[112:127], v[172:175], v[188:191], v[112:127]
    s_waitcnt vmcnt(9)
    s_waitcnt lgkmcnt(0)
    s_barrier
    v_mfma_f32_32x32x16_bf16 v[64:79], v[128:131], v[144:147], v[64:79]
    ds_read_b128 v[176:179], v12 offset:32768
    ds_read_b128 v[180:183], v12 offset:36864
    ds_read_b64_tr_b16 v[160:161], v8 offset:8192
    ds_read_b64_tr_b16 v[162:163], v8 offset:9216
    v_mfma_f32_32x32x16_bf16 v[80:95], v[128:131], v[148:151], v[80:95]
    ds_read_b64_tr_b16 v[164:165], v9 offset:8192
    ds_read_b64_tr_b16 v[166:167], v9 offset:9216
    ds_read_b128 v[184:187], v13 offset:32768
    ds_read_b128 v[188:191], v13 offset:36864
    v_mfma_f32_32x32x16_bf16 v[96:111], v[132:135], v[144:147], v[96:111]
    ds_read_b64_tr_b16 v[168:169], v8 offset:12288
    ds_read_b64_tr_b16 v[170:171], v8 offset:13312
    ds_read_b64_tr_b16 v[172:173], v9 offset:12288
    ds_read_b64_tr_b16 v[174:175], v9 offset:13312
    v_mfma_f32_32x32x16_bf16 v[112:127], v[132:135], v[148:151], v[112:127]
    v_mfma_f32_32x32x16_bf16 v[64:79], v[136:139], v[152:155], v[64:79]
    v_mfma_f32_32x32x16_bf16 v[80:95], v[136:139], v[156:159], v[80:95]
    v_mfma_f32_32x32x16_bf16 v[96:111], v[140:143], v[152:155], v[96:111]
    v_mfma_f32_32x32x16_bf16 v[112:127], v[140:143], v[156:159], v[112:127]
    s_waitcnt vmcnt(3)
    s_waitcnt lgkmcnt(0)
    s_barrier
    v_mfma_f32_32x32x16_bf16 v[64:79], v[160:163], v[176:179], v[64:79]
    ds_read_b128 v[144:147], v10 offset:0
    ds_read_b128 v[148:151], v10 offset:4096
    ds_read_b64_tr_b16 v[128:129], v8 offset:16384
    ds_read_b64_tr_b16 v[130:131], v8 offset:17408
    v_mfma_f32_32x32x16_bf16 v[80:95], v[160:163], v[180:183], v[80:95]
    ds_read_b64_tr_b16 v[132:133], v9 offset:16384
    ds_read_b64_tr_b16 v[134:135], v9 offset:17408
    ds_read_b128 v[152:155], v11 offset:0
    ds_read_b128 v[156:159], v11 offset:4096
    v_mfma_f32_32x32x16_bf16 v[96:111], v[164:167], v[176:179], v[96:111]
    ds_read_b64_tr_b16 v[136:137], v8 offset:20480
    ds_read_b64_tr_b16 v[138:139], v8 offset:21504
    ds_read_b64_tr_b16 v[140:141], v9 offset:20480
    ds_read_b64_tr_b16 v[142:143], v9 offset:21504
    v_mfma_f32_32x32x16_bf16 v[112:127], v[164:167], v[180:183], v[112:127]
    v_mfma_f32_32x32x16_bf16 v[64:79], v[168:171], v[184:187], v[64:79]
    v_mfma_f32_32x32x16_bf16 v[80:95], v[168:171], v[188:191], v[80:95]
    v_mfma_f32_32x32x16_bf16 v[96:111], v[172:175], v[184:187], v[96:111]
    v_mfma_f32_32x32x16_bf16 v[112:127], v[172:175], v[188:191], v[112:127]
    s_waitcnt vmcnt(0)
    s_waitcnt lgkmcnt(0)
    s_barrier
    v_mfma_f32_32x32x16_bf16 v[64:79], v[128:131], v[144:147], v[64:79]
    ds_read_b128 v[176:179], v12 offset:0
    ds_read_b128 v[180:183], v12 offset:4096
    ds_read_b64_tr_b16 v[160:161], v8 offset:24576
    ds_read_b64_tr_b16 v[162:163], v8 offset:25600
    v_mfma_f32_32x32x16_bf16 v[80:95], v[128:131], v[148:151], v[80:95]
    ds_read_b64_tr_b16 v[164:165], v9 offset:24576
    ds_read_b64_tr_b16 v[166:167], v9 offset:25600
    ds_read_b128 v[184:187], v13 offset:0
    ds_read_b128 v[188:191], v13 offset:4096
    v_mfma_f32_32x32x16_bf16 v[96:111], v[132:135], v[144:147], v[96:111]
    ds_read_b64_tr_b16 v[168:169], v8 offset:28672
    ds_read_b64_tr_b16 v[170:171], v8 offset:29696
    ds_read_b64_tr_b16 v[172:173], v9 offset:28672
    ds_read_b64_tr_b16 v[174:175], v9 offset:29696
    v_mfma_f32_32x32x16_bf16 v[112:127], v[132:135], v[148:151], v[112:127]
    v_mfma_f32_32x32x16_bf16 v[64:79], v[136:139], v[152:155], v[64:79]
    v_mfma_f32_32x32x16_bf16 v[80:95], v[136:139], v[156:159], v[80:95]
    v_mfma_f32_32x32x16_bf16 v[96:111], v[140:143], v[152:155], v[96:111]
    v_mfma_f32_32x32x16_bf16 v[112:127], v[140:143], v[156:159], v[112:127]
    s_waitcnt lgkmcnt(0)
    s_barrier
    v_mfma_f32_32x32x16_bf16 v[64:79], v[160:163], v[176:179], v[64:79]
    v_mfma_f32_32x32x16_bf16 v[80:95], v[160:163], v[180:183], v[80:95]
    v_mfma_f32_32x32x16_bf16 v[96:111], v[164:167], v[176:179], v[96:111]
    v_mfma_f32_32x32x16_bf16 v[112:127], v[164:167], v[180:183], v[112:127]
    v_mfma_f32_32x32x16_bf16 v[64:79], v[168:171], v[184:187], v[64:79]
    v_mfma_f32_32x32x16_bf16 v[80:95], v[168:171], v[188:191], v[80:95]
    v_mfma_f32_32x32x16_bf16 v[96:111], v[172:175], v[184:187], v[96:111]
    v_mfma_f32_32x32x16_bf16 v[112:127], v[172:175], v[188:191], v[112:127]
    s_setprio 2
    v_lshlrev_b32 v128, 16, v192
    v_and_b32 v129, 0xffff0000, v192
    v_lshlrev_b32 v130, 16, v193
    v_and_b32 v131, 0xffff0000, v193
    v_lshlrev_b32 v132, 16, v194
    v_and_b32 v133, 0xffff0000, v194
    v_lshlrev_b32 v134, 16, v195
    v_and_b32 v135, 0xffff0000, v195
    v_lshlrev_b32 v136, 16, v196
    v_and_b32 v137, 0xffff0000, v196
    v_lshlrev_b32 v138, 16, v197
    v_and_b32 v139, 0xffff0000, v197
    v_lshlrev_b32 v140, 16, v198
    v_and_b32 v141, 0xffff0000, v198
    v_lshlrev_b32 v142, 16, v199
    v_and_b32 v143, 0xffff0000, v199
    v_lshlrev_b32 v144, 16, v200
    v_and_b32 v145, 0xffff0000, v200
    v_lshlrev_b32 v146, 16, v201
    v_and_b32 v147, 0xffff0000, v201
    v_lshlrev_b32 v148, 16, v202
    v_and_b32 v149, 0xffff0000, v202
    v_lshlrev_b32 v150, 16, v203
    v_and_b32 v151, 0xffff0000, v203
    v_lshlrev_b32 v152, 16, v204
    v_and_b32 v153, 0xffff0000, v204
    v_lshlrev_b32 v154, 16, v205
    v_and_b32 v155, 0xffff0000, v205
    v_lshlrev_b32 v156, 16, v206
    v_and_b32 v157, 0xffff0000, v206
    v_lshlrev_b32 v158, 16, v207
    v_and_b32 v159, 0xffff0000, v207
    v_bfe_u32 v1, v0, 4, 1
    v_mul_u32_u24 v1, 55296, v1
    v_lshrrev_b32 v2, 5, v0
    v_lshl_add_u32 v1, v2, 8, v1
    v_and_b32 v2, 15, v0
    v_lshl_add_u32 v1, v2, 4, v1
    s_lshl_b32 s10, s98, 3
    s_lshr_b32 s11, s3, 1
    s_lshl_b32 s11, s11, 2
    s_add_u32 s10, s10, s11
    s_mul_i32 s10, s10, 54
    s_lshr_b32 s11, s4, 1
    s_add_u32 s10, s10, s11
    s_and_b32 s11, s3, 1
    s_lshl_b32 s11, s11, 1
    s_add_u32 s10, s10, s11
    s_lshl_b32 s10, s10, 10
    s_mov_b32 s11, 0xffff0000
    s_nop 5
    .p2align 3
    v_cvt_pk_bf16_f32 v24, v64, v65
    v_cvt_pk_bf16_f32 v25, v66, v67
    v_lshlrev_b32 v26, 16, v24
    v_and_b32 v27, s11, v24
    v_lshlrev_b32 v28, 16, v25
    v_and_b32 v29, s11, v25
    v_pk_add_f32 v[26:27], v[26:27], v[128:129]
    v_pk_add_f32 v[28:29], v[28:29], v[130:131]
    v_cvt_pk_bf16_f32 v24, v26, v27
    v_cvt_pk_bf16_f32 v25, v28, v29
    v_pk_max_i16 v24, v24, 0
    v_pk_max_i16 v25, v25, 0
    v_lshlrev_b32 v26, 16, v24
    v_and_b32 v27, s11, v24
    v_lshlrev_b32 v28, 16, v25
    v_and_b32 v29, s11, v25
    v_pk_mul_f32 v[26:27], v[26:27], v[26:27]
    v_pk_mul_f32 v[28:29], v[28:29], v[28:29]
    v_cvt_pk_bf16_f32 v160, v26, v27
    v_cvt_pk_bf16_f32 v161, v28, v29
    v_cvt_pk_bf16_f32 v30, v68, v69
    v_cvt_pk_bf16_f32 v31, v70, v71
    v_lshlrev_b32 v32, 16, v30
    v_and_b32 v33, s11, v30
    v_lshlrev_b32 v34, 16, v31
    v_and_b32 v35, s11, v31
    v_pk_add_f32 v[32:33], v[32:33], v[132:133]
    v_pk_add_f32 v[34:35], v[34:35], v[134:135]
    v_cvt_pk_bf16_f32 v30, v32, v33
    v_cvt_pk_bf16_f32 v31, v34, v35
    v_pk_max_i16 v30, v30, 0
    v_pk_max_i16 v31, v31, 0
    v_lshlrev_b32 v32, 16, v30
    v_and_b32 v33, s11, v30
    v_lshlrev_b32 v34, 16, v31
    v_and_b32 v35, s11, v31
    v_pk_mul_f32 v[32:33], v[32:33], v[32:33]
    v_pk_mul_f32 v[34:35], v[34:35], v[34:35]
    v_cvt_pk_bf16_f32 v162, v32, v33
    v_cvt_pk_bf16_f32 v163, v34, v35
    v_cvt_pk_bf16_f32 v24, v72, v73
    v_cvt_pk_bf16_f32 v25, v74, v75
    v_lshlrev_b32 v26, 16, v24
    v_and_b32 v27, s11, v24
    v_lshlrev_b32 v28, 16, v25
    v_and_b32 v29, s11, v25
    v_pk_add_f32 v[26:27], v[26:27], v[136:137]
    v_pk_add_f32 v[28:29], v[28:29], v[138:139]
    v_cvt_pk_bf16_f32 v24, v26, v27
    v_cvt_pk_bf16_f32 v25, v28, v29
    v_pk_max_i16 v24, v24, 0
    v_pk_max_i16 v25, v25, 0
    v_lshlrev_b32 v26, 16, v24
    v_and_b32 v27, s11, v24
    v_lshlrev_b32 v28, 16, v25
    v_and_b32 v29, s11, v25
    v_pk_mul_f32 v[26:27], v[26:27], v[26:27]
    v_pk_mul_f32 v[28:29], v[28:29], v[28:29]
    v_cvt_pk_bf16_f32 v164, v26, v27
    v_cvt_pk_bf16_f32 v165, v28, v29
    v_cvt_pk_bf16_f32 v30, v76, v77
    v_cvt_pk_bf16_f32 v31, v78, v79
    v_lshlrev_b32 v32, 16, v30
    v_and_b32 v33, s11, v30
    v_lshlrev_b32 v34, 16, v31
    v_and_b32 v35, s11, v31
    v_pk_add_f32 v[32:33], v[32:33], v[140:141]
    v_pk_add_f32 v[34:35], v[34:35], v[142:143]
    v_cvt_pk_bf16_f32 v30, v32, v33
    v_cvt_pk_bf16_f32 v31, v34, v35
    v_pk_max_i16 v30, v30, 0
    v_pk_max_i16 v31, v31, 0
    v_lshlrev_b32 v32, 16, v30
    v_and_b32 v33, s11, v30
    v_lshlrev_b32 v34, 16, v31
    v_and_b32 v35, s11, v31
    v_pk_mul_f32 v[32:33], v[32:33], v[32:33]
    v_pk_mul_f32 v[34:35], v[34:35], v[34:35]
    v_cvt_pk_bf16_f32 v166, v32, v33
    v_cvt_pk_bf16_f32 v167, v34, v35
    s_nop 1
    v_permlane32_swap_b32 v160, v162
    v_permlane32_swap_b32 v161, v163
    v_permlane32_swap_b32 v164, v166
    v_permlane32_swap_b32 v165, v167
    s_add_u32 s12, s10, 0
    s_nop 0
    buffer_store_dwordx4 v[160:163], v1, s[60:63], s12 offen sc1
    buffer_store_dwordx4 v[164:167], v1, s[60:63], s12 offen offset:512 sc1
    v_cvt_pk_bf16_f32 v24, v96, v97
    v_cvt_pk_bf16_f32 v25, v98, v99
    v_lshlrev_b32 v26, 16, v24
    v_and_b32 v27, s11, v24
    v_lshlrev_b32 v28, 16, v25
    v_and_b32 v29, s11, v25
    v_pk_add_f32 v[26:27], v[26:27], v[144:145]
    v_pk_add_f32 v[28:29], v[28:29], v[146:147]
    v_cvt_pk_bf16_f32 v24, v26, v27
    v_cvt_pk_bf16_f32 v25, v28, v29
    v_pk_max_i16 v24, v24, 0
    v_pk_max_i16 v25, v25, 0
    v_lshlrev_b32 v26, 16, v24
    v_and_b32 v27, s11, v24
    v_lshlrev_b32 v28, 16, v25
    v_and_b32 v29, s11, v25
    v_pk_mul_f32 v[26:27], v[26:27], v[26:27]
    v_pk_mul_f32 v[28:29], v[28:29], v[28:29]
    v_cvt_pk_bf16_f32 v168, v26, v27
    v_cvt_pk_bf16_f32 v169, v28, v29
    v_cvt_pk_bf16_f32 v30, v100, v101
    v_cvt_pk_bf16_f32 v31, v102, v103
    v_lshlrev_b32 v32, 16, v30
    v_and_b32 v33, s11, v30
    v_lshlrev_b32 v34, 16, v31
    v_and_b32 v35, s11, v31
    v_pk_add_f32 v[32:33], v[32:33], v[148:149]
    v_pk_add_f32 v[34:35], v[34:35], v[150:151]
    v_cvt_pk_bf16_f32 v30, v32, v33
    v_cvt_pk_bf16_f32 v31, v34, v35
    v_pk_max_i16 v30, v30, 0
    v_pk_max_i16 v31, v31, 0
    v_lshlrev_b32 v32, 16, v30
    v_and_b32 v33, s11, v30
    v_lshlrev_b32 v34, 16, v31
    v_and_b32 v35, s11, v31
    v_pk_mul_f32 v[32:33], v[32:33], v[32:33]
    v_pk_mul_f32 v[34:35], v[34:35], v[34:35]
    v_cvt_pk_bf16_f32 v170, v32, v33
    v_cvt_pk_bf16_f32 v171, v34, v35
    v_cvt_pk_bf16_f32 v24, v104, v105
    v_cvt_pk_bf16_f32 v25, v106, v107
    v_lshlrev_b32 v26, 16, v24
    v_and_b32 v27, s11, v24
    v_lshlrev_b32 v28, 16, v25
    v_and_b32 v29, s11, v25
    v_pk_add_f32 v[26:27], v[26:27], v[152:153]
    v_pk_add_f32 v[28:29], v[28:29], v[154:155]
    v_cvt_pk_bf16_f32 v24, v26, v27
    v_cvt_pk_bf16_f32 v25, v28, v29
    v_pk_max_i16 v24, v24, 0
    v_pk_max_i16 v25, v25, 0
    v_lshlrev_b32 v26, 16, v24
    v_and_b32 v27, s11, v24
    v_lshlrev_b32 v28, 16, v25
    v_and_b32 v29, s11, v25
    v_pk_mul_f32 v[26:27], v[26:27], v[26:27]
    v_pk_mul_f32 v[28:29], v[28:29], v[28:29]
    v_cvt_pk_bf16_f32 v172, v26, v27
    v_cvt_pk_bf16_f32 v173, v28, v29
    v_cvt_pk_bf16_f32 v30, v108, v109
    v_cvt_pk_bf16_f32 v31, v110, v111
    v_lshlrev_b32 v32, 16, v30
    v_and_b32 v33, s11, v30
    v_lshlrev_b32 v34, 16, v31
    v_and_b32 v35, s11, v31
    v_pk_add_f32 v[32:33], v[32:33], v[156:157]
    v_pk_add_f32 v[34:35], v[34:35], v[158:159]
    v_cvt_pk_bf16_f32 v30, v32, v33
    v_cvt_pk_bf16_f32 v31, v34, v35
    v_pk_max_i16 v30, v30, 0
    v_pk_max_i16 v31, v31, 0
    v_lshlrev_b32 v32, 16, v30
    v_and_b32 v33, s11, v30
    v_lshlrev_b32 v34, 16, v31
    v_and_b32 v35, s11, v31
    v_pk_mul_f32 v[32:33], v[32:33], v[32:33]
    v_pk_mul_f32 v[34:35], v[34:35], v[34:35]
    v_cvt_pk_bf16_f32 v174, v32, v33
    v_cvt_pk_bf16_f32 v175, v34, v35
    s_nop 1
    v_permlane32_swap_b32 v168, v170
    v_permlane32_swap_b32 v169, v171
    v_permlane32_swap_b32 v172, v174
    v_permlane32_swap_b32 v173, v175
    s_add_u32 s12, s10, 1024
    s_nop 0
    buffer_store_dwordx4 v[168:171], v1, s[60:63], s12 offen sc1
    buffer_store_dwordx4 v[172:175], v1, s[60:63], s12 offen offset:512 sc1
    v_cvt_pk_bf16_f32 v24, v80, v81
    v_cvt_pk_bf16_f32 v25, v82, v83
    v_lshlrev_b32 v26, 16, v24
    v_and_b32 v27, s11, v24
    v_lshlrev_b32 v28, 16, v25
    v_and_b32 v29, s11, v25
    v_pk_add_f32 v[26:27], v[26:27], v[128:129]
    v_pk_add_f32 v[28:29], v[28:29], v[130:131]
    v_cvt_pk_bf16_f32 v24, v26, v27
    v_cvt_pk_bf16_f32 v25, v28, v29
    v_pk_max_i16 v24, v24, 0
    v_pk_max_i16 v25, v25, 0
    v_lshlrev_b32 v26, 16, v24
    v_and_b32 v27, s11, v24
    v_lshlrev_b32 v28, 16, v25
    v_and_b32 v29, s11, v25
    v_pk_mul_f32 v[26:27], v[26:27], v[26:27]
    v_pk_mul_f32 v[28:29], v[28:29], v[28:29]
    v_cvt_pk_bf16_f32 v160, v26, v27
    v_cvt_pk_bf16_f32 v161, v28, v29
    v_cvt_pk_bf16_f32 v30, v84, v85
    v_cvt_pk_bf16_f32 v31, v86, v87
    v_lshlrev_b32 v32, 16, v30
    v_and_b32 v33, s11, v30
    v_lshlrev_b32 v34, 16, v31
    v_and_b32 v35, s11, v31
    v_pk_add_f32 v[32:33], v[32:33], v[132:133]
    v_pk_add_f32 v[34:35], v[34:35], v[134:135]
    v_cvt_pk_bf16_f32 v30, v32, v33
    v_cvt_pk_bf16_f32 v31, v34, v35
    v_pk_max_i16 v30, v30, 0
    v_pk_max_i16 v31, v31, 0
    v_lshlrev_b32 v32, 16, v30
    v_and_b32 v33, s11, v30
    v_lshlrev_b32 v34, 16, v31
    v_and_b32 v35, s11, v31
    v_pk_mul_f32 v[32:33], v[32:33], v[32:33]
    v_pk_mul_f32 v[34:35], v[34:35], v[34:35]
    v_cvt_pk_bf16_f32 v162, v32, v33
    v_cvt_pk_bf16_f32 v163, v34, v35
    v_cvt_pk_bf16_f32 v24, v88, v89
    v_cvt_pk_bf16_f32 v25, v90, v91
    v_lshlrev_b32 v26, 16, v24
    v_and_b32 v27, s11, v24
    v_lshlrev_b32 v28, 16, v25
    v_and_b32 v29, s11, v25
    v_pk_add_f32 v[26:27], v[26:27], v[136:137]
    v_pk_add_f32 v[28:29], v[28:29], v[138:139]
    v_cvt_pk_bf16_f32 v24, v26, v27
    v_cvt_pk_bf16_f32 v25, v28, v29
    v_pk_max_i16 v24, v24, 0
    v_pk_max_i16 v25, v25, 0
    v_lshlrev_b32 v26, 16, v24
    v_and_b32 v27, s11, v24
    v_lshlrev_b32 v28, 16, v25
    v_and_b32 v29, s11, v25
    v_pk_mul_f32 v[26:27], v[26:27], v[26:27]
    v_pk_mul_f32 v[28:29], v[28:29], v[28:29]
    v_cvt_pk_bf16_f32 v164, v26, v27
    v_cvt_pk_bf16_f32 v165, v28, v29
    v_cvt_pk_bf16_f32 v30, v92, v93
    v_cvt_pk_bf16_f32 v31, v94, v95
    v_lshlrev_b32 v32, 16, v30
    v_and_b32 v33, s11, v30
    v_lshlrev_b32 v34, 16, v31
    v_and_b32 v35, s11, v31
    v_pk_add_f32 v[32:33], v[32:33], v[140:141]
    v_pk_add_f32 v[34:35], v[34:35], v[142:143]
    v_cvt_pk_bf16_f32 v30, v32, v33
    v_cvt_pk_bf16_f32 v31, v34, v35
    v_pk_max_i16 v30, v30, 0
    v_pk_max_i16 v31, v31, 0
    v_lshlrev_b32 v32, 16, v30
    v_and_b32 v33, s11, v30
    v_lshlrev_b32 v34, 16, v31
    v_and_b32 v35, s11, v31
    v_pk_mul_f32 v[32:33], v[32:33], v[32:33]
    v_pk_mul_f32 v[34:35], v[34:35], v[34:35]
    v_cvt_pk_bf16_f32 v166, v32, v33
    v_cvt_pk_bf16_f32 v167, v34, v35
    s_nop 1
    v_permlane32_swap_b32 v160, v162
    v_permlane32_swap_b32 v161, v163
    v_permlane32_swap_b32 v164, v166
    v_permlane32_swap_b32 v165, v167
    s_add_u32 s12, s10, 110592
    s_nop 0
    buffer_store_dwordx4 v[160:163], v1, s[60:63], s12 offen sc1
    buffer_store_dwordx4 v[164:167], v1, s[60:63], s12 offen offset:512 sc1
    v_cvt_pk_bf16_f32 v24, v112, v113
    v_cvt_pk_bf16_f32 v25, v114, v115
    v_lshlrev_b32 v26, 16, v24
    v_and_b32 v27, s11, v24
    v_lshlrev_b32 v28, 16, v25
    v_and_b32 v29, s11, v25
    v_pk_add_f32 v[26:27], v[26:27], v[144:145]
    v_pk_add_f32 v[28:29], v[28:29], v[146:147]
    v_cvt_pk_bf16_f32 v24, v26, v27
    v_cvt_pk_bf16_f32 v25, v28, v29
    v_pk_max_i16 v24, v24, 0
    v_pk_max_i16 v25, v25, 0
    v_lshlrev_b32 v26, 16, v24
    v_and_b32 v27, s11, v24
    v_lshlrev_b32 v28, 16, v25
    v_and_b32 v29, s11, v25
    v_pk_mul_f32 v[26:27], v[26:27], v[26:27]
    v_pk_mul_f32 v[28:29], v[28:29], v[28:29]
    v_cvt_pk_bf16_f32 v168, v26, v27
    v_cvt_pk_bf16_f32 v169, v28, v29
    v_cvt_pk_bf16_f32 v30, v116, v117
    v_cvt_pk_bf16_f32 v31, v118, v119
    v_lshlrev_b32 v32, 16, v30
    v_and_b32 v33, s11, v30
    v_lshlrev_b32 v34, 16, v31
    v_and_b32 v35, s11, v31
    v_pk_add_f32 v[32:33], v[32:33], v[148:149]
    v_pk_add_f32 v[34:35], v[34:35], v[150:151]
    v_cvt_pk_bf16_f32 v30, v32, v33
    v_cvt_pk_bf16_f32 v31, v34, v35
    v_pk_max_i16 v30, v30, 0
    v_pk_max_i16 v31, v31, 0
    v_lshlrev_b32 v32, 16, v30
    v_and_b32 v33, s11, v30
    v_lshlrev_b32 v34, 16, v31
    v_and_b32 v35, s11, v31
    v_pk_mul_f32 v[32:33], v[32:33], v[32:33]
    v_pk_mul_f32 v[34:35], v[34:35], v[34:35]
    v_cvt_pk_bf16_f32 v170, v32, v33
    v_cvt_pk_bf16_f32 v171, v34, v35
    v_cvt_pk_bf16_f32 v24, v120, v121
    v_cvt_pk_bf16_f32 v25, v122, v123
    v_lshlrev_b32 v26, 16, v24
    v_and_b32 v27, s11, v24
    v_lshlrev_b32 v28, 16, v25
    v_and_b32 v29, s11, v25
    v_pk_add_f32 v[26:27], v[26:27], v[152:153]
    v_pk_add_f32 v[28:29], v[28:29], v[154:155]
    v_cvt_pk_bf16_f32 v24, v26, v27
    v_cvt_pk_bf16_f32 v25, v28, v29
    v_pk_max_i16 v24, v24, 0
    v_pk_max_i16 v25, v25, 0
    v_lshlrev_b32 v26, 16, v24
    v_and_b32 v27, s11, v24
    v_lshlrev_b32 v28, 16, v25
    v_and_b32 v29, s11, v25
    v_pk_mul_f32 v[26:27], v[26:27], v[26:27]
    v_pk_mul_f32 v[28:29], v[28:29], v[28:29]
    v_cvt_pk_bf16_f32 v172, v26, v27
    v_cvt_pk_bf16_f32 v173, v28, v29
    v_cvt_pk_bf16_f32 v30, v124, v125
    v_cvt_pk_bf16_f32 v31, v126, v127
    v_lshlrev_b32 v32, 16, v30
    v_and_b32 v33, s11, v30
    v_lshlrev_b32 v34, 16, v31
    v_and_b32 v35, s11, v31
    v_pk_add_f32 v[32:33], v[32:33], v[156:157]
    v_pk_add_f32 v[34:35], v[34:35], v[158:159]
    v_cvt_pk_bf16_f32 v30, v32, v33
    v_cvt_pk_bf16_f32 v31, v34, v35
    v_pk_max_i16 v30, v30, 0
    v_pk_max_i16 v31, v31, 0
    v_lshlrev_b32 v32, 16, v30
    v_and_b32 v33, s11, v30
    v_lshlrev_b32 v34, 16, v31
    v_and_b32 v35, s11, v31
    v_pk_mul_f32 v[32:33], v[32:33], v[32:33]
    v_pk_mul_f32 v[34:35], v[34:35], v[34:35]
    v_cvt_pk_bf16_f32 v174, v32, v33
    v_cvt_pk_bf16_f32 v175, v34, v35
    s_nop 1
    v_permlane32_swap_b32 v168, v170
    v_permlane32_swap_b32 v169, v171
    v_permlane32_swap_b32 v172, v174
    v_permlane32_swap_b32 v173, v175
    s_add_u32 s12, s10, 111616
    s_nop 0
    buffer_store_dwordx4 v[168:171], v1, s[60:63], s12 offen sc1
    buffer_store_dwordx4 v[172:175], v1, s[60:63], s12 offen offset:512 sc1
    s_waitcnt vmcnt(0)
    v_readfirstlane_b32 s101, v22
    s_cmp_lg_u32 s101, 0
    s_cbranch_scc1 haveepg_35
    s_mov_b32 s12, s44
    s_mov_b32 s13, s45
    s_mov_b32 s14, 256
    s_mov_b32 s15, 0x00020000
    v_mov_b32 v25, 0
    s_mov_b32 s10, 400000
ep_36:
    buffer_load_dword v24, v25, s[12:15], 0 offen sc1
    s_waitcnt vmcnt(0)
    v_readfirstlane_b32 s101, v24
    s_sub_u32 s10, s10, 1
    s_cmp_eq_u32 s10, 0
    s_cbranch_scc1 epd_37
    s_cmp_lg_u32 s101, 0
    s_cbranch_scc1 epd_37
    s_sleep 1
    s_branch ep_36
epd_37:
haveepg_35:
    s_lshl_b32 s9, s98, 7
    s_lshl_b32 s10, s99, 2
    s_add_u32 s9, s9, s10
    s_add_u32 s9, s9, 2048
    s_waitcnt vmcnt(0)
    s_barrier
    s_cmp_lg_u32 s3, 0
    s_cbranch_scc1 sig_38
    s_add_u32 s12, s46, 16842752
    s_addc_u32 s13, s47, 0
    s_mov_b32 s14, 8192
    s_mov_b32 s15, 0x00020000
    v_mov_b32 v24, s101
    v_mov_b32 v25, 0
    s_mov_b64 exec, 1
    buffer_store_dword v24, v25, s[12:15], s9 offen sc1
    s_mov_b64 exec, -1
sig_38:
    s_branch fz_G2
fz_gate:
    s_mov_b32 s91, 0
    s_lshl_b32 s94, s92, 2
    s_add_u32 s94, s94, s93
    s_sub_u32 s94, s94, 28
    s_mul_i32 s95, s94, 14
    s_add_u32 s95, s95, s3
    s_add_u32 s95, s95, 0
    s_add_u32 s96, s3, 0
    s_cmp_ge_u32 s96, 14
    s_cselect_b32 s96, 4, 0
    s_sub_u32 s95, s95, s96
    s_min_u32 s95, s95, 431
    s_mov_b32 s84, s95
    s_mov_b32 s12, s36
    s_mov_b32 s13, s37
    s_mov_b32 s14, 2211840
    s_mov_b32 s15, 0x00020000
    s_mul_i32 s4, s84, 1214
    s_lshr_b32 s4, s4, 16
    s_mul_i32 s5, s4, 54
    s_sub_u32 s5, s84, s5
    s_mul_i32 s6, s5, 40960
    s_mul_i32 s7, s4, 160
    s_add_u32 s6, s6, s7
    s_mul_i32 s8, s3, 20480
    s_add_u32 s8, s8, 0
    v_add_u32 v12, 0, v0
    v_mul_u32_u24 v13, 6554, v12
    v_lshrrev_b32 v13, 16, v13
    v_mul_u32_u24 v15, 10, v13
    v_sub_u32 v14, v12, v15
    v_mul_u32_u24 v13, 1280, v13
    v_lshlrev_b32 v14, 4, v14
    v_add_u32 v13, v13, v14
    s_add_u32 s9, s8, 0
    s_mov_b32 m0, s9
    s_nop 0
    buffer_load_dwordx4 v13, s[12:15], s6 offen lds
    v_add_u32 v12, 64, v0
    v_mul_u32_u24 v13, 6554, v12
    v_lshrrev_b32 v13, 16, v13
    v_mul_u32_u24 v15, 10, v13
    v_sub_u32 v14, v12, v15
    v_mul_u32_u24 v13, 1280, v13
    v_lshlrev_b32 v14, 4, v14
    v_add_u32 v13, v13, v14
    s_add_u32 s9, s8, 1024
    s_mov_b32 m0, s9
    s_nop 0
    buffer_load_dwordx4 v13, s[12:15], s6 offen lds
    v_add_u32 v12, 128, v0
    v_mul_u32_u24 v13, 6554, v12
    v_lshrrev_b32 v13, 16, v13
    v_mul_u32_u24 v15, 10, v13
    v_sub_u32 v14, v12, v15
    v_mul_u32_u24 v13, 1280, v13
    v_lshlrev_b32 v14, 4, v14
    v_add_u32 v13, v13, v14
    s_add_u32 s9, s8, 2048
    s_mov_b32 m0, s9
    s_nop 0
    buffer_load_dwordx4 v13, s[12:15], s6 offen lds
    v_add_u32 v12, 192, v0
    v_mul_u32_u24 v13, 6554, v12
    v_lshrrev_b32 v13, 16, v13
    v_mul_u32_u24 v15, 10, v13
    v_sub_u32 v14, v12, v15
    v_mul_u32_u24 v13, 1280, v13
    v_lshlrev_b32 v14, 4, v14
    v_add_u32 v13, v13, v14
    s_add_u32 s9, s8, 3072
    s_mov_b32 m0, s9
    s_nop 0
    buffer_load_dwordx4 v13, s[12:15], s6 offen lds
    v_add_u32 v12, 256, v0
    v_mul_u32_u24 v13, 6554, v12
    v_lshrrev_b32 v13, 16, v13
    v_mul_u32_u24 v15, 10, v13
    v_sub_u32 v14, v12, v15
    v_mul_u32_u24 v13, 1280, v13
    v_lshlrev_b32 v14, 4, v14
    v_add_u32 v13, v13, v14
    s_add_u32 s9, s8, 4096
    s_mov_b32 m0, s9
    s_nop 0
    buffer_load_dwordx4 v13, s[12:15], s6 offen lds
    s_mul_i32 s95, s94, 14
    s_add_u32 s95, s95, s3
    s_add_u32 s95, s95, 4
    s_add_u32 s96, s3, 4
    s_cmp_ge_u32 s96, 14
    s_cselect_b32 s96, 4, 0
    s_sub_u32 s95, s95, s96
    s_min_u32 s95, s95, 431
    s_mov_b32 s85, s95
    s_mov_b32 s12, s36
    s_mov_b32 s13, s37
    s_mov_b32 s14, 2211840
    s_mov_b32 s15, 0x00020000
    s_mul_i32 s4, s85, 1214
    s_lshr_b32 s4, s4, 16
    s_mul_i32 s5, s4, 54
    s_sub_u32 s5, s85, s5
    s_mul_i32 s6, s5, 40960
    s_mul_i32 s7, s4, 160
    s_add_u32 s6, s6, s7
    s_mul_i32 s8, s3, 20480
    s_add_u32 s8, s8, 5120
    v_add_u32 v12, 0, v0
    v_mul_u32_u24 v13, 6554, v12
    v_lshrrev_b32 v13, 16, v13
    v_mul_u32_u24 v15, 10, v13
    v_sub_u32 v14, v12, v15
    v_mul_u32_u24 v13, 1280, v13
    v_lshlrev_b32 v14, 4, v14
    v_add_u32 v13, v13, v14
    s_add_u32 s9, s8, 0
    s_mov_b32 m0, s9
    s_nop 0
    buffer_load_dwordx4 v13, s[12:15], s6 offen lds
    v_add_u32 v12, 64, v0
    v_mul_u32_u24 v13, 6554, v12
    v_lshrrev_b32 v13, 16, v13
    v_mul_u32_u24 v15, 10, v13
    v_sub_u32 v14, v12, v15
    v_mul_u32_u24 v13, 1280, v13
    v_lshlrev_b32 v14, 4, v14
    v_add_u32 v13, v13, v14
    s_add_u32 s9, s8, 1024
    s_mov_b32 m0, s9
    s_nop 0
    buffer_load_dwordx4 v13, s[12:15], s6 offen lds
    v_add_u32 v12, 128, v0
    v_mul_u32_u24 v13, 6554, v12
    v_lshrrev_b32 v13, 16, v13
    v_mul_u32_u24 v15, 10, v13
    v_sub_u32 v14, v12, v15
    v_mul_u32_u24 v13, 1280, v13
    v_lshlrev_b32 v14, 4, v14
    v_add_u32 v13, v13, v14
    s_add_u32 s9, s8, 2048
    s_mov_b32 m0, s9
    s_nop 0
    buffer_load_dwordx4 v13, s[12:15], s6 offen lds
    v_add_u32 v12, 192, v0
    v_mul_u32_u24 v13, 6554, v12
    v_lshrrev_b32 v13, 16, v13
    v_mul_u32_u24 v15, 10, v13
    v_sub_u32 v14, v12, v15
    v_mul_u32_u24 v13, 1280, v13
    v_lshlrev_b32 v14, 4, v14
    v_add_u32 v13, v13, v14
    s_add_u32 s9, s8, 3072
    s_mov_b32 m0, s9
    s_nop 0
    buffer_load_dwordx4 v13, s[12:15], s6 offen lds
    v_add_u32 v12, 256, v0
    v_mul_u32_u24 v13, 6554, v12
    v_lshrrev_b32 v13, 16, v13
    v_mul_u32_u24 v15, 10, v13
    v_sub_u32 v14, v12, v15
    v_mul_u32_u24 v13, 1280, v13
    v_lshlrev_b32 v14, 4, v14
    v_add_u32 v13, v13, v14
    s_add_u32 s9, s8, 4096
    s_mov_b32 m0, s9
    s_nop 0
    buffer_load_dwordx4 v13, s[12:15], s6 offen lds
    s_mul_i32 s95, s94, 14
    s_add_u32 s95, s95, s3
    s_add_u32 s95, s95, 8
    s_add_u32 s96, s3, 8
    s_cmp_ge_u32 s96, 14
    s_cselect_b32 s96, 4, 0
    s_sub_u32 s95, s95, s96
    s_min_u32 s95, s95, 431
    s_mov_b32 s86, s95
    s_mov_b32 s12, s36
    s_mov_b32 s13, s37
    s_mov_b32 s14, 2211840
    s_mov_b32 s15, 0x00020000
    s_mul_i32 s4, s86, 1214
    s_lshr_b32 s4, s4, 16
    s_mul_i32 s5, s4, 54
    s_sub_u32 s5, s86, s5
    s_mul_i32 s6, s5, 40960
    s_mul_i32 s7, s4, 160
    s_add_u32 s6, s6, s7
    s_mul_i32 s8, s3, 20480
    s_add_u32 s8, s8, 10240
    v_add_u32 v12, 0, v0
    v_mul_u32_u24 v13, 6554, v12
    v_lshrrev_b32 v13, 16, v13
    v_mul_u32_u24 v15, 10, v13
    v_sub_u32 v14, v12, v15
    v_mul_u32_u24 v13, 1280, v13
    v_lshlrev_b32 v14, 4, v14
    v_add_u32 v13, v13, v14
    s_add_u32 s9, s8, 0
    s_mov_b32 m0, s9
    s_nop 0
    buffer_load_dwordx4 v13, s[12:15], s6 offen lds
    v_add_u32 v12, 64, v0
    v_mul_u32_u24 v13, 6554, v12
    v_lshrrev_b32 v13, 16, v13
    v_mul_u32_u24 v15, 10, v13
    v_sub_u32 v14, v12, v15
    v_mul_u32_u24 v13, 1280, v13
    v_lshlrev_b32 v14, 4, v14
    v_add_u32 v13, v13, v14
    s_add_u32 s9, s8, 1024
    s_mov_b32 m0, s9
    s_nop 0
    buffer_load_dwordx4 v13, s[12:15], s6 offen lds
    v_add_u32 v12, 128, v0
    v_mul_u32_u24 v13, 6554, v12
    v_lshrrev_b32 v13, 16, v13
    v_mul_u32_u24 v15, 10, v13
    v_sub_u32 v14, v12, v15
    v_mul_u32_u24 v13, 1280, v13
    v_lshlrev_b32 v14, 4, v14
    v_add_u32 v13, v13, v14
    s_add_u32 s9, s8, 2048
    s_mov_b32 m0, s9
    s_nop 0
    buffer_load_dwordx4 v13, s[12:15], s6 offen lds
    v_add_u32 v12, 192, v0
    v_mul_u32_u24 v13, 6554, v12
    v_lshrrev_b32 v13, 16, v13
    v_mul_u32_u24 v15, 10, v13
    v_sub_u32 v14, v12, v15
    v_mul_u32_u24 v13, 1280, v13
    v_lshlrev_b32 v14, 4, v14
    v_add_u32 v13, v13, v14
    s_add_u32 s9, s8, 3072
    s_mov_b32 m0, s9
    s_nop 0
    buffer_load_dwordx4 v13, s[12:15], s6 offen lds
    v_add_u32 v12, 256, v0
    v_mul_u32_u24 v13, 6554, v12
    v_lshrrev_b32 v13, 16, v13
    v_mul_u32_u24 v15, 10, v13
    v_sub_u32 v14, v12, v15
    v_mul_u32_u24 v13, 1280, v13
    v_lshlrev_b32 v14, 4, v14
    v_add_u32 v13, v13, v14
    s_add_u32 s9, s8, 4096
    s_mov_b32 m0, s9
    s_nop 0
    buffer_load_dwordx4 v13, s[12:15], s6 offen lds
    s_mul_i32 s95, s94, 14
    s_add_u32 s95, s95, s3
    s_add_u32 s95, s95, 12
    s_add_u32 s96, s3, 12
    s_cmp_ge_u32 s96, 14
    s_cselect_b32 s96, 4, 0
    s_sub_u32 s95, s95, s96
    s_min_u32 s95, s95, 431
    s_mov_b32 s87, s95
    s_mov_b32 s12, s36
    s_mov_b32 s13, s37
    s_mov_b32 s14, 2211840
    s_mov_b32 s15, 0x00020000
    s_mul_i32 s4, s87, 1214
    s_lshr_b32 s4, s4, 16
    s_mul_i32 s5, s4, 54
    s_sub_u32 s5, s87, s5
    s_mul_i32 s6, s5, 40960
    s_mul_i32 s7, s4, 160
    s_add_u32 s6, s6, s7
    s_mul_i32 s8, s3, 20480
    s_add_u32 s8, s8, 15360
    v_add_u32 v12, 0, v0
    v_mul_u32_u24 v13, 6554, v12
    v_lshrrev_b32 v13, 16, v13
    v_mul_u32_u24 v15, 10, v13
    v_sub_u32 v14, v12, v15
    v_mul_u32_u24 v13, 1280, v13
    v_lshlrev_b32 v14, 4, v14
    v_add_u32 v13, v13, v14
    s_add_u32 s9, s8, 0
    s_mov_b32 m0, s9
    s_nop 0
    buffer_load_dwordx4 v13, s[12:15], s6 offen lds
    v_add_u32 v12, 64, v0
    v_mul_u32_u24 v13, 6554, v12
    v_lshrrev_b32 v13, 16, v13
    v_mul_u32_u24 v15, 10, v13
    v_sub_u32 v14, v12, v15
    v_mul_u32_u24 v13, 1280, v13
    v_lshlrev_b32 v14, 4, v14
    v_add_u32 v13, v13, v14
    s_add_u32 s9, s8, 1024
    s_mov_b32 m0, s9
    s_nop 0
    buffer_load_dwordx4 v13, s[12:15], s6 offen lds
    v_add_u32 v12, 128, v0
    v_mul_u32_u24 v13, 6554, v12
    v_lshrrev_b32 v13, 16, v13
    v_mul_u32_u24 v15, 10, v13
    v_sub_u32 v14, v12, v15
    v_mul_u32_u24 v13, 1280, v13
    v_lshlrev_b32 v14, 4, v14
    v_add_u32 v13, v13, v14
    s_add_u32 s9, s8, 2048
    s_mov_b32 m0, s9
    s_nop 0
    buffer_load_dwordx4 v13, s[12:15], s6 offen lds
    v_add_u32 v12, 192, v0
    v_mul_u32_u24 v13, 6554, v12
    v_lshrrev_b32 v13, 16, v13
    v_mul_u32_u24 v15, 10, v13
    v_sub_u32 v14, v12, v15
    v_mul_u32_u24 v13, 1280, v13
    v_lshlrev_b32 v14, 4, v14
    v_add_u32 v13, v13, v14
    s_add_u32 s9, s8, 3072
    s_mov_b32 m0, s9
    s_nop 0
    buffer_load_dwordx4 v13, s[12:15], s6 offen lds
    v_add_u32 v12, 256, v0
    v_mul_u32_u24 v13, 6554, v12
    v_lshrrev_b32 v13, 16, v13
    v_mul_u32_u24 v15, 10, v13
    v_sub_u32 v14, v12, v15
    v_mul_u32_u24 v13, 1280, v13
    v_lshlrev_b32 v14, 4, v14
    v_add_u32 v13, v13, v14
    s_add_u32 s9, s8, 4096
    s_mov_b32 m0, s9
    s_nop 0
    buffer_load_dwordx4 v13, s[12:15], s6 offen lds
    s_add_u32 s12, s46, 10485760
    s_addc_u32 s13, s47, 0
    s_mov_b32 s14, 2211840
    s_mov_b32 s15, 0x00020000
    s_mul_i32 s8, s3, 20480
    s_add_u32 s8, s8, 0
    v_lshrrev_b32 v52, 4, v0
    v_bfe_u32 v53, v0, 2, 2
    v_and_b32 v54, 3, v0
    v_lshl_add_u32 v55, v52, 3, v53
    v_mul_u32_u24 v55, 160, v55
    v_lshl_add_u32 v55, v54, 3, v55
    v_add_u32 v55, s8, v55
    v_lshlrev_b32 v56, 4, v0
    v_add_u32 v57, 4096, v56
    s_mul_i32 s9, s84, 5120
    s_waitcnt vmcnt(15)
    ds_read_b64_tr_b16 v[72:73], v55 offset:0
    ds_read_b64_tr_b16 v[74:75], v55 offset:640
    ds_read_b64_tr_b16 v[76:77], v55 offset:32
    ds_read_b64_tr_b16 v[78:79], v55 offset:672
    ds_read_b64_tr_b16 v[80:81], v55 offset:64
    ds_read_b64_tr_b16 v[82:83], v55 offset:704
    ds_read_b64_tr_b16 v[84:85], v55 offset:96
    ds_read_b64_tr_b16 v[86:87], v55 offset:736
    ds_read_b64_tr_b16 v[88:89], v55 offset:128
    ds_read_b64_tr_b16 v[90:91], v55 offset:768
    s_waitcnt lgkmcnt(8)
    buffer_store_dwordx4 v[72:75], v56, s[12:15], s9 offen offset:0 sc1
    s_waitcnt lgkmcnt(6)
    buffer_store_dwordx4 v[76:79], v56, s[12:15], s9 offen offset:1024 sc1
    s_waitcnt lgkmcnt(4)
    buffer_store_dwordx4 v[80:83], v56, s[12:15], s9 offen offset:2048 sc1
    s_waitcnt lgkmcnt(2)
    buffer_store_dwordx4 v[84:87], v56, s[12:15], s9 offen offset:3072 sc1
    s_waitcnt lgkmcnt(0)
    buffer_store_dwordx4 v[88:91], v57, s[12:15], s9 offen sc1
    s_add_u32 s12, s46, 10485760
    s_addc_u32 s13, s47, 0
    s_mov_b32 s14, 2211840
    s_mov_b32 s15, 0x00020000
    s_mul_i32 s8, s3, 20480
    s_add_u32 s8, s8, 5120
    v_lshrrev_b32 v52, 4, v0
    v_bfe_u32 v53, v0, 2, 2
    v_and_b32 v54, 3, v0
    v_lshl_add_u32 v55, v52, 3, v53
    v_mul_u32_u24 v55, 160, v55
    v_lshl_add_u32 v55, v54, 3, v55
    v_add_u32 v55, s8, v55
    v_lshlrev_b32 v56, 4, v0
    v_add_u32 v57, 4096, v56
    s_mul_i32 s9, s85, 5120
    s_waitcnt vmcnt(15)
    ds_read_b64_tr_b16 v[72:73], v55 offset:0
    ds_read_b64_tr_b16 v[74:75], v55 offset:640
    ds_read_b64_tr_b16 v[76:77], v55 offset:32
    ds_read_b64_tr_b16 v[78:79], v55 offset:672
    ds_read_b64_tr_b16 v[80:81], v55 offset:64
    ds_read_b64_tr_b16 v[82:83], v55 offset:704
    ds_read_b64_tr_b16 v[84:85], v55 offset:96
    ds_read_b64_tr_b16 v[86:87], v55 offset:736
    ds_read_b64_tr_b16 v[88:89], v55 offset:128
    ds_read_b64_tr_b16 v[90:91], v55 offset:768
    s_waitcnt lgkmcnt(8)
    buffer_store_dwordx4 v[72:75], v56, s[12:15], s9 offen offset:0 sc1
    s_waitcnt lgkmcnt(6)
    buffer_store_dwordx4 v[76:79], v56, s[12:15], s9 offen offset:1024 sc1
    s_waitcnt lgkmcnt(4)
    buffer_store_dwordx4 v[80:83], v56, s[12:15], s9 offen offset:2048 sc1
    s_waitcnt lgkmcnt(2)
    buffer_store_dwordx4 v[84:87], v56, s[12:15], s9 offen offset:3072 sc1
    s_waitcnt lgkmcnt(0)
    buffer_store_dwordx4 v[88:91], v57, s[12:15], s9 offen sc1
    s_add_u32 s12, s46, 10485760
    s_addc_u32 s13, s47, 0
    s_mov_b32 s14, 2211840
    s_mov_b32 s15, 0x00020000
    s_mul_i32 s8, s3, 20480
    s_add_u32 s8, s8, 10240
    v_lshrrev_b32 v52, 4, v0
    v_bfe_u32 v53, v0, 2, 2
    v_and_b32 v54, 3, v0
    v_lshl_add_u32 v55, v52, 3, v53
    v_mul_u32_u24 v55, 160, v55
    v_lshl_add_u32 v55, v54, 3, v55
    v_add_u32 v55, s8, v55
    v_lshlrev_b32 v56, 4, v0
    v_add_u32 v57, 4096, v56
    s_mul_i32 s9, s86, 5120
    s_waitcnt vmcnt(15)
    ds_read_b64_tr_b16 v[72:73], v55 offset:0
    ds_read_b64_tr_b16 v[74:75], v55 offset:640
    ds_read_b64_tr_b16 v[76:77], v55 offset:32
    ds_read_b64_tr_b16 v[78:79], v55 offset:672
    ds_read_b64_tr_b16 v[80:81], v55 offset:64
    ds_read_b64_tr_b16 v[82:83], v55 offset:704
    ds_read_b64_tr_b16 v[84:85], v55 offset:96
    ds_read_b64_tr_b16 v[86:87], v55 offset:736
    ds_read_b64_tr_b16 v[88:89], v55 offset:128
    ds_read_b64_tr_b16 v[90:91], v55 offset:768
    s_waitcnt lgkmcnt(8)
    buffer_store_dwordx4 v[72:75], v56, s[12:15], s9 offen offset:0 sc1
    s_waitcnt lgkmcnt(6)
    buffer_store_dwordx4 v[76:79], v56, s[12:15], s9 offen offset:1024 sc1
    s_waitcnt lgkmcnt(4)
    buffer_store_dwordx4 v[80:83], v56, s[12:15], s9 offen offset:2048 sc1
    s_waitcnt lgkmcnt(2)
    buffer_store_dwordx4 v[84:87], v56, s[12:15], s9 offen offset:3072 sc1
    s_waitcnt lgkmcnt(0)
    buffer_store_dwordx4 v[88:91], v57, s[12:15], s9 offen sc1
    s_add_u32 s12, s46, 10485760
    s_addc_u32 s13, s47, 0
    s_mov_b32 s14, 2211840
    s_mov_b32 s15, 0x00020000
    s_mul_i32 s8, s3, 20480
    s_add_u32 s8, s8, 15360
    v_lshrrev_b32 v52, 4, v0
    v_bfe_u32 v53, v0, 2, 2
    v_and_b32 v54, 3, v0
    v_lshl_add_u32 v55, v52, 3, v53
    v_mul_u32_u24 v55, 160, v55
    v_lshl_add_u32 v55, v54, 3, v55
    v_add_u32 v55, s8, v55
    v_lshlrev_b32 v56, 4, v0
    v_add_u32 v57, 4096, v56
    s_mul_i32 s9, s87, 5120
    s_waitcnt vmcnt(15)
    ds_read_b64_tr_b16 v[72:73], v55 offset:0
    ds_read_b64_tr_b16 v[74:75], v55 offset:640
    ds_read_b64_tr_b16 v[76:77], v55 offset:32
    ds_read_b64_tr_b16 v[78:79], v55 offset:672
    ds_read_b64_tr_b16 v[80:81], v55 offset:64
    ds_read_b64_tr_b16 v[82:83], v55 offset:704
    ds_read_b64_tr_b16 v[84:85], v55 offset:96
    ds_read_b64_tr_b16 v[86:87], v55 offset:736
    ds_read_b64_tr_b16 v[88:89], v55 offset:128
    ds_read_b64_tr_b16 v[90:91], v55 offset:768
    s_waitcnt lgkmcnt(8)
    buffer_store_dwordx4 v[72:75], v56, s[12:15], s9 offen offset:0 sc1
    s_waitcnt lgkmcnt(6)
    buffer_store_dwordx4 v[76:79], v56, s[12:15], s9 offen offset:1024 sc1
    s_waitcnt lgkmcnt(4)
    buffer_store_dwordx4 v[80:83], v56, s[12:15], s9 offen offset:2048 sc1
    s_waitcnt lgkmcnt(2)
    buffer_store_dwordx4 v[84:87], v56, s[12:15], s9 offen offset:3072 sc1
    s_waitcnt lgkmcnt(0)
    buffer_store_dwordx4 v[88:91], v57, s[12:15], s9 offen sc1
    s_mov_b32 s12, s44
    s_mov_b32 s13, s45
    s_mov_b32 s14, 256
    s_mov_b32 s15, 0x00020000
    v_mov_b32 v23, 0
    buffer_load_dword v22, v23, s[12:15], 0 offen sc1
    s_waitcnt vmcnt(0)
    v_readfirstlane_b32 s101, v22
    s_cmp_lg_u32 s101, 0
    s_cbranch_scc1 haveepw_39
    s_mov_b32 s12, s44
    s_mov_b32 s13, s45
    s_mov_b32 s14, 256
    s_mov_b32 s15, 0x00020000
    v_mov_b32 v25, 0
    s_mov_b32 s10, 400000
ep_40:
    buffer_load_dword v24, v25, s[12:15], 0 offen sc1
    s_waitcnt vmcnt(0)
    v_readfirstlane_b32 s101, v24
    s_sub_u32 s10, s10, 1
    s_cmp_eq_u32 s10, 0
    s_cbranch_scc1 epd_41
    s_cmp_lg_u32 s101, 0
    s_cbranch_scc1 epd_41
    s_sleep 1
    s_branch ep_40
epd_41:
haveepw_39:
    s_lshl_b32 s9, s94, 2
    s_add_u32 s9, s9, 1536
    s_waitcnt vmcnt(0)
    s_barrier
    s_cmp_lg_u32 s3, 0
    s_cbranch_scc1 sig_42
    s_add_u32 s12, s46, 16842752
    s_addc_u32 s13, s47, 0
    s_mov_b32 s14, 8192
    s_mov_b32 s15, 0x00020000
    v_mov_b32 v24, s101
    v_mov_b32 v25, 0
    s_mov_b64 exec, 1
    buffer_store_dword v24, v25, s[12:15], s9 offen sc1
    s_mov_b64 exec, -1
sig_42:
    s_lshl_b32 s10, s94, 6
    s_lshl_b32 s11, s3, 4
    s_add_u32 s10, s10, s11
    s_mov_b32 s95, s10
    s_mov_b32 s48, s16
    s_mov_b32 s49, s17
    s_mov_b32 s50, 2621440
    s_mov_b32 s51, 0x00020000
    s_mov_b32 s64, s40
    s_mov_b32 s65, s41
    s_mov_b32 s66, 1280
    s_mov_b32 s67, 0x00020000
    s_add_u32 s68, s46, 16777216
    s_addc_u32 s69, s47, 0
    s_mov_b32 s70, 8192
    s_mov_b32 s71, 0x00020000
    v_and_b32 v1, 15, v0
    v_lshlrev_b32 v1, 4, v1
    v_lshrrev_b32 v2, 4, v0
    v_mul_u32_u24 v3, 1280, v2
    v_add_u32 v3, v3, v1
    buffer_load_dwordx4 v[40:43], v1, s[64:67], 0 offen offset:0
    buffer_load_dwordx4 v[44:47], v1, s[64:67], 0 offen offset:256
    buffer_load_dwordx4 v[48:51], v1, s[64:67], 0 offen offset:512
    buffer_load_dwordx4 v[52:55], v1, s[64:67], 0 offen offset:768
    buffer_load_dwordx4 v[56:59], v1, s[64:67], 0 offen offset:1024
    s_mul_i32 s4, s95, 1280
    buffer_load_dwordx4 v[100:103], v3, s[48:51], s4 offen offset:0
    buffer_load_dwordx4 v[104:107], v3, s[48:51], s4 offen offset:256
    buffer_load_dwordx4 v[108:111], v3, s[48:51], s4 offen offset:512
    buffer_load_dwordx4 v[112:115], v3, s[48:51], s4 offen offset:768
    buffer_load_dwordx4 v[116:119], v3, s[48:51], s4 offen offset:1024
    s_add_u32 s4, s4, 5120
    buffer_load_dwordx4 v[120:123], v3, s[48:51], s4 offen offset:0
    buffer_load_dwordx4 v[124:127], v3, s[48:51], s4 offen offset:256
    buffer_load_dwordx4 v[128:131], v3, s[48:51], s4 offen offset:512
    buffer_load_dwordx4 v[132:135], v3, s[48:51], s4 offen offset:768
    buffer_load_dwordx4 v[136:139], v3, s[48:51], s4 offen offset:1024
    s_add_u32 s4, s4, 5120
    buffer_load_dwordx4 v[140:143], v3, s[48:51], s4 offen offset:0
    buffer_load_dwordx4 v[144:147], v3, s[48:51], s4 offen offset:256
    buffer_load_dwordx4 v[148:151], v3, s[48:51], s4 offen offset:512
    buffer_load_dwordx4 v[152:155], v3, s[48:51], s4 offen offset:768
    buffer_load_dwordx4 v[156:159], v3, s[48:51], s4 offen offset:1024
    s_add_u32 s4, s4, 5120
    buffer_load_dwordx4 v[160:163], v3, s[48:51], s4 offen offset:0
    buffer_load_dwordx4 v[164:167], v3, s[48:51], s4 offen offset:256
    buffer_load_dwordx4 v[168:171], v3, s[48:51], s4 offen offset:512
    buffer_load_dwordx4 v[172:175], v3, s[48:51], s4 offen offset:768
    buffer_load_dwordx4 v[176:179], v3, s[48:51], s4 offen offset:1024
    s_add_u32 s4, s4, 5120
    s_waitcnt vmcnt(20)
    s_mov_b32 s6, 0xffff0000
    v_lshlrev_b32 v60, 16, v40
    v_and_b32 v61, s6, v40
    v_lshlrev_b32 v62, 16, v41
    v_and_b32 v63, s6, v41
    v_lshlrev_b32 v64, 16, v42
    v_and_b32 v65, s6, v42
    v_lshlrev_b32 v66, 16, v43
    v_and_b32 v67, s6, v43
    v_lshlrev_b32 v68, 16, v44
    v_and_b32 v69, s6, v44
    v_lshlrev_b32 v70, 16, v45
    v_and_b32 v71, s6, v45
    v_lshlrev_b32 v72, 16, v46
    v_and_b32 v73, s6, v46
    v_lshlrev_b32 v74, 16, v47
    v_and_b32 v75, s6, v47
    v_lshlrev_b32 v76, 16, v48
    v_and_b32 v77, s6, v48
    v_lshlrev_b32 v78, 16, v49
    v_and_b32 v79, s6, v49
    v_lshlrev_b32 v80, 16, v50
    v_and_b32 v81, s6, v50
    v_lshlrev_b32 v82, 16, v51
    v_and_b32 v83, s6, v51
    v_lshlrev_b32 v84, 16, v52
    v_and_b32 v85, s6, v52
    v_lshlrev_b32 v86, 16, v53
    v_and_b32 v87, s6, v53
    v_lshlrev_b32 v88, 16, v54
    v_and_b32 v89, s6, v54
    v_lshlrev_b32 v90, 16, v55
    v_and_b32 v91, s6, v55
    v_lshlrev_b32 v92, 16, v56
    v_and_b32 v93, s6, v56
    v_lshlrev_b32 v94, 16, v57
    v_and_b32 v95, s6, v57
    v_lshlrev_b32 v96, 16, v58
    v_and_b32 v97, s6, v58
    v_lshlrev_b32 v98, 16, v59
    v_and_b32 v99, s6, v59
    v_lshlrev_b32 v6, 2, v2
    v_mov_b32 v8, 0x40000000
    v_cmp_eq_u32 vcc, 0, v1
    s_nop 1
    v_cndmask_b32 v6, v8, v6, vcc
    v_mov_b32 v4, 0
    v_mov_b32 v5, 0
    s_waitcnt vmcnt(15)
    v_lshlrev_b32 v30, 16, v100
    v_and_b32 v31, s6, v100
    v_mul_f32 v30, v30, v60
    v_mul_f32 v31, v31, v61
    v_cvt_pk_bf16_f32 v32, v30, v31
    v_lshlrev_b32 v30, 16, v32
    v_and_b32 v31, s6, v32
    v_add_f32 v4, v4, v30
    v_add_f32 v5, v5, v31
    v_lshlrev_b32 v34, 16, v101
    v_and_b32 v35, s6, v101
    v_mul_f32 v34, v34, v62
    v_mul_f32 v35, v35, v63
    v_cvt_pk_bf16_f32 v36, v34, v35
    v_lshlrev_b32 v34, 16, v36
    v_and_b32 v35, s6, v36
    v_add_f32 v4, v4, v34
    v_add_f32 v5, v5, v35
    v_lshlrev_b32 v30, 16, v102
    v_and_b32 v31, s6, v102
    v_mul_f32 v30, v30, v64
    v_mul_f32 v31, v31, v65
    v_cvt_pk_bf16_f32 v32, v30, v31
    v_lshlrev_b32 v30, 16, v32
    v_and_b32 v31, s6, v32
    v_add_f32 v4, v4, v30
    v_add_f32 v5, v5, v31
    v_lshlrev_b32 v34, 16, v103
    v_and_b32 v35, s6, v103
    v_mul_f32 v34, v34, v66
    v_mul_f32 v35, v35, v67
    v_cvt_pk_bf16_f32 v36, v34, v35
    v_lshlrev_b32 v34, 16, v36
    v_and_b32 v35, s6, v36
    v_add_f32 v4, v4, v34
    v_add_f32 v5, v5, v35
    v_lshlrev_b32 v30, 16, v104
    v_and_b32 v31, s6, v104
    v_mul_f32 v30, v30, v68
    v_mul_f32 v31, v31, v69
    v_cvt_pk_bf16_f32 v32, v30, v31
    v_lshlrev_b32 v30, 16, v32
    v_and_b32 v31, s6, v32
    v_add_f32 v4, v4, v30
    v_add_f32 v5, v5, v31
    v_lshlrev_b32 v34, 16, v105
    v_and_b32 v35, s6, v105
    v_mul_f32 v34, v34, v70
    v_mul_f32 v35, v35, v71
    v_cvt_pk_bf16_f32 v36, v34, v35
    v_lshlrev_b32 v34, 16, v36
    v_and_b32 v35, s6, v36
    v_add_f32 v4, v4, v34
    v_add_f32 v5, v5, v35
    v_lshlrev_b32 v30, 16, v106
    v_and_b32 v31, s6, v106
    v_mul_f32 v30, v30, v72
    v_mul_f32 v31, v31, v73
    v_cvt_pk_bf16_f32 v32, v30, v31
    v_lshlrev_b32 v30, 16, v32
    v_and_b32 v31, s6, v32
    v_add_f32 v4, v4, v30
    v_add_f32 v5, v5, v31
    v_lshlrev_b32 v34, 16, v107
    v_and_b32 v35, s6, v107
    v_mul_f32 v34, v34, v74
    v_mul_f32 v35, v35, v75
    v_cvt_pk_bf16_f32 v36, v34, v35
    v_lshlrev_b32 v34, 16, v36
    v_and_b32 v35, s6, v36
    v_add_f32 v4, v4, v34
    v_add_f32 v5, v5, v35
    v_lshlrev_b32 v30, 16, v108
    v_and_b32 v31, s6, v108
    v_mul_f32 v30, v30, v76
    v_mul_f32 v31, v31, v77
    v_cvt_pk_bf16_f32 v32, v30, v31
    v_lshlrev_b32 v30, 16, v32
    v_and_b32 v31, s6, v32
    v_add_f32 v4, v4, v30
    v_add_f32 v5, v5, v31
    v_lshlrev_b32 v34, 16, v109
    v_and_b32 v35, s6, v109
    v_mul_f32 v34, v34, v78
    v_mul_f32 v35, v35, v79
    v_cvt_pk_bf16_f32 v36, v34, v35
    v_lshlrev_b32 v34, 16, v36
    v_and_b32 v35, s6, v36
    v_add_f32 v4, v4, v34
    v_add_f32 v5, v5, v35
    v_lshlrev_b32 v30, 16, v110
    v_and_b32 v31, s6, v110
    v_mul_f32 v30, v30, v80
    v_mul_f32 v31, v31, v81
    v_cvt_pk_bf16_f32 v32, v30, v31
    v_lshlrev_b32 v30, 16, v32
    v_and_b32 v31, s6, v32
    v_add_f32 v4, v4, v30
    v_add_f32 v5, v5, v31
    v_lshlrev_b32 v34, 16, v111
    v_and_b32 v35, s6, v111
    v_mul_f32 v34, v34, v82
    v_mul_f32 v35, v35, v83
    v_cvt_pk_bf16_f32 v36, v34, v35
    v_lshlrev_b32 v34, 16, v36
    v_and_b32 v35, s6, v36
    v_add_f32 v4, v4, v34
    v_add_f32 v5, v5, v35
    v_lshlrev_b32 v30, 16, v112
    v_and_b32 v31, s6, v112
    v_mul_f32 v30, v30, v84
    v_mul_f32 v31, v31, v85
    v_cvt_pk_bf16_f32 v32, v30, v31
    v_lshlrev_b32 v30, 16, v32
    v_and_b32 v31, s6, v32
    v_add_f32 v4, v4, v30
    v_add_f32 v5, v5, v31
    v_lshlrev_b32 v34, 16, v113
    v_and_b32 v35, s6, v113
    v_mul_f32 v34, v34, v86
    v_mul_f32 v35, v35, v87
    v_cvt_pk_bf16_f32 v36, v34, v35
    v_lshlrev_b32 v34, 16, v36
    v_and_b32 v35, s6, v36
    v_add_f32 v4, v4, v34
    v_add_f32 v5, v5, v35
    v_lshlrev_b32 v30, 16, v114
    v_and_b32 v31, s6, v114
    v_mul_f32 v30, v30, v88
    v_mul_f32 v31, v31, v89
    v_cvt_pk_bf16_f32 v32, v30, v31
    v_lshlrev_b32 v30, 16, v32
    v_and_b32 v31, s6, v32
    v_add_f32 v4, v4, v30
    v_add_f32 v5, v5, v31
    v_lshlrev_b32 v34, 16, v115
    v_and_b32 v35, s6, v115
    v_mul_f32 v34, v34, v90
    v_mul_f32 v35, v35, v91
    v_cvt_pk_bf16_f32 v36, v34, v35
    v_lshlrev_b32 v34, 16, v36
    v_and_b32 v35, s6, v36
    v_add_f32 v4, v4, v34
    v_add_f32 v5, v5, v35
    v_lshlrev_b32 v30, 16, v116
    v_and_b32 v31, s6, v116
    v_mul_f32 v30, v30, v92
    v_mul_f32 v31, v31, v93
    v_cvt_pk_bf16_f32 v32, v30, v31
    v_lshlrev_b32 v30, 16, v32
    v_and_b32 v31, s6, v32
    v_add_f32 v4, v4, v30
    v_add_f32 v5, v5, v31
    v_lshlrev_b32 v34, 16, v117
    v_and_b32 v35, s6, v117
    v_mul_f32 v34, v34, v94
    v_mul_f32 v35, v35, v95
    v_cvt_pk_bf16_f32 v36, v34, v35
    v_lshlrev_b32 v34, 16, v36
    v_and_b32 v35, s6, v36
    v_add_f32 v4, v4, v34
    v_add_f32 v5, v5, v35
    v_lshlrev_b32 v30, 16, v118
    v_and_b32 v31, s6, v118
    v_mul_f32 v30, v30, v96
    v_mul_f32 v31, v31, v97
    v_cvt_pk_bf16_f32 v32, v30, v31
    v_lshlrev_b32 v30, 16, v32
    v_and_b32 v31, s6, v32
    v_add_f32 v4, v4, v30
    v_add_f32 v5, v5, v31
    v_lshlrev_b32 v34, 16, v119
    v_and_b32 v35, s6, v119
    v_mul_f32 v34, v34, v98
    v_mul_f32 v35, v35, v99
    v_cvt_pk_bf16_f32 v36, v34, v35
    v_lshlrev_b32 v34, 16, v36
    v_and_b32 v35, s6, v36
    v_add_f32 v4, v4, v34
    v_add_f32 v5, v5, v35
    v_add_f32 v4, v4, v5
    s_nop 1
    v_add_f32_dpp v4, v4, v4 row_ror:8 row_mask:0xf bank_mask:0xf
    s_nop 1
    v_add_f32_dpp v4, v4, v4 row_ror:4 row_mask:0xf bank_mask:0xf
    s_nop 1
    v_add_f32_dpp v4, v4, v4 row_ror:2 row_mask:0xf bank_mask:0xf
    s_nop 1
    v_add_f32_dpp v4, v4, v4 row_ror:1 row_mask:0xf bank_mask:0xf
    v_cvt_pk_bf16_f32 v4, v4, v4
    v_lshlrev_b32 v4, 16, v4
    v_mul_f32 v5, 0xbfb8aa3b, v4
    v_exp_f32 v5, v5
    s_nop 0
    v_add_f32 v5, 1.0, v5
    v_rcp_f32 v5, v5
    s_nop 0
    v_cvt_pk_bf16_f32 v5, v5, v5
    v_lshlrev_b32 v9, 16, v5
    s_lshl_b32 s5, s95, 2
    s_add_u32 s5, s5, 0
    buffer_store_dword v9, v6, s[68:71], s5 offen sc1
    v_mov_b32 v4, 0
    v_mov_b32 v5, 0
    s_waitcnt vmcnt(11)
    v_lshlrev_b32 v30, 16, v120
    v_and_b32 v31, s6, v120
    v_mul_f32 v30, v30, v60
    v_mul_f32 v31, v31, v61
    v_cvt_pk_bf16_f32 v32, v30, v31
    v_lshlrev_b32 v30, 16, v32
    v_and_b32 v31, s6, v32
    v_add_f32 v4, v4, v30
    v_add_f32 v5, v5, v31
    v_lshlrev_b32 v34, 16, v121
    v_and_b32 v35, s6, v121
    v_mul_f32 v34, v34, v62
    v_mul_f32 v35, v35, v63
    v_cvt_pk_bf16_f32 v36, v34, v35
    v_lshlrev_b32 v34, 16, v36
    v_and_b32 v35, s6, v36
    v_add_f32 v4, v4, v34
    v_add_f32 v5, v5, v35
    v_lshlrev_b32 v30, 16, v122
    v_and_b32 v31, s6, v122
    v_mul_f32 v30, v30, v64
    v_mul_f32 v31, v31, v65
    v_cvt_pk_bf16_f32 v32, v30, v31
    v_lshlrev_b32 v30, 16, v32
    v_and_b32 v31, s6, v32
    v_add_f32 v4, v4, v30
    v_add_f32 v5, v5, v31
    v_lshlrev_b32 v34, 16, v123
    v_and_b32 v35, s6, v123
    v_mul_f32 v34, v34, v66
    v_mul_f32 v35, v35, v67
    v_cvt_pk_bf16_f32 v36, v34, v35
    v_lshlrev_b32 v34, 16, v36
    v_and_b32 v35, s6, v36
    v_add_f32 v4, v4, v34
    v_add_f32 v5, v5, v35
    v_lshlrev_b32 v30, 16, v124
    v_and_b32 v31, s6, v124
    v_mul_f32 v30, v30, v68
    v_mul_f32 v31, v31, v69
    v_cvt_pk_bf16_f32 v32, v30, v31
    v_lshlrev_b32 v30, 16, v32
    v_and_b32 v31, s6, v32
    v_add_f32 v4, v4, v30
    v_add_f32 v5, v5, v31
    v_lshlrev_b32 v34, 16, v125
    v_and_b32 v35, s6, v125
    v_mul_f32 v34, v34, v70
    v_mul_f32 v35, v35, v71
    v_cvt_pk_bf16_f32 v36, v34, v35
    v_lshlrev_b32 v34, 16, v36
    v_and_b32 v35, s6, v36
    v_add_f32 v4, v4, v34
    v_add_f32 v5, v5, v35
    v_lshlrev_b32 v30, 16, v126
    v_and_b32 v31, s6, v126
    v_mul_f32 v30, v30, v72
    v_mul_f32 v31, v31, v73
    v_cvt_pk_bf16_f32 v32, v30, v31
    v_lshlrev_b32 v30, 16, v32
    v_and_b32 v31, s6, v32
    v_add_f32 v4, v4, v30
    v_add_f32 v5, v5, v31
    v_lshlrev_b32 v34, 16, v127
    v_and_b32 v35, s6, v127
    v_mul_f32 v34, v34, v74
    v_mul_f32 v35, v35, v75
    v_cvt_pk_bf16_f32 v36, v34, v35
    v_lshlrev_b32 v34, 16, v36
    v_and_b32 v35, s6, v36
    v_add_f32 v4, v4, v34
    v_add_f32 v5, v5, v35
    v_lshlrev_b32 v30, 16, v128
    v_and_b32 v31, s6, v128
    v_mul_f32 v30, v30, v76
    v_mul_f32 v31, v31, v77
    v_cvt_pk_bf16_f32 v32, v30, v31
    v_lshlrev_b32 v30, 16, v32
    v_and_b32 v31, s6, v32
    v_add_f32 v4, v4, v30
    v_add_f32 v5, v5, v31
    v_lshlrev_b32 v34, 16, v129
    v_and_b32 v35, s6, v129
    v_mul_f32 v34, v34, v78
    v_mul_f32 v35, v35, v79
    v_cvt_pk_bf16_f32 v36, v34, v35
    v_lshlrev_b32 v34, 16, v36
    v_and_b32 v35, s6, v36
    v_add_f32 v4, v4, v34
    v_add_f32 v5, v5, v35
    v_lshlrev_b32 v30, 16, v130
    v_and_b32 v31, s6, v130
    v_mul_f32 v30, v30, v80
    v_mul_f32 v31, v31, v81
    v_cvt_pk_bf16_f32 v32, v30, v31
    v_lshlrev_b32 v30, 16, v32
    v_and_b32 v31, s6, v32
    v_add_f32 v4, v4, v30
    v_add_f32 v5, v5, v31
    v_lshlrev_b32 v34, 16, v131
    v_and_b32 v35, s6, v131
    v_mul_f32 v34, v34, v82
    v_mul_f32 v35, v35, v83
    v_cvt_pk_bf16_f32 v36, v34, v35
    v_lshlrev_b32 v34, 16, v36
    v_and_b32 v35, s6, v36
    v_add_f32 v4, v4, v34
    v_add_f32 v5, v5, v35
    v_lshlrev_b32 v30, 16, v132
    v_and_b32 v31, s6, v132
    v_mul_f32 v30, v30, v84
    v_mul_f32 v31, v31, v85
    v_cvt_pk_bf16_f32 v32, v30, v31
    v_lshlrev_b32 v30, 16, v32
    v_and_b32 v31, s6, v32
    v_add_f32 v4, v4, v30
    v_add_f32 v5, v5, v31
    v_lshlrev_b32 v34, 16, v133
    v_and_b32 v35, s6, v133
    v_mul_f32 v34, v34, v86
    v_mul_f32 v35, v35, v87
    v_cvt_pk_bf16_f32 v36, v34, v35
    v_lshlrev_b32 v34, 16, v36
    v_and_b32 v35, s6, v36
    v_add_f32 v4, v4, v34
    v_add_f32 v5, v5, v35
    v_lshlrev_b32 v30, 16, v134
    v_and_b32 v31, s6, v134
    v_mul_f32 v30, v30, v88
    v_mul_f32 v31, v31, v89
    v_cvt_pk_bf16_f32 v32, v30, v31
    v_lshlrev_b32 v30, 16, v32
    v_and_b32 v31, s6, v32
    v_add_f32 v4, v4, v30
    v_add_f32 v5, v5, v31
    v_lshlrev_b32 v34, 16, v135
    v_and_b32 v35, s6, v135
    v_mul_f32 v34, v34, v90
    v_mul_f32 v35, v35, v91
    v_cvt_pk_bf16_f32 v36, v34, v35
    v_lshlrev_b32 v34, 16, v36
    v_and_b32 v35, s6, v36
    v_add_f32 v4, v4, v34
    v_add_f32 v5, v5, v35
    v_lshlrev_b32 v30, 16, v136
    v_and_b32 v31, s6, v136
    v_mul_f32 v30, v30, v92
    v_mul_f32 v31, v31, v93
    v_cvt_pk_bf16_f32 v32, v30, v31
    v_lshlrev_b32 v30, 16, v32
    v_and_b32 v31, s6, v32
    v_add_f32 v4, v4, v30
    v_add_f32 v5, v5, v31
    v_lshlrev_b32 v34, 16, v137
    v_and_b32 v35, s6, v137
    v_mul_f32 v34, v34, v94
    v_mul_f32 v35, v35, v95
    v_cvt_pk_bf16_f32 v36, v34, v35
    v_lshlrev_b32 v34, 16, v36
    v_and_b32 v35, s6, v36
    v_add_f32 v4, v4, v34
    v_add_f32 v5, v5, v35
    v_lshlrev_b32 v30, 16, v138
    v_and_b32 v31, s6, v138
    v_mul_f32 v30, v30, v96
    v_mul_f32 v31, v31, v97
    v_cvt_pk_bf16_f32 v32, v30, v31
    v_lshlrev_b32 v30, 16, v32
    v_and_b32 v31, s6, v32
    v_add_f32 v4, v4, v30
    v_add_f32 v5, v5, v31
    v_lshlrev_b32 v34, 16, v139
    v_and_b32 v35, s6, v139
    v_mul_f32 v34, v34, v98
    v_mul_f32 v35, v35, v99
    v_cvt_pk_bf16_f32 v36, v34, v35
    v_lshlrev_b32 v34, 16, v36
    v_and_b32 v35, s6, v36
    v_add_f32 v4, v4, v34
    v_add_f32 v5, v5, v35
    v_add_f32 v4, v4, v5
    s_nop 1
    v_add_f32_dpp v4, v4, v4 row_ror:8 row_mask:0xf bank_mask:0xf
    s_nop 1
    v_add_f32_dpp v4, v4, v4 row_ror:4 row_mask:0xf bank_mask:0xf
    s_nop 1
    v_add_f32_dpp v4, v4, v4 row_ror:2 row_mask:0xf bank_mask:0xf
    s_nop 1
    v_add_f32_dpp v4, v4, v4 row_ror:1 row_mask:0xf bank_mask:0xf
    v_cvt_pk_bf16_f32 v4, v4, v4
    v_lshlrev_b32 v4, 16, v4
    v_mul_f32 v5, 0xbfb8aa3b, v4
    v_exp_f32 v5, v5
    s_nop 0
    v_add_f32 v5, 1.0, v5
    v_rcp_f32 v5, v5
    s_nop 0
    v_cvt_pk_bf16_f32 v5, v5, v5
    v_lshlrev_b32 v10, 16, v5
    s_lshl_b32 s5, s95, 2
    s_add_u32 s5, s5, 16
    buffer_store_dword v10, v6, s[68:71], s5 offen sc1
    v_mov_b32 v4, 0
    v_mov_b32 v5, 0
    s_waitcnt vmcnt(7)
    v_lshlrev_b32 v30, 16, v140
    v_and_b32 v31, s6, v140
    v_mul_f32 v30, v30, v60
    v_mul_f32 v31, v31, v61
    v_cvt_pk_bf16_f32 v32, v30, v31
    v_lshlrev_b32 v30, 16, v32
    v_and_b32 v31, s6, v32
    v_add_f32 v4, v4, v30
    v_add_f32 v5, v5, v31
    v_lshlrev_b32 v34, 16, v141
    v_and_b32 v35, s6, v141
    v_mul_f32 v34, v34, v62
    v_mul_f32 v35, v35, v63
    v_cvt_pk_bf16_f32 v36, v34, v35
    v_lshlrev_b32 v34, 16, v36
    v_and_b32 v35, s6, v36
    v_add_f32 v4, v4, v34
    v_add_f32 v5, v5, v35
    v_lshlrev_b32 v30, 16, v142
    v_and_b32 v31, s6, v142
    v_mul_f32 v30, v30, v64
    v_mul_f32 v31, v31, v65
    v_cvt_pk_bf16_f32 v32, v30, v31
    v_lshlrev_b32 v30, 16, v32
    v_and_b32 v31, s6, v32
    v_add_f32 v4, v4, v30
    v_add_f32 v5, v5, v31
    v_lshlrev_b32 v34, 16, v143
    v_and_b32 v35, s6, v143
    v_mul_f32 v34, v34, v66
    v_mul_f32 v35, v35, v67
    v_cvt_pk_bf16_f32 v36, v34, v35
    v_lshlrev_b32 v34, 16, v36
    v_and_b32 v35, s6, v36
    v_add_f32 v4, v4, v34
    v_add_f32 v5, v5, v35
    v_lshlrev_b32 v30, 16, v144
    v_and_b32 v31, s6, v144
    v_mul_f32 v30, v30, v68
    v_mul_f32 v31, v31, v69
    v_cvt_pk_bf16_f32 v32, v30, v31
    v_lshlrev_b32 v30, 16, v32
    v_and_b32 v31, s6, v32
    v_add_f32 v4, v4, v30
    v_add_f32 v5, v5, v31
    v_lshlrev_b32 v34, 16, v145
    v_and_b32 v35, s6, v145
    v_mul_f32 v34, v34, v70
    v_mul_f32 v35, v35, v71
    v_cvt_pk_bf16_f32 v36, v34, v35
    v_lshlrev_b32 v34, 16, v36
    v_and_b32 v35, s6, v36
    v_add_f32 v4, v4, v34
    v_add_f32 v5, v5, v35
    v_lshlrev_b32 v30, 16, v146
    v_and_b32 v31, s6, v146
    v_mul_f32 v30, v30, v72
    v_mul_f32 v31, v31, v73
    v_cvt_pk_bf16_f32 v32, v30, v31
    v_lshlrev_b32 v30, 16, v32
    v_and_b32 v31, s6, v32
    v_add_f32 v4, v4, v30
    v_add_f32 v5, v5, v31
    v_lshlrev_b32 v34, 16, v147
    v_and_b32 v35, s6, v147
    v_mul_f32 v34, v34, v74
    v_mul_f32 v35, v35, v75
    v_cvt_pk_bf16_f32 v36, v34, v35
    v_lshlrev_b32 v34, 16, v36
    v_and_b32 v35, s6, v36
    v_add_f32 v4, v4, v34
    v_add_f32 v5, v5, v35
    v_lshlrev_b32 v30, 16, v148
    v_and_b32 v31, s6, v148
    v_mul_f32 v30, v30, v76
    v_mul_f32 v31, v31, v77
    v_cvt_pk_bf16_f32 v32, v30, v31
    v_lshlrev_b32 v30, 16, v32
    v_and_b32 v31, s6, v32
    v_add_f32 v4, v4, v30
    v_add_f32 v5, v5, v31
    v_lshlrev_b32 v34, 16, v149
    v_and_b32 v35, s6, v149
    v_mul_f32 v34, v34, v78
    v_mul_f32 v35, v35, v79
    v_cvt_pk_bf16_f32 v36, v34, v35
    v_lshlrev_b32 v34, 16, v36
    v_and_b32 v35, s6, v36
    v_add_f32 v4, v4, v34
    v_add_f32 v5, v5, v35
    v_lshlrev_b32 v30, 16, v150
    v_and_b32 v31, s6, v150
    v_mul_f32 v30, v30, v80
    v_mul_f32 v31, v31, v81
    v_cvt_pk_bf16_f32 v32, v30, v31
    v_lshlrev_b32 v30, 16, v32
    v_and_b32 v31, s6, v32
    v_add_f32 v4, v4, v30
    v_add_f32 v5, v5, v31
    v_lshlrev_b32 v34, 16, v151
    v_and_b32 v35, s6, v151
    v_mul_f32 v34, v34, v82
    v_mul_f32 v35, v35, v83
    v_cvt_pk_bf16_f32 v36, v34, v35
    v_lshlrev_b32 v34, 16, v36
    v_and_b32 v35, s6, v36
    v_add_f32 v4, v4, v34
    v_add_f32 v5, v5, v35
    v_lshlrev_b32 v30, 16, v152
    v_and_b32 v31, s6, v152
    v_mul_f32 v30, v30, v84
    v_mul_f32 v31, v31, v85
    v_cvt_pk_bf16_f32 v32, v30, v31
    v_lshlrev_b32 v30, 16, v32
    v_and_b32 v31, s6, v32
    v_add_f32 v4, v4, v30
    v_add_f32 v5, v5, v31
    v_lshlrev_b32 v34, 16, v153
    v_and_b32 v35, s6, v153
    v_mul_f32 v34, v34, v86
    v_mul_f32 v35, v35, v87
    v_cvt_pk_bf16_f32 v36, v34, v35
    v_lshlrev_b32 v34, 16, v36
    v_and_b32 v35, s6, v36
    v_add_f32 v4, v4, v34
    v_add_f32 v5, v5, v35
    v_lshlrev_b32 v30, 16, v154
    v_and_b32 v31, s6, v154
    v_mul_f32 v30, v30, v88
    v_mul_f32 v31, v31, v89
    v_cvt_pk_bf16_f32 v32, v30, v31
    v_lshlrev_b32 v30, 16, v32
    v_and_b32 v31, s6, v32
    v_add_f32 v4, v4, v30
    v_add_f32 v5, v5, v31
    v_lshlrev_b32 v34, 16, v155
    v_and_b32 v35, s6, v155
    v_mul_f32 v34, v34, v90
    v_mul_f32 v35, v35, v91
    v_cvt_pk_bf16_f32 v36, v34, v35
    v_lshlrev_b32 v34, 16, v36
    v_and_b32 v35, s6, v36
    v_add_f32 v4, v4, v34
    v_add_f32 v5, v5, v35
    v_lshlrev_b32 v30, 16, v156
    v_and_b32 v31, s6, v156
    v_mul_f32 v30, v30, v92
    v_mul_f32 v31, v31, v93
    v_cvt_pk_bf16_f32 v32, v30, v31
    v_lshlrev_b32 v30, 16, v32
    v_and_b32 v31, s6, v32
    v_add_f32 v4, v4, v30
    v_add_f32 v5, v5, v31
    v_lshlrev_b32 v34, 16, v157
    v_and_b32 v35, s6, v157
    v_mul_f32 v34, v34, v94
    v_mul_f32 v35, v35, v95
    v_cvt_pk_bf16_f32 v36, v34, v35
    v_lshlrev_b32 v34, 16, v36
    v_and_b32 v35, s6, v36
    v_add_f32 v4, v4, v34
    v_add_f32 v5, v5, v35
    v_lshlrev_b32 v30, 16, v158
    v_and_b32 v31, s6, v158
    v_mul_f32 v30, v30, v96
    v_mul_f32 v31, v31, v97
    v_cvt_pk_bf16_f32 v32, v30, v31
    v_lshlrev_b32 v30, 16, v32
    v_and_b32 v31, s6, v32
    v_add_f32 v4, v4, v30
    v_add_f32 v5, v5, v31
    v_lshlrev_b32 v34, 16, v159
    v_and_b32 v35, s6, v159
    v_mul_f32 v34, v34, v98
    v_mul_f32 v35, v35, v99
    v_cvt_pk_bf16_f32 v36, v34, v35
    v_lshlrev_b32 v34, 16, v36
    v_and_b32 v35, s6, v36
    v_add_f32 v4, v4, v34
    v_add_f32 v5, v5, v35
    v_add_f32 v4, v4, v5
    s_nop 1
    v_add_f32_dpp v4, v4, v4 row_ror:8 row_mask:0xf bank_mask:0xf
    s_nop 1
    v_add_f32_dpp v4, v4, v4 row_ror:4 row_mask:0xf bank_mask:0xf
    s_nop 1
    v_add_f32_dpp v4, v4, v4 row_ror:2 row_mask:0xf bank_mask:0xf
    s_nop 1
    v_add_f32_dpp v4, v4, v4 row_ror:1 row_mask:0xf bank_mask:0xf
    v_cvt_pk_bf16_f32 v4, v4, v4
    v_lshlrev_b32 v4, 16, v4
    v_mul_f32 v5, 0xbfb8aa3b, v4
    v_exp_f32 v5, v5
    s_nop 0
    v_add_f32 v5, 1.0, v5
    v_rcp_f32 v5, v5
    s_nop 0
    v_cvt_pk_bf16_f32 v5, v5, v5
    v_lshlrev_b32 v11, 16, v5
    s_lshl_b32 s5, s95, 2
    s_add_u32 s5, s5, 32
    buffer_store_dword v11, v6, s[68:71], s5 offen sc1
    v_mov_b32 v4, 0
    v_mov_b32 v5, 0
    s_waitcnt vmcnt(3)
    v_lshlrev_b32 v30, 16, v160
    v_and_b32 v31, s6, v160
    v_mul_f32 v30, v30, v60
    v_mul_f32 v31, v31, v61
    v_cvt_pk_bf16_f32 v32, v30, v31
    v_lshlrev_b32 v30, 16, v32
    v_and_b32 v31, s6, v32
    v_add_f32 v4, v4, v30
    v_add_f32 v5, v5, v31
    v_lshlrev_b32 v34, 16, v161
    v_and_b32 v35, s6, v161
    v_mul_f32 v34, v34, v62
    v_mul_f32 v35, v35, v63
    v_cvt_pk_bf16_f32 v36, v34, v35
    v_lshlrev_b32 v34, 16, v36
    v_and_b32 v35, s6, v36
    v_add_f32 v4, v4, v34
    v_add_f32 v5, v5, v35
    v_lshlrev_b32 v30, 16, v162
    v_and_b32 v31, s6, v162
    v_mul_f32 v30, v30, v64
    v_mul_f32 v31, v31, v65
    v_cvt_pk_bf16_f32 v32, v30, v31
    v_lshlrev_b32 v30, 16, v32
    v_and_b32 v31, s6, v32
    v_add_f32 v4, v4, v30
    v_add_f32 v5, v5, v31
    v_lshlrev_b32 v34, 16, v163
    v_and_b32 v35, s6, v163
    v_mul_f32 v34, v34, v66
    v_mul_f32 v35, v35, v67
    v_cvt_pk_bf16_f32 v36, v34, v35
    v_lshlrev_b32 v34, 16, v36
    v_and_b32 v35, s6, v36
    v_add_f32 v4, v4, v34
    v_add_f32 v5, v5, v35
    v_lshlrev_b32 v30, 16, v164
    v_and_b32 v31, s6, v164
    v_mul_f32 v30, v30, v68
    v_mul_f32 v31, v31, v69
    v_cvt_pk_bf16_f32 v32, v30, v31
    v_lshlrev_b32 v30, 16, v32
    v_and_b32 v31, s6, v32
    v_add_f32 v4, v4, v30
    v_add_f32 v5, v5, v31
    v_lshlrev_b32 v34, 16, v165
    v_and_b32 v35, s6, v165
    v_mul_f32 v34, v34, v70
    v_mul_f32 v35, v35, v71
    v_cvt_pk_bf16_f32 v36, v34, v35
    v_lshlrev_b32 v34, 16, v36
    v_and_b32 v35, s6, v36
    v_add_f32 v4, v4, v34
    v_add_f32 v5, v5, v35
    v_lshlrev_b32 v30, 16, v166
    v_and_b32 v31, s6, v166
    v_mul_f32 v30, v30, v72
    v_mul_f32 v31, v31, v73
    v_cvt_pk_bf16_f32 v32, v30, v31
    v_lshlrev_b32 v30, 16, v32
    v_and_b32 v31, s6, v32
    v_add_f32 v4, v4, v30
    v_add_f32 v5, v5, v31
    v_lshlrev_b32 v34, 16, v167
    v_and_b32 v35, s6, v167
    v_mul_f32 v34, v34, v74
    v_mul_f32 v35, v35, v75
    v_cvt_pk_bf16_f32 v36, v34, v35
    v_lshlrev_b32 v34, 16, v36
    v_and_b32 v35, s6, v36
    v_add_f32 v4, v4, v34
    v_add_f32 v5, v5, v35
    v_lshlrev_b32 v30, 16, v168
    v_and_b32 v31, s6, v168
    v_mul_f32 v30, v30, v76
    v_mul_f32 v31, v31, v77
    v_cvt_pk_bf16_f32 v32, v30, v31
    v_lshlrev_b32 v30, 16, v32
    v_and_b32 v31, s6, v32
    v_add_f32 v4, v4, v30
    v_add_f32 v5, v5, v31
    v_lshlrev_b32 v34, 16, v169
    v_and_b32 v35, s6, v169
    v_mul_f32 v34, v34, v78
    v_mul_f32 v35, v35, v79
    v_cvt_pk_bf16_f32 v36, v34, v35
    v_lshlrev_b32 v34, 16, v36
    v_and_b32 v35, s6, v36
    v_add_f32 v4, v4, v34
    v_add_f32 v5, v5, v35
    v_lshlrev_b32 v30, 16, v170
    v_and_b32 v31, s6, v170
    v_mul_f32 v30, v30, v80
    v_mul_f32 v31, v31, v81
    v_cvt_pk_bf16_f32 v32, v30, v31
    v_lshlrev_b32 v30, 16, v32
    v_and_b32 v31, s6, v32
    v_add_f32 v4, v4, v30
    v_add_f32 v5, v5, v31
    v_lshlrev_b32 v34, 16, v171
    v_and_b32 v35, s6, v171
    v_mul_f32 v34, v34, v82
    v_mul_f32 v35, v35, v83
    v_cvt_pk_bf16_f32 v36, v34, v35
    v_lshlrev_b32 v34, 16, v36
    v_and_b32 v35, s6, v36
    v_add_f32 v4, v4, v34
    v_add_f32 v5, v5, v35
    v_lshlrev_b32 v30, 16, v172
    v_and_b32 v31, s6, v172
    v_mul_f32 v30, v30, v84
    v_mul_f32 v31, v31, v85
    v_cvt_pk_bf16_f32 v32, v30, v31
    v_lshlrev_b32 v30, 16, v32
    v_and_b32 v31, s6, v32
    v_add_f32 v4, v4, v30
    v_add_f32 v5, v5, v31
    v_lshlrev_b32 v34, 16, v173
    v_and_b32 v35, s6, v173
    v_mul_f32 v34, v34, v86
    v_mul_f32 v35, v35, v87
    v_cvt_pk_bf16_f32 v36, v34, v35
    v_lshlrev_b32 v34, 16, v36
    v_and_b32 v35, s6, v36
    v_add_f32 v4, v4, v34
    v_add_f32 v5, v5, v35
    v_lshlrev_b32 v30, 16, v174
    v_and_b32 v31, s6, v174
    v_mul_f32 v30, v30, v88
    v_mul_f32 v31, v31, v89
    v_cvt_pk_bf16_f32 v32, v30, v31
    v_lshlrev_b32 v30, 16, v32
    v_and_b32 v31, s6, v32
    v_add_f32 v4, v4, v30
    v_add_f32 v5, v5, v31
    v_lshlrev_b32 v34, 16, v175
    v_and_b32 v35, s6, v175
    v_mul_f32 v34, v34, v90
    v_mul_f32 v35, v35, v91
    v_cvt_pk_bf16_f32 v36, v34, v35
    v_lshlrev_b32 v34, 16, v36
    v_and_b32 v35, s6, v36
    v_add_f32 v4, v4, v34
    v_add_f32 v5, v5, v35
    v_lshlrev_b32 v30, 16, v176
    v_and_b32 v31, s6, v176
    v_mul_f32 v30, v30, v92
    v_mul_f32 v31, v31, v93
    v_cvt_pk_bf16_f32 v32, v30, v31
    v_lshlrev_b32 v30, 16, v32
    v_and_b32 v31, s6, v32
    v_add_f32 v4, v4, v30
    v_add_f32 v5, v5, v31
    v_lshlrev_b32 v34, 16, v177
    v_and_b32 v35, s6, v177
    v_mul_f32 v34, v34, v94
    v_mul_f32 v35, v35, v95
    v_cvt_pk_bf16_f32 v36, v34, v35
    v_lshlrev_b32 v34, 16, v36
    v_and_b32 v35, s6, v36
    v_add_f32 v4, v4, v34
    v_add_f32 v5, v5, v35
    v_lshlrev_b32 v30, 16, v178
    v_and_b32 v31, s6, v178
    v_mul_f32 v30, v30, v96
    v_mul_f32 v31, v31, v97
    v_cvt_pk_bf16_f32 v32, v30, v31
    v_lshlrev_b32 v30, 16, v32
    v_and_b32 v31, s6, v32
    v_add_f32 v4, v4, v30
    v_add_f32 v5, v5, v31
    v_lshlrev_b32 v34, 16, v179
    v_and_b32 v35, s6, v179
    v_mul_f32 v34, v34, v98
    v_mul_f32 v35, v35, v99
    v_cvt_pk_bf16_f32 v36, v34, v35
    v_lshlrev_b32 v34, 16, v36
    v_and_b32 v35, s6, v36
    v_add_f32 v4, v4, v34
    v_add_f32 v5, v5, v35
    v_add_f32 v4, v4, v5
    s_nop 1
    v_add_f32_dpp v4, v4, v4 row_ror:8 row_mask:0xf bank_mask:0xf
    s_nop 1
    v_add_f32_dpp v4, v4, v4 row_ror:4 row_mask:0xf bank_mask:0xf
    s_nop 1
    v_add_f32_dpp v4, v4, v4 row_ror:2 row_mask:0xf bank_mask:0xf
    s_nop 1
    v_add_f32_dpp v4, v4, v4 row_ror:1 row_mask:0xf bank_mask:0xf
    v_cvt_pk_bf16_f32 v4, v4, v4
    v_lshlrev_b32 v4, 16, v4
    v_mul_f32 v5, 0xbfb8aa3b, v4
    v_exp_f32 v5, v5
    s_nop 0
    v_add_f32 v5, 1.0, v5
    v_rcp_f32 v5, v5
    s_nop 0
    v_cvt_pk_bf16_f32 v5, v5, v5
    v_lshlrev_b32 v12, 16, v5
    s_lshl_b32 s5, s95, 2
    s_add_u32 s5, s5, 48
    buffer_store_dword v12, v6, s[68:71], s5 offen sc1
    s_lshl_b32 s9, s94, 2
    s_add_u32 s9, s9, 5120
    s_waitcnt vmcnt(0)
    s_barrier
    s_cmp_lg_u32 s3, 0
    s_cbranch_scc1 sig_43
    s_add_u32 s12, s46, 16842752
    s_addc_u32 s13, s47, 0
    s_mov_b32 s14, 8192
    s_mov_b32 s15, 0x00020000
    v_mov_b32 v24, s101
    v_mov_b32 v25, 0
    s_mov_b64 exec, 1
    buffer_store_dword v24, v25, s[12:15], s9 offen sc1
    s_mov_b64 exec, -1
sig_43:
fz_G2:
    s_setprio 0
    s_lshl_b32 s14, s92, 2
    s_and_b32 s15, s93, 3
    s_add_u32 s98, s14, s15
    s_lshr_b32 s99, s93, 2
    s_mov_b32 s97, 0
    s_add_u32 s48, s46, 3145728
    s_addc_u32 s49, s47, 0
    s_mov_b32 s50, 7077888
    s_mov_b32 s51, 0x00020000
    s_add_u32 s52, s46, 10485760
    s_addc_u32 s53, s47, 0
    s_mov_b32 s54, 2211840
    s_mov_b32 s55, 0x00020000
    s_add_u32 s56, s46, 13631488
    s_addc_u32 s57, s47, 0
    s_mov_b32 s58, 2621440
    s_mov_b32 s59, 0x00020000
    s_mov_b32 s60, s42
    s_mov_b32 s61, s43
    s_mov_b32 s62, 2621440
    s_mov_b32 s63, 0x00020000
    s_add_u32 s64, s46, 16777216
    s_addc_u32 s65, s47, 0
    s_mov_b32 s66, 8192
    s_mov_b32 s67, 0x00020000
    s_mov_b32 s68, s38
    s_mov_b32 s69, s39
    s_mov_b32 s70, 1280
    s_mov_b32 s71, 0x00020000
    v_lshlrev_b32 v1, 4, v0
    v_add_u32 v156, 4096, v1
    v_add_u32 v152, 0, v1
    v_add_u32 v153, 55296, v1
    v_add_u32 v154, 110592, v1
    v_add_u32 v155, 165888, v1
    v_lshrrev_b32 v3, 4, v0
    v_lshlrev_b32 v3, 3, v3
    s_mul_i32 s7, s99, 160
    buffer_load_dwordx2 v[160:161], v3, s[68:71], s7 offen offset:0
    buffer_load_dwordx2 v[162:163], v3, s[68:71], s7 offen offset:32
    buffer_load_dwordx2 v[164:165], v3, s[68:71], s7 offen offset:64
    buffer_load_dwordx2 v[166:167], v3, s[68:71], s7 offen offset:96
    buffer_load_dwordx2 v[168:169], v3, s[68:71], s7 offen offset:128
    s_mul_i32 s4, s99, 276480
    s_mul_i32 s5, s98, 221184
    s_add_u32 s8, s97, s3
    s_cmp_ge_u32 s8, 54
    s_cselect_b32 s10, 54, 0
    s_sub_u32 s8, s8, s10
    s_mov_b32 s9, s8
    v_mov_b32 v176, 0
    v_mov_b32 v177, 0
    v_mov_b32 v178, 0
    v_mov_b32 v179, 0
    v_mov_b32 v180, 0
    v_mov_b32 v181, 0
    v_mov_b32 v182, 0
    v_mov_b32 v183, 0
    v_mov_b32 v184, 0
    v_mov_b32 v185, 0
    v_mov_b32 v186, 0
    v_mov_b32 v187, 0
    v_mov_b32 v188, 0
    v_mov_b32 v189, 0
    v_mov_b32 v190, 0
    v_mov_b32 v191, 0
    v_mov_b32 v192, 0
    v_mov_b32 v193, 0
    v_mov_b32 v194, 0
    v_mov_b32 v195, 0
    v_mov_b32 v196, 0
    v_mov_b32 v197, 0
    v_mov_b32 v198, 0
    v_mov_b32 v199, 0
    v_mov_b32 v200, 0
    v_mov_b32 v201, 0
    v_mov_b32 v202, 0
    v_mov_b32 v203, 0
    v_mov_b32 v204, 0
    v_mov_b32 v205, 0
    v_mov_b32 v206, 0
    v_mov_b32 v207, 0
    v_mov_b32 v208, 0
    v_mov_b32 v209, 0
    v_mov_b32 v210, 0
    v_mov_b32 v211, 0
    v_mov_b32 v212, 0
    v_mov_b32 v213, 0
    v_mov_b32 v214, 0
    v_mov_b32 v215, 0
    v_mov_b32 v216, 0
    v_mov_b32 v217, 0
    v_mov_b32 v218, 0
    v_mov_b32 v219, 0
    v_mov_b32 v220, 0
    v_mov_b32 v221, 0
    v_mov_b32 v222, 0
    v_mov_b32 v223, 0
    v_mov_b32 v224, 0
    v_mov_b32 v225, 0
    v_mov_b32 v226, 0
    v_mov_b32 v227, 0
    v_mov_b32 v228, 0
    v_mov_b32 v229, 0
    v_mov_b32 v230, 0
    v_mov_b32 v231, 0
    v_mov_b32 v232, 0
    v_mov_b32 v233, 0
    v_mov_b32 v234, 0
    v_mov_b32 v235, 0
    v_mov_b32 v236, 0
    v_mov_b32 v237, 0
    v_mov_b32 v238, 0
    v_mov_b32 v239, 0
    v_mov_b32 v240, 0
    v_mov_b32 v241, 0
    v_mov_b32 v242, 0
    v_mov_b32 v243, 0
    v_mov_b32 v244, 0
    v_mov_b32 v245, 0
    v_mov_b32 v246, 0
    v_mov_b32 v247, 0
    v_mov_b32 v248, 0
    v_mov_b32 v249, 0
    v_mov_b32 v250, 0
    v_mov_b32 v251, 0
    v_mov_b32 v252, 0
    v_mov_b32 v253, 0
    v_mov_b32 v254, 0
    v_mov_b32 v255, 0
    s_mul_i32 s95, s99, 54
    s_mul_i32 s95, s95, 4682
    s_lshr_b32 s95, s95, 16
    s_min_u32 s95, s95, 26
    s_lshl_b32 s95, s95, 2
    s_add_u32 s95, s95, 1536
    s_cmp_lg_u32 s3, 0
    s_cbranch_scc1 pollw_45
    s_add_u32 s12, s46, 16842752
    s_addc_u32 s13, s47, 0
    s_mov_b32 s14, 8192
    s_mov_b32 s15, 0x00020000
    v_lshlrev_b32 v159, 2, v0
    s_mov_b32 s10, 400000
poll_46:
    buffer_load_dword v158, v159, s[12:15], s95 offen sc1
    s_waitcnt vmcnt(0)
    v_cmp_eq_u32 vcc, s101, v158
    s_sub_u32 s10, s10, 1
    s_cmp_eq_u32 s10, 0
    s_cbranch_scc1 pollto_48
    s_and_b32 s11, vcc_lo, 0x1f
    s_cmp_eq_u32 s11, 0x1f
    s_cbranch_scc1 polld_47
    s_sleep 1
    s_branch poll_46
pollto_48:
polld_47:
pollw_45:
    s_barrier
w2ok_44:
    s_mul_i32 s6, s8, 5120
    s_add_u32 s6, s6, s4
    buffer_load_dwordx4 v[8:11], v1, s[52:55], s6 offen offset:0 sc1
    buffer_load_dwordx4 v[12:15], v1, s[52:55], s6 offen offset:1024 sc1
    buffer_load_dwordx4 v[16:19], v1, s[52:55], s6 offen offset:2048 sc1
    buffer_load_dwordx4 v[20:23], v1, s[52:55], s6 offen offset:3072 sc1
    buffer_load_dwordx4 v[24:27], v156, s[52:55], s6 offen sc1
    s_add_u32 s8, s8, 4
    s_cmp_ge_u32 s8, 54
    s_cselect_b32 s10, 54, 0
    s_sub_u32 s8, s8, s10
    s_mul_i32 s6, s8, 5120
    s_add_u32 s6, s6, s4
    buffer_load_dwordx4 v[44:47], v1, s[52:55], s6 offen offset:0 sc1
    buffer_load_dwordx4 v[48:51], v1, s[52:55], s6 offen offset:1024 sc1
    buffer_load_dwordx4 v[52:55], v1, s[52:55], s6 offen offset:2048 sc1
    buffer_load_dwordx4 v[56:59], v1, s[52:55], s6 offen offset:3072 sc1
    buffer_load_dwordx4 v[60:63], v156, s[52:55], s6 offen sc1
    s_add_u32 s8, s8, 4
    s_cmp_ge_u32 s8, 54
    s_cselect_b32 s10, 54, 0
    s_sub_u32 s8, s8, s10
    s_mul_i32 s6, s8, 5120
    s_add_u32 s6, s6, s4
    buffer_load_dwordx4 v[80:83], v1, s[52:55], s6 offen offset:0 sc1
    buffer_load_dwordx4 v[84:87], v1, s[52:55], s6 offen offset:1024 sc1
    buffer_load_dwordx4 v[88:91], v1, s[52:55], s6 offen offset:2048 sc1
    buffer_load_dwordx4 v[92:95], v1, s[52:55], s6 offen offset:3072 sc1
    buffer_load_dwordx4 v[96:99], v156, s[52:55], s6 offen sc1
    s_add_u32 s8, s8, 4
    s_cmp_ge_u32 s8, 54
    s_cselect_b32 s10, 54, 0
    s_sub_u32 s8, s8, s10
    s_lshr_b32 s95, s98, 1
    s_lshl_b32 s95, s95, 7
    s_add_u32 s95, s95, 2048
    s_cmp_lg_u32 s3, 0
    s_cbranch_scc1 pollw_49
    s_add_u32 s12, s46, 16842752
    s_addc_u32 s13, s47, 0
    s_mov_b32 s14, 8192
    s_mov_b32 s15, 0x00020000
    v_lshlrev_b32 v159, 2, v0
    s_mov_b32 s10, 400000
poll_50:
    buffer_load_dword v158, v159, s[12:15], s95 offen sc1
    s_waitcnt vmcnt(0)
    v_cmp_eq_u32 vcc, s101, v158
    s_sub_u32 s10, s10, 1
    s_cmp_eq_u32 s10, 0
    s_cbranch_scc1 pollto_52
    s_and_b32 s11, vcc_lo, 0x3fff
    s_cmp_eq_u32 s11, 0x3fff
    s_cbranch_scc1 polld_51
    s_sleep 1
    s_branch poll_50
pollto_52:
polld_51:
pollw_49:
    s_barrier
    s_lshl_b32 s7, s9, 10
    s_add_u32 s7, s7, s5
    buffer_load_dwordx4 v[28:31], v152, s[48:51], s7 offen sc1
    buffer_load_dwordx4 v[32:35], v153, s[48:51], s7 offen sc1
    buffer_load_dwordx4 v[36:39], v154, s[48:51], s7 offen sc1
    buffer_load_dwordx4 v[40:43], v155, s[48:51], s7 offen sc1
    s_add_u32 s9, s9, 4
    s_cmp_ge_u32 s9, 54
    s_cselect_b32 s10, 54, 0
    s_sub_u32 s9, s9, s10
    s_lshl_b32 s7, s9, 10
    s_add_u32 s7, s7, s5
    buffer_load_dwordx4 v[64:67], v152, s[48:51], s7 offen sc1
    buffer_load_dwordx4 v[68:71], v153, s[48:51], s7 offen sc1
    buffer_load_dwordx4 v[72:75], v154, s[48:51], s7 offen sc1
    buffer_load_dwordx4 v[76:79], v155, s[48:51], s7 offen sc1
    s_add_u32 s9, s9, 4
    s_cmp_ge_u32 s9, 54
    s_cselect_b32 s10, 54, 0
    s_sub_u32 s9, s9, s10
    s_lshl_b32 s7, s9, 10
    s_add_u32 s7, s7, s5
    buffer_load_dwordx4 v[100:103], v152, s[48:51], s7 offen sc1
    buffer_load_dwordx4 v[104:107], v153, s[48:51], s7 offen sc1
    buffer_load_dwordx4 v[108:111], v154, s[48:51], s7 offen sc1
    buffer_load_dwordx4 v[112:115], v155, s[48:51], s7 offen sc1
    s_add_u32 s9, s9, 4
    s_cmp_ge_u32 s9, 54
    s_cselect_b32 s10, 54, 0
    s_sub_u32 s9, s9, s10
    s_waitcnt vmcnt(8)
    v_mfma_f32_16x16x32_bf16 v[176:179], v[8:11], v[28:31], v[176:179]
    s_mul_i32 s6, s8, 5120
    v_mfma_f32_16x16x32_bf16 v[180:183], v[12:15], v[28:31], v[180:183]
    s_add_u32 s6, s6, s4
    v_mfma_f32_16x16x32_bf16 v[184:187], v[16:19], v[28:31], v[184:187]
    buffer_load_dwordx4 v[116:119], v1, s[52:55], s6 offen offset:0 sc1
    v_mfma_f32_16x16x32_bf16 v[188:191], v[20:23], v[28:31], v[188:191]
    buffer_load_dwordx4 v[120:123], v1, s[52:55], s6 offen offset:1024 sc1
    v_mfma_f32_16x16x32_bf16 v[192:195], v[24:27], v[28:31], v[192:195]
    buffer_load_dwordx4 v[124:127], v1, s[52:55], s6 offen offset:2048 sc1
    v_mfma_f32_16x16x32_bf16 v[196:199], v[8:11], v[32:35], v[196:199]
    buffer_load_dwordx4 v[128:131], v1, s[52:55], s6 offen offset:3072 sc1
    v_mfma_f32_16x16x32_bf16 v[200:203], v[12:15], v[32:35], v[200:203]
    buffer_load_dwordx4 v[132:135], v156, s[52:55], s6 offen sc1
    v_mfma_f32_16x16x32_bf16 v[204:207], v[16:19], v[32:35], v[204:207]
    s_add_u32 s8, s8, 4
    v_mfma_f32_16x16x32_bf16 v[208:211], v[20:23], v[32:35], v[208:211]
    s_cmp_ge_u32 s8, 54
    v_mfma_f32_16x16x32_bf16 v[212:215], v[24:27], v[32:35], v[212:215]
    s_cselect_b32 s10, 54, 0
    v_mfma_f32_16x16x32_bf16 v[216:219], v[8:11], v[36:39], v[216:219]
    s_sub_u32 s8, s8, s10
    v_mfma_f32_16x16x32_bf16 v[220:223], v[12:15], v[36:39], v[220:223]
    s_lshl_b32 s7, s9, 10
    v_mfma_f32_16x16x32_bf16 v[224:227], v[16:19], v[36:39], v[224:227]
    s_add_u32 s7, s7, s5
    v_mfma_f32_16x16x32_bf16 v[228:231], v[20:23], v[36:39], v[228:231]
    buffer_load_dwordx4 v[136:139], v152, s[48:51], s7 offen sc1
    v_mfma_f32_16x16x32_bf16 v[232:235], v[24:27], v[36:39], v[232:235]
    buffer_load_dwordx4 v[140:143], v153, s[48:51], s7 offen sc1
    v_mfma_f32_16x16x32_bf16 v[236:239], v[8:11], v[40:43], v[236:239]
    buffer_load_dwordx4 v[144:147], v154, s[48:51], s7 offen sc1
    v_mfma_f32_16x16x32_bf16 v[240:243], v[12:15], v[40:43], v[240:243]
    buffer_load_dwordx4 v[148:151], v155, s[48:51], s7 offen sc1
    v_mfma_f32_16x16x32_bf16 v[244:247], v[16:19], v[40:43], v[244:247]
    s_add_u32 s9, s9, 4
    v_mfma_f32_16x16x32_bf16 v[248:251], v[20:23], v[40:43], v[248:251]
    s_cmp_ge_u32 s9, 54
    v_mfma_f32_16x16x32_bf16 v[252:255], v[24:27], v[40:43], v[252:255]
    s_cselect_b32 s10, 54, 0
    s_sub_u32 s9, s9, s10
    s_waitcnt vmcnt(13)
    v_mfma_f32_16x16x32_bf16 v[176:179], v[44:47], v[64:67], v[176:179]
    s_mul_i32 s6, s8, 5120
    v_mfma_f32_16x16x32_bf16 v[180:183], v[48:51], v[64:67], v[180:183]
    s_add_u32 s6, s6, s4
    v_mfma_f32_16x16x32_bf16 v[184:187], v[52:55], v[64:67], v[184:187]
    buffer_load_dwordx4 v[8:11], v1, s[52:55], s6 offen offset:0 sc1
    v_mfma_f32_16x16x32_bf16 v[188:191], v[56:59], v[64:67], v[188:191]
    buffer_load_dwordx4 v[12:15], v1, s[52:55], s6 offen offset:1024 sc1
    v_mfma_f32_16x16x32_bf16 v[192:195], v[60:63], v[64:67], v[192:195]
    buffer_load_dwordx4 v[16:19], v1, s[52:55], s6 offen offset:2048 sc1
    v_mfma_f32_16x16x32_bf16 v[196:199], v[44:47], v[68:71], v[196:199]
    buffer_load_dwordx4 v[20:23], v1, s[52:55], s6 offen offset:3072 sc1
    v_mfma_f32_16x16x32_bf16 v[200:203], v[48:51], v[68:71], v[200:203]
    buffer_load_dwordx4 v[24:27], v156, s[52:55], s6 offen sc1
    v_mfma_f32_16x16x32_bf16 v[204:207], v[52:55], v[68:71], v[204:207]
    s_add_u32 s8, s8, 4
    v_mfma_f32_16x16x32_bf16 v[208:211], v[56:59], v[68:71], v[208:211]
    s_cmp_ge_u32 s8, 54
    v_mfma_f32_16x16x32_bf16 v[212:215], v[60:63], v[68:71], v[212:215]
    s_cselect_b32 s10, 54, 0
    v_mfma_f32_16x16x32_bf16 v[216:219], v[44:47], v[72:75], v[216:219]
    s_sub_u32 s8, s8, s10
    v_mfma_f32_16x16x32_bf16 v[220:223], v[48:51], v[72:75], v[220:223]
    s_lshl_b32 s7, s9, 10
    v_mfma_f32_16x16x32_bf16 v[224:227], v[52:55], v[72:75], v[224:227]
    s_add_u32 s7, s7, s5
    v_mfma_f32_16x16x32_bf16 v[228:231], v[56:59], v[72:75], v[228:231]
    buffer_load_dwordx4 v[28:31], v152, s[48:51], s7 offen sc1
    v_mfma_f32_16x16x32_bf16 v[232:235], v[60:63], v[72:75], v[232:235]
    buffer_load_dwordx4 v[32:35], v153, s[48:51], s7 offen sc1
    v_mfma_f32_16x16x32_bf16 v[236:239], v[44:47], v[76:79], v[236:239]
    buffer_load_dwordx4 v[36:39], v154, s[48:51], s7 offen sc1
    v_mfma_f32_16x16x32_bf16 v[240:243], v[48:51], v[76:79], v[240:243]
    buffer_load_dwordx4 v[40:43], v155, s[48:51], s7 offen sc1
    v_mfma_f32_16x16x32_bf16 v[244:247], v[52:55], v[76:79], v[244:247]
    s_add_u32 s9, s9, 4
    v_mfma_f32_16x16x32_bf16 v[248:251], v[56:59], v[76:79], v[248:251]
    s_cmp_ge_u32 s9, 54
    v_mfma_f32_16x16x32_bf16 v[252:255], v[60:63], v[76:79], v[252:255]
    s_cselect_b32 s10, 54, 0
    s_sub_u32 s9, s9, s10
    s_waitcnt vmcnt(18)
    v_mfma_f32_16x16x32_bf16 v[176:179], v[80:83], v[100:103], v[176:179]
    s_mul_i32 s6, s8, 5120
    v_mfma_f32_16x16x32_bf16 v[180:183], v[84:87], v[100:103], v[180:183]
    s_add_u32 s6, s6, s4
    v_mfma_f32_16x16x32_bf16 v[184:187], v[88:91], v[100:103], v[184:187]
    buffer_load_dwordx4 v[44:47], v1, s[52:55], s6 offen offset:0 sc1
    v_mfma_f32_16x16x32_bf16 v[188:191], v[92:95], v[100:103], v[188:191]
    buffer_load_dwordx4 v[48:51], v1, s[52:55], s6 offen offset:1024 sc1
    v_mfma_f32_16x16x32_bf16 v[192:195], v[96:99], v[100:103], v[192:195]
    buffer_load_dwordx4 v[52:55], v1, s[52:55], s6 offen offset:2048 sc1
    v_mfma_f32_16x16x32_bf16 v[196:199], v[80:83], v[104:107], v[196:199]
    buffer_load_dwordx4 v[56:59], v1, s[52:55], s6 offen offset:3072 sc1
    v_mfma_f32_16x16x32_bf16 v[200:203], v[84:87], v[104:107], v[200:203]
    buffer_load_dwordx4 v[60:63], v156, s[52:55], s6 offen sc1
    v_mfma_f32_16x16x32_bf16 v[204:207], v[88:91], v[104:107], v[204:207]
    s_add_u32 s8, s8, 4
    v_mfma_f32_16x16x32_bf16 v[208:211], v[92:95], v[104:107], v[208:211]
    s_cmp_ge_u32 s8, 54
    v_mfma_f32_16x16x32_bf16 v[212:215], v[96:99], v[104:107], v[212:215]
    s_cselect_b32 s10, 54, 0
    v_mfma_f32_16x16x32_bf16 v[216:219], v[80:83], v[108:111], v[216:219]
    s_sub_u32 s8, s8, s10
    v_mfma_f32_16x16x32_bf16 v[220:223], v[84:87], v[108:111], v[220:223]
    s_lshl_b32 s7, s9, 10
    v_mfma_f32_16x16x32_bf16 v[224:227], v[88:91], v[108:111], v[224:227]
    s_add_u32 s7, s7, s5
    v_mfma_f32_16x16x32_bf16 v[228:231], v[92:95], v[108:111], v[228:231]
    buffer_load_dwordx4 v[64:67], v152, s[48:51], s7 offen sc1
    v_mfma_f32_16x16x32_bf16 v[232:235], v[96:99], v[108:111], v[232:235]
    buffer_load_dwordx4 v[68:71], v153, s[48:51], s7 offen sc1
    v_mfma_f32_16x16x32_bf16 v[236:239], v[80:83], v[112:115], v[236:239]
    buffer_load_dwordx4 v[72:75], v154, s[48:51], s7 offen sc1
    v_mfma_f32_16x16x32_bf16 v[240:243], v[84:87], v[112:115], v[240:243]
    buffer_load_dwordx4 v[76:79], v155, s[48:51], s7 offen sc1
    v_mfma_f32_16x16x32_bf16 v[244:247], v[88:91], v[112:115], v[244:247]
    s_add_u32 s9, s9, 4
    v_mfma_f32_16x16x32_bf16 v[248:251], v[92:95], v[112:115], v[248:251]
    s_cmp_ge_u32 s9, 54
    v_mfma_f32_16x16x32_bf16 v[252:255], v[96:99], v[112:115], v[252:255]
    s_cselect_b32 s10, 54, 0
    s_sub_u32 s9, s9, s10
    s_waitcnt vmcnt(18)
    v_mfma_f32_16x16x32_bf16 v[176:179], v[116:119], v[136:139], v[176:179]
    s_mul_i32 s6, s8, 5120
    v_mfma_f32_16x16x32_bf16 v[180:183], v[120:123], v[136:139], v[180:183]
    s_add_u32 s6, s6, s4
    v_mfma_f32_16x16x32_bf16 v[184:187], v[124:127], v[136:139], v[184:187]
    buffer_load_dwordx4 v[80:83], v1, s[52:55], s6 offen offset:0 sc1
    v_mfma_f32_16x16x32_bf16 v[188:191], v[128:131], v[136:139], v[188:191]
    buffer_load_dwordx4 v[84:87], v1, s[52:55], s6 offen offset:1024 sc1
    v_mfma_f32_16x16x32_bf16 v[192:195], v[132:135], v[136:139], v[192:195]
    buffer_load_dwordx4 v[88:91], v1, s[52:55], s6 offen offset:2048 sc1
    v_mfma_f32_16x16x32_bf16 v[196:199], v[116:119], v[140:143], v[196:199]
    buffer_load_dwordx4 v[92:95], v1, s[52:55], s6 offen offset:3072 sc1
    v_mfma_f32_16x16x32_bf16 v[200:203], v[120:123], v[140:143], v[200:203]
    buffer_load_dwordx4 v[96:99], v156, s[52:55], s6 offen sc1
    v_mfma_f32_16x16x32_bf16 v[204:207], v[124:127], v[140:143], v[204:207]
    s_add_u32 s8, s8, 4
    v_mfma_f32_16x16x32_bf16 v[208:211], v[128:131], v[140:143], v[208:211]
    s_cmp_ge_u32 s8, 54
    v_mfma_f32_16x16x32_bf16 v[212:215], v[132:135], v[140:143], v[212:215]
    s_cselect_b32 s10, 54, 0
    v_mfma_f32_16x16x32_bf16 v[216:219], v[116:119], v[144:147], v[216:219]
    s_sub_u32 s8, s8, s10
    v_mfma_f32_16x16x32_bf16 v[220:223], v[120:123], v[144:147], v[220:223]
    s_lshl_b32 s7, s9, 10
    v_mfma_f32_16x16x32_bf16 v[224:227], v[124:127], v[144:147], v[224:227]
    s_add_u32 s7, s7, s5
    v_mfma_f32_16x16x32_bf16 v[228:231], v[128:131], v[144:147], v[228:231]
    buffer_load_dwordx4 v[100:103], v152, s[48:51], s7 offen sc1
    v_mfma_f32_16x16x32_bf16 v[232:235], v[132:135], v[144:147], v[232:235]
    buffer_load_dwordx4 v[104:107], v153, s[48:51], s7 offen sc1
    v_mfma_f32_16x16x32_bf16 v[236:239], v[116:119], v[148:151], v[236:239]
    buffer_load_dwordx4 v[108:111], v154, s[48:51], s7 offen sc1
    v_mfma_f32_16x16x32_bf16 v[240:243], v[120:123], v[148:151], v[240:243]
    buffer_load_dwordx4 v[112:115], v155, s[48:51], s7 offen sc1
    v_mfma_f32_16x16x32_bf16 v[244:247], v[124:127], v[148:151], v[244:247]
    s_add_u32 s9, s9, 4
    v_mfma_f32_16x16x32_bf16 v[248:251], v[128:131], v[148:151], v[248:251]
    s_cmp_ge_u32 s9, 54
    v_mfma_f32_16x16x32_bf16 v[252:255], v[132:135], v[148:151], v[252:255]
    s_cselect_b32 s10, 54, 0
    s_sub_u32 s9, s9, s10
    s_waitcnt vmcnt(18)
    v_mfma_f32_16x16x32_bf16 v[176:179], v[8:11], v[28:31], v[176:179]
    s_mul_i32 s6, s8, 5120
    v_mfma_f32_16x16x32_bf16 v[180:183], v[12:15], v[28:31], v[180:183]
    s_add_u32 s6, s6, s4
    v_mfma_f32_16x16x32_bf16 v[184:187], v[16:19], v[28:31], v[184:187]
    buffer_load_dwordx4 v[116:119], v1, s[52:55], s6 offen offset:0 sc1
    v_mfma_f32_16x16x32_bf16 v[188:191], v[20:23], v[28:31], v[188:191]
    buffer_load_dwordx4 v[120:123], v1, s[52:55], s6 offen offset:1024 sc1
    v_mfma_f32_16x16x32_bf16 v[192:195], v[24:27], v[28:31], v[192:195]
    buffer_load_dwordx4 v[124:127], v1, s[52:55], s6 offen offset:2048 sc1
    v_mfma_f32_16x16x32_bf16 v[196:199], v[8:11], v[32:35], v[196:199]
    buffer_load_dwordx4 v[128:131], v1, s[52:55], s6 offen offset:3072 sc1
    v_mfma_f32_16x16x32_bf16 v[200:203], v[12:15], v[32:35], v[200:203]
    buffer_load_dwordx4 v[132:135], v156, s[52:55], s6 offen sc1
    v_mfma_f32_16x16x32_bf16 v[204:207], v[16:19], v[32:35], v[204:207]
    s_add_u32 s8, s8, 4
    v_mfma_f32_16x16x32_bf16 v[208:211], v[20:23], v[32:35], v[208:211]
    s_cmp_ge_u32 s8, 54
    v_mfma_f32_16x16x32_bf16 v[212:215], v[24:27], v[32:35], v[212:215]
    s_cselect_b32 s10, 54, 0
    v_mfma_f32_16x16x32_bf16 v[216:219], v[8:11], v[36:39], v[216:219]
    s_sub_u32 s8, s8, s10
    v_mfma_f32_16x16x32_bf16 v[220:223], v[12:15], v[36:39], v[220:223]
    s_lshl_b32 s7, s9, 10
    v_mfma_f32_16x16x32_bf16 v[224:227], v[16:19], v[36:39], v[224:227]
    s_add_u32 s7, s7, s5
    v_mfma_f32_16x16x32_bf16 v[228:231], v[20:23], v[36:39], v[228:231]
    buffer_load_dwordx4 v[136:139], v152, s[48:51], s7 offen sc1
    v_mfma_f32_16x16x32_bf16 v[232:235], v[24:27], v[36:39], v[232:235]
    buffer_load_dwordx4 v[140:143], v153, s[48:51], s7 offen sc1
    v_mfma_f32_16x16x32_bf16 v[236:239], v[8:11], v[40:43], v[236:239]
    buffer_load_dwordx4 v[144:147], v154, s[48:51], s7 offen sc1
    v_mfma_f32_16x16x32_bf16 v[240:243], v[12:15], v[40:43], v[240:243]
    buffer_load_dwordx4 v[148:151], v155, s[48:51], s7 offen sc1
    v_mfma_f32_16x16x32_bf16 v[244:247], v[16:19], v[40:43], v[244:247]
    s_add_u32 s9, s9, 4
    v_mfma_f32_16x16x32_bf16 v[248:251], v[20:23], v[40:43], v[248:251]
    s_cmp_ge_u32 s9, 54
    v_mfma_f32_16x16x32_bf16 v[252:255], v[24:27], v[40:43], v[252:255]
    s_cselect_b32 s10, 54, 0
    s_sub_u32 s9, s9, s10
    s_waitcnt vmcnt(18)
    v_mfma_f32_16x16x32_bf16 v[176:179], v[44:47], v[64:67], v[176:179]
    s_mul_i32 s6, s8, 5120
    v_mfma_f32_16x16x32_bf16 v[180:183], v[48:51], v[64:67], v[180:183]
    s_add_u32 s6, s6, s4
    v_mfma_f32_16x16x32_bf16 v[184:187], v[52:55], v[64:67], v[184:187]
    buffer_load_dwordx4 v[8:11], v1, s[52:55], s6 offen offset:0 sc1
    v_mfma_f32_16x16x32_bf16 v[188:191], v[56:59], v[64:67], v[188:191]
    buffer_load_dwordx4 v[12:15], v1, s[52:55], s6 offen offset:1024 sc1
    v_mfma_f32_16x16x32_bf16 v[192:195], v[60:63], v[64:67], v[192:195]
    buffer_load_dwordx4 v[16:19], v1, s[52:55], s6 offen offset:2048 sc1
    v_mfma_f32_16x16x32_bf16 v[196:199], v[44:47], v[68:71], v[196:199]
    buffer_load_dwordx4 v[20:23], v1, s[52:55], s6 offen offset:3072 sc1
    v_mfma_f32_16x16x32_bf16 v[200:203], v[48:51], v[68:71], v[200:203]
    buffer_load_dwordx4 v[24:27], v156, s[52:55], s6 offen sc1
    v_mfma_f32_16x16x32_bf16 v[204:207], v[52:55], v[68:71], v[204:207]
    s_add_u32 s8, s8, 4
    v_mfma_f32_16x16x32_bf16 v[208:211], v[56:59], v[68:71], v[208:211]
    s_cmp_ge_u32 s8, 54
    v_mfma_f32_16x16x32_bf16 v[212:215], v[60:63], v[68:71], v[212:215]
    s_cselect_b32 s10, 54, 0
    v_mfma_f32_16x16x32_bf16 v[216:219], v[44:47], v[72:75], v[216:219]
    s_sub_u32 s8, s8, s10
    v_mfma_f32_16x16x32_bf16 v[220:223], v[48:51], v[72:75], v[220:223]
    s_lshl_b32 s7, s9, 10
    v_mfma_f32_16x16x32_bf16 v[224:227], v[52:55], v[72:75], v[224:227]
    s_add_u32 s7, s7, s5
    v_mfma_f32_16x16x32_bf16 v[228:231], v[56:59], v[72:75], v[228:231]
    buffer_load_dwordx4 v[28:31], v152, s[48:51], s7 offen sc1
    v_mfma_f32_16x16x32_bf16 v[232:235], v[60:63], v[72:75], v[232:235]
    buffer_load_dwordx4 v[32:35], v153, s[48:51], s7 offen sc1
    v_mfma_f32_16x16x32_bf16 v[236:239], v[44:47], v[76:79], v[236:239]
    buffer_load_dwordx4 v[36:39], v154, s[48:51], s7 offen sc1
    v_mfma_f32_16x16x32_bf16 v[240:243], v[48:51], v[76:79], v[240:243]
    buffer_load_dwordx4 v[40:43], v155, s[48:51], s7 offen sc1
    v_mfma_f32_16x16x32_bf16 v[244:247], v[52:55], v[76:79], v[244:247]
    s_add_u32 s9, s9, 4
    v_mfma_f32_16x16x32_bf16 v[248:251], v[56:59], v[76:79], v[248:251]
    s_cmp_ge_u32 s9, 54
    v_mfma_f32_16x16x32_bf16 v[252:255], v[60:63], v[76:79], v[252:255]
    s_cselect_b32 s10, 54, 0
    s_sub_u32 s9, s9, s10
    s_waitcnt vmcnt(18)
    v_mfma_f32_16x16x32_bf16 v[176:179], v[80:83], v[100:103], v[176:179]
    s_mul_i32 s6, s8, 5120
    v_mfma_f32_16x16x32_bf16 v[180:183], v[84:87], v[100:103], v[180:183]
    s_add_u32 s6, s6, s4
    v_mfma_f32_16x16x32_bf16 v[184:187], v[88:91], v[100:103], v[184:187]
    buffer_load_dwordx4 v[44:47], v1, s[52:55], s6 offen offset:0 sc1
    v_mfma_f32_16x16x32_bf16 v[188:191], v[92:95], v[100:103], v[188:191]
    buffer_load_dwordx4 v[48:51], v1, s[52:55], s6 offen offset:1024 sc1
    v_mfma_f32_16x16x32_bf16 v[192:195], v[96:99], v[100:103], v[192:195]
    buffer_load_dwordx4 v[52:55], v1, s[52:55], s6 offen offset:2048 sc1
    v_mfma_f32_16x16x32_bf16 v[196:199], v[80:83], v[104:107], v[196:199]
    buffer_load_dwordx4 v[56:59], v1, s[52:55], s6 offen offset:3072 sc1
    v_mfma_f32_16x16x32_bf16 v[200:203], v[84:87], v[104:107], v[200:203]
    buffer_load_dwordx4 v[60:63], v156, s[52:55], s6 offen sc1
    v_mfma_f32_16x16x32_bf16 v[204:207], v[88:91], v[104:107], v[204:207]
    s_add_u32 s8, s8, 4
    v_mfma_f32_16x16x32_bf16 v[208:211], v[92:95], v[104:107], v[208:211]
    s_cmp_ge_u32 s8, 54
    v_mfma_f32_16x16x32_bf16 v[212:215], v[96:99], v[104:107], v[212:215]
    s_cselect_b32 s10, 54, 0
    v_mfma_f32_16x16x32_bf16 v[216:219], v[80:83], v[108:111], v[216:219]
    s_sub_u32 s8, s8, s10
    v_mfma_f32_16x16x32_bf16 v[220:223], v[84:87], v[108:111], v[220:223]
    s_lshl_b32 s7, s9, 10
    v_mfma_f32_16x16x32_bf16 v[224:227], v[88:91], v[108:111], v[224:227]
    s_add_u32 s7, s7, s5
    v_mfma_f32_16x16x32_bf16 v[228:231], v[92:95], v[108:111], v[228:231]
    buffer_load_dwordx4 v[64:67], v152, s[48:51], s7 offen sc1
    v_mfma_f32_16x16x32_bf16 v[232:235], v[96:99], v[108:111], v[232:235]
    buffer_load_dwordx4 v[68:71], v153, s[48:51], s7 offen sc1
    v_mfma_f32_16x16x32_bf16 v[236:239], v[80:83], v[112:115], v[236:239]
    buffer_load_dwordx4 v[72:75], v154, s[48:51], s7 offen sc1
    v_mfma_f32_16x16x32_bf16 v[240:243], v[84:87], v[112:115], v[240:243]
    buffer_load_dwordx4 v[76:79], v155, s[48:51], s7 offen sc1
    v_mfma_f32_16x16x32_bf16 v[244:247], v[88:91], v[112:115], v[244:247]
    s_add_u32 s9, s9, 4
    v_mfma_f32_16x16x32_bf16 v[248:251], v[92:95], v[112:115], v[248:251]
    s_cmp_ge_u32 s9, 54
    v_mfma_f32_16x16x32_bf16 v[252:255], v[96:99], v[112:115], v[252:255]
    s_cselect_b32 s10, 54, 0
    s_sub_u32 s9, s9, s10
    s_waitcnt vmcnt(18)
    v_mfma_f32_16x16x32_bf16 v[176:179], v[116:119], v[136:139], v[176:179]
    s_mul_i32 s6, s8, 5120
    v_mfma_f32_16x16x32_bf16 v[180:183], v[120:123], v[136:139], v[180:183]
    s_add_u32 s6, s6, s4
    v_mfma_f32_16x16x32_bf16 v[184:187], v[124:127], v[136:139], v[184:187]
    buffer_load_dwordx4 v[80:83], v1, s[52:55], s6 offen offset:0 sc1
    v_mfma_f32_16x16x32_bf16 v[188:191], v[128:131], v[136:139], v[188:191]
    buffer_load_dwordx4 v[84:87], v1, s[52:55], s6 offen offset:1024 sc1
    v_mfma_f32_16x16x32_bf16 v[192:195], v[132:135], v[136:139], v[192:195]
    buffer_load_dwordx4 v[88:91], v1, s[52:55], s6 offen offset:2048 sc1
    v_mfma_f32_16x16x32_bf16 v[196:199], v[116:119], v[140:143], v[196:199]
    buffer_load_dwordx4 v[92:95], v1, s[52:55], s6 offen offset:3072 sc1
    v_mfma_f32_16x16x32_bf16 v[200:203], v[120:123], v[140:143], v[200:203]
    buffer_load_dwordx4 v[96:99], v156, s[52:55], s6 offen sc1
    v_mfma_f32_16x16x32_bf16 v[204:207], v[124:127], v[140:143], v[204:207]
    s_add_u32 s8, s8, 4
    v_mfma_f32_16x16x32_bf16 v[208:211], v[128:131], v[140:143], v[208:211]
    s_cmp_ge_u32 s8, 54
    v_mfma_f32_16x16x32_bf16 v[212:215], v[132:135], v[140:143], v[212:215]
    s_cselect_b32 s10, 54, 0
    v_mfma_f32_16x16x32_bf16 v[216:219], v[116:119], v[144:147], v[216:219]
    s_sub_u32 s8, s8, s10
    v_mfma_f32_16x16x32_bf16 v[220:223], v[120:123], v[144:147], v[220:223]
    s_lshl_b32 s7, s9, 10
    v_mfma_f32_16x16x32_bf16 v[224:227], v[124:127], v[144:147], v[224:227]
    s_add_u32 s7, s7, s5
    v_mfma_f32_16x16x32_bf16 v[228:231], v[128:131], v[144:147], v[228:231]
    buffer_load_dwordx4 v[100:103], v152, s[48:51], s7 offen sc1
    v_mfma_f32_16x16x32_bf16 v[232:235], v[132:135], v[144:147], v[232:235]
    buffer_load_dwordx4 v[104:107], v153, s[48:51], s7 offen sc1
    v_mfma_f32_16x16x32_bf16 v[236:239], v[116:119], v[148:151], v[236:239]
    buffer_load_dwordx4 v[108:111], v154, s[48:51], s7 offen sc1
    v_mfma_f32_16x16x32_bf16 v[240:243], v[120:123], v[148:151], v[240:243]
    buffer_load_dwordx4 v[112:115], v155, s[48:51], s7 offen sc1
    v_mfma_f32_16x16x32_bf16 v[244:247], v[124:127], v[148:151], v[244:247]
    s_add_u32 s9, s9, 4
    v_mfma_f32_16x16x32_bf16 v[248:251], v[128:131], v[148:151], v[248:251]
    s_cmp_ge_u32 s9, 54
    v_mfma_f32_16x16x32_bf16 v[252:255], v[132:135], v[148:151], v[252:255]
    s_cselect_b32 s10, 54, 0
    s_sub_u32 s9, s9, s10
    s_waitcnt vmcnt(18)
    v_mfma_f32_16x16x32_bf16 v[176:179], v[8:11], v[28:31], v[176:179]
    s_mul_i32 s6, s8, 5120
    v_mfma_f32_16x16x32_bf16 v[180:183], v[12:15], v[28:31], v[180:183]
    s_add_u32 s6, s6, s4
    v_mfma_f32_16x16x32_bf16 v[184:187], v[16:19], v[28:31], v[184:187]
    buffer_load_dwordx4 v[116:119], v1, s[52:55], s6 offen offset:0 sc1
    v_mfma_f32_16x16x32_bf16 v[188:191], v[20:23], v[28:31], v[188:191]
    buffer_load_dwordx4 v[120:123], v1, s[52:55], s6 offen offset:1024 sc1
    v_mfma_f32_16x16x32_bf16 v[192:195], v[24:27], v[28:31], v[192:195]
    buffer_load_dwordx4 v[124:127], v1, s[52:55], s6 offen offset:2048 sc1
    v_mfma_f32_16x16x32_bf16 v[196:199], v[8:11], v[32:35], v[196:199]
    buffer_load_dwordx4 v[128:131], v1, s[52:55], s6 offen offset:3072 sc1
    v_mfma_f32_16x16x32_bf16 v[200:203], v[12:15], v[32:35], v[200:203]
    buffer_load_dwordx4 v[132:135], v156, s[52:55], s6 offen sc1
    v_mfma_f32_16x16x32_bf16 v[204:207], v[16:19], v[32:35], v[204:207]
    s_add_u32 s8, s8, 4
    v_mfma_f32_16x16x32_bf16 v[208:211], v[20:23], v[32:35], v[208:211]
    s_cmp_ge_u32 s8, 54
    v_mfma_f32_16x16x32_bf16 v[212:215], v[24:27], v[32:35], v[212:215]
    s_cselect_b32 s10, 54, 0
    v_mfma_f32_16x16x32_bf16 v[216:219], v[8:11], v[36:39], v[216:219]
    s_sub_u32 s8, s8, s10
    v_mfma_f32_16x16x32_bf16 v[220:223], v[12:15], v[36:39], v[220:223]
    s_lshl_b32 s7, s9, 10
    v_mfma_f32_16x16x32_bf16 v[224:227], v[16:19], v[36:39], v[224:227]
    s_add_u32 s7, s7, s5
    v_mfma_f32_16x16x32_bf16 v[228:231], v[20:23], v[36:39], v[228:231]
    buffer_load_dwordx4 v[136:139], v152, s[48:51], s7 offen sc1
    v_mfma_f32_16x16x32_bf16 v[232:235], v[24:27], v[36:39], v[232:235]
    buffer_load_dwordx4 v[140:143], v153, s[48:51], s7 offen sc1
    v_mfma_f32_16x16x32_bf16 v[236:239], v[8:11], v[40:43], v[236:239]
    buffer_load_dwordx4 v[144:147], v154, s[48:51], s7 offen sc1
    v_mfma_f32_16x16x32_bf16 v[240:243], v[12:15], v[40:43], v[240:243]
    buffer_load_dwordx4 v[148:151], v155, s[48:51], s7 offen sc1
    v_mfma_f32_16x16x32_bf16 v[244:247], v[16:19], v[40:43], v[244:247]
    s_add_u32 s9, s9, 4
    v_mfma_f32_16x16x32_bf16 v[248:251], v[20:23], v[40:43], v[248:251]
    s_cmp_ge_u32 s9, 54
    v_mfma_f32_16x16x32_bf16 v[252:255], v[24:27], v[40:43], v[252:255]
    s_cselect_b32 s10, 54, 0
    s_sub_u32 s9, s9, s10
    s_waitcnt vmcnt(18)
    v_mfma_f32_16x16x32_bf16 v[176:179], v[44:47], v[64:67], v[176:179]
    s_mul_i32 s6, s8, 5120
    v_mfma_f32_16x16x32_bf16 v[180:183], v[48:51], v[64:67], v[180:183]
    s_add_u32 s6, s6, s4
    v_mfma_f32_16x16x32_bf16 v[184:187], v[52:55], v[64:67], v[184:187]
    buffer_load_dwordx4 v[8:11], v1, s[52:55], s6 offen offset:0 sc1
    v_mfma_f32_16x16x32_bf16 v[188:191], v[56:59], v[64:67], v[188:191]
    buffer_load_dwordx4 v[12:15], v1, s[52:55], s6 offen offset:1024 sc1
    v_mfma_f32_16x16x32_bf16 v[192:195], v[60:63], v[64:67], v[192:195]
    buffer_load_dwordx4 v[16:19], v1, s[52:55], s6 offen offset:2048 sc1
    v_mfma_f32_16x16x32_bf16 v[196:199], v[44:47], v[68:71], v[196:199]
    buffer_load_dwordx4 v[20:23], v1, s[52:55], s6 offen offset:3072 sc1
    v_mfma_f32_16x16x32_bf16 v[200:203], v[48:51], v[68:71], v[200:203]
    buffer_load_dwordx4 v[24:27], v156, s[52:55], s6 offen sc1
    v_mfma_f32_16x16x32_bf16 v[204:207], v[52:55], v[68:71], v[204:207]
    s_add_u32 s8, s8, 4
    v_mfma_f32_16x16x32_bf16 v[208:211], v[56:59], v[68:71], v[208:211]
    s_cmp_ge_u32 s8, 54
    v_mfma_f32_16x16x32_bf16 v[212:215], v[60:63], v[68:71], v[212:215]
    s_cselect_b32 s10, 54, 0
    v_mfma_f32_16x16x32_bf16 v[216:219], v[44:47], v[72:75], v[216:219]
    s_sub_u32 s8, s8, s10
    v_mfma_f32_16x16x32_bf16 v[220:223], v[48:51], v[72:75], v[220:223]
    s_lshl_b32 s7, s9, 10
    v_mfma_f32_16x16x32_bf16 v[224:227], v[52:55], v[72:75], v[224:227]
    s_add_u32 s7, s7, s5
    v_mfma_f32_16x16x32_bf16 v[228:231], v[56:59], v[72:75], v[228:231]
    buffer_load_dwordx4 v[28:31], v152, s[48:51], s7 offen sc1
    v_mfma_f32_16x16x32_bf16 v[232:235], v[60:63], v[72:75], v[232:235]
    buffer_load_dwordx4 v[32:35], v153, s[48:51], s7 offen sc1
    v_mfma_f32_16x16x32_bf16 v[236:239], v[44:47], v[76:79], v[236:239]
    buffer_load_dwordx4 v[36:39], v154, s[48:51], s7 offen sc1
    v_mfma_f32_16x16x32_bf16 v[240:243], v[48:51], v[76:79], v[240:243]
    buffer_load_dwordx4 v[40:43], v155, s[48:51], s7 offen sc1
    v_mfma_f32_16x16x32_bf16 v[244:247], v[52:55], v[76:79], v[244:247]
    s_add_u32 s9, s9, 4
    v_mfma_f32_16x16x32_bf16 v[248:251], v[56:59], v[76:79], v[248:251]
    s_cmp_ge_u32 s9, 54
    v_mfma_f32_16x16x32_bf16 v[252:255], v[60:63], v[76:79], v[252:255]
    s_cselect_b32 s10, 54, 0
    s_sub_u32 s9, s9, s10
    s_waitcnt vmcnt(18)
    v_mfma_f32_16x16x32_bf16 v[176:179], v[80:83], v[100:103], v[176:179]
    s_mul_i32 s6, s8, 5120
    v_mfma_f32_16x16x32_bf16 v[180:183], v[84:87], v[100:103], v[180:183]
    s_add_u32 s6, s6, s4
    v_mfma_f32_16x16x32_bf16 v[184:187], v[88:91], v[100:103], v[184:187]
    buffer_load_dwordx4 v[44:47], v1, s[52:55], s6 offen offset:0 sc1
    v_mfma_f32_16x16x32_bf16 v[188:191], v[92:95], v[100:103], v[188:191]
    buffer_load_dwordx4 v[48:51], v1, s[52:55], s6 offen offset:1024 sc1
    v_mfma_f32_16x16x32_bf16 v[192:195], v[96:99], v[100:103], v[192:195]
    buffer_load_dwordx4 v[52:55], v1, s[52:55], s6 offen offset:2048 sc1
    v_mfma_f32_16x16x32_bf16 v[196:199], v[80:83], v[104:107], v[196:199]
    buffer_load_dwordx4 v[56:59], v1, s[52:55], s6 offen offset:3072 sc1
    v_mfma_f32_16x16x32_bf16 v[200:203], v[84:87], v[104:107], v[200:203]
    buffer_load_dwordx4 v[60:63], v156, s[52:55], s6 offen sc1
    v_mfma_f32_16x16x32_bf16 v[204:207], v[88:91], v[104:107], v[204:207]
    s_add_u32 s8, s8, 4
    v_mfma_f32_16x16x32_bf16 v[208:211], v[92:95], v[104:107], v[208:211]
    s_cmp_ge_u32 s8, 54
    v_mfma_f32_16x16x32_bf16 v[212:215], v[96:99], v[104:107], v[212:215]
    s_cselect_b32 s10, 54, 0
    v_mfma_f32_16x16x32_bf16 v[216:219], v[80:83], v[108:111], v[216:219]
    s_sub_u32 s8, s8, s10
    v_mfma_f32_16x16x32_bf16 v[220:223], v[84:87], v[108:111], v[220:223]
    s_lshl_b32 s7, s9, 10
    v_mfma_f32_16x16x32_bf16 v[224:227], v[88:91], v[108:111], v[224:227]
    s_add_u32 s7, s7, s5
    v_mfma_f32_16x16x32_bf16 v[228:231], v[92:95], v[108:111], v[228:231]
    buffer_load_dwordx4 v[64:67], v152, s[48:51], s7 offen sc1
    v_mfma_f32_16x16x32_bf16 v[232:235], v[96:99], v[108:111], v[232:235]
    buffer_load_dwordx4 v[68:71], v153, s[48:51], s7 offen sc1
    v_mfma_f32_16x16x32_bf16 v[236:239], v[80:83], v[112:115], v[236:239]
    buffer_load_dwordx4 v[72:75], v154, s[48:51], s7 offen sc1
    v_mfma_f32_16x16x32_bf16 v[240:243], v[84:87], v[112:115], v[240:243]
    buffer_load_dwordx4 v[76:79], v155, s[48:51], s7 offen sc1
    v_mfma_f32_16x16x32_bf16 v[244:247], v[88:91], v[112:115], v[244:247]
    s_add_u32 s9, s9, 4
    v_mfma_f32_16x16x32_bf16 v[248:251], v[92:95], v[112:115], v[248:251]
    s_cmp_ge_u32 s9, 54
    v_mfma_f32_16x16x32_bf16 v[252:255], v[96:99], v[112:115], v[252:255]
    s_cselect_b32 s10, 54, 0
    s_sub_u32 s9, s9, s10
    s_waitcnt vmcnt(18)
    v_mfma_f32_16x16x32_bf16 v[176:179], v[116:119], v[136:139], v[176:179]
    v_mfma_f32_16x16x32_bf16 v[180:183], v[120:123], v[136:139], v[180:183]
    v_mfma_f32_16x16x32_bf16 v[184:187], v[124:127], v[136:139], v[184:187]
    v_mfma_f32_16x16x32_bf16 v[188:191], v[128:131], v[136:139], v[188:191]
    v_mfma_f32_16x16x32_bf16 v[192:195], v[132:135], v[136:139], v[192:195]
    v_mfma_f32_16x16x32_bf16 v[196:199], v[116:119], v[140:143], v[196:199]
    v_mfma_f32_16x16x32_bf16 v[200:203], v[120:123], v[140:143], v[200:203]
    v_mfma_f32_16x16x32_bf16 v[204:207], v[124:127], v[140:143], v[204:207]
    v_mfma_f32_16x16x32_bf16 v[208:211], v[128:131], v[140:143], v[208:211]
    v_mfma_f32_16x16x32_bf16 v[212:215], v[132:135], v[140:143], v[212:215]
    v_mfma_f32_16x16x32_bf16 v[216:219], v[116:119], v[144:147], v[216:219]
    v_mfma_f32_16x16x32_bf16 v[220:223], v[120:123], v[144:147], v[220:223]
    v_mfma_f32_16x16x32_bf16 v[224:227], v[124:127], v[144:147], v[224:227]
    v_mfma_f32_16x16x32_bf16 v[228:231], v[128:131], v[144:147], v[228:231]
    v_mfma_f32_16x16x32_bf16 v[232:235], v[132:135], v[144:147], v[232:235]
    v_mfma_f32_16x16x32_bf16 v[236:239], v[116:119], v[148:151], v[236:239]
    v_mfma_f32_16x16x32_bf16 v[240:243], v[120:123], v[148:151], v[240:243]
    v_mfma_f32_16x16x32_bf16 v[244:247], v[124:127], v[148:151], v[244:247]
    v_mfma_f32_16x16x32_bf16 v[248:251], v[128:131], v[148:151], v[248:251]
    v_mfma_f32_16x16x32_bf16 v[252:255], v[132:135], v[148:151], v[252:255]
    s_waitcnt vmcnt(9)
    v_mfma_f32_16x16x32_bf16 v[176:179], v[8:11], v[28:31], v[176:179]
    v_mfma_f32_16x16x32_bf16 v[180:183], v[12:15], v[28:31], v[180:183]
    v_mfma_f32_16x16x32_bf16 v[184:187], v[16:19], v[28:31], v[184:187]
    v_mfma_f32_16x16x32_bf16 v[188:191], v[20:23], v[28:31], v[188:191]
    v_mfma_f32_16x16x32_bf16 v[192:195], v[24:27], v[28:31], v[192:195]
    v_mfma_f32_16x16x32_bf16 v[196:199], v[8:11], v[32:35], v[196:199]
    v_mfma_f32_16x16x32_bf16 v[200:203], v[12:15], v[32:35], v[200:203]
    v_mfma_f32_16x16x32_bf16 v[204:207], v[16:19], v[32:35], v[204:207]
    v_mfma_f32_16x16x32_bf16 v[208:211], v[20:23], v[32:35], v[208:211]
    v_mfma_f32_16x16x32_bf16 v[212:215], v[24:27], v[32:35], v[212:215]
    v_mfma_f32_16x16x32_bf16 v[216:219], v[8:11], v[36:39], v[216:219]
    v_mfma_f32_16x16x32_bf16 v[220:223], v[12:15], v[36:39], v[220:223]
    v_mfma_f32_16x16x32_bf16 v[224:227], v[16:19], v[36:39], v[224:227]
    v_mfma_f32_16x16x32_bf16 v[228:231], v[20:23], v[36:39], v[228:231]
    v_mfma_f32_16x16x32_bf16 v[232:235], v[24:27], v[36:39], v[232:235]
    v_mfma_f32_16x16x32_bf16 v[236:239], v[8:11], v[40:43], v[236:239]
    v_mfma_f32_16x16x32_bf16 v[240:243], v[12:15], v[40:43], v[240:243]
    v_mfma_f32_16x16x32_bf16 v[244:247], v[16:19], v[40:43], v[244:247]
    v_mfma_f32_16x16x32_bf16 v[248:251], v[20:23], v[40:43], v[248:251]
    v_mfma_f32_16x16x32_bf16 v[252:255], v[24:27], v[40:43], v[252:255]
    s_cmp_ge_u32 s3, 2
    s_cbranch_scc1 g2_skip_53
    s_waitcnt vmcnt(0)
    v_mfma_f32_16x16x32_bf16 v[176:179], v[44:47], v[64:67], v[176:179]
    v_mfma_f32_16x16x32_bf16 v[180:183], v[48:51], v[64:67], v[180:183]
    v_mfma_f32_16x16x32_bf16 v[184:187], v[52:55], v[64:67], v[184:187]
    v_mfma_f32_16x16x32_bf16 v[188:191], v[56:59], v[64:67], v[188:191]
    v_mfma_f32_16x16x32_bf16 v[192:195], v[60:63], v[64:67], v[192:195]
    v_mfma_f32_16x16x32_bf16 v[196:199], v[44:47], v[68:71], v[196:199]
    v_mfma_f32_16x16x32_bf16 v[200:203], v[48:51], v[68:71], v[200:203]
    v_mfma_f32_16x16x32_bf16 v[204:207], v[52:55], v[68:71], v[204:207]
    v_mfma_f32_16x16x32_bf16 v[208:211], v[56:59], v[68:71], v[208:211]
    v_mfma_f32_16x16x32_bf16 v[212:215], v[60:63], v[68:71], v[212:215]
    v_mfma_f32_16x16x32_bf16 v[216:219], v[44:47], v[72:75], v[216:219]
    v_mfma_f32_16x16x32_bf16 v[220:223], v[48:51], v[72:75], v[220:223]
    v_mfma_f32_16x16x32_bf16 v[224:227], v[52:55], v[72:75], v[224:227]
    v_mfma_f32_16x16x32_bf16 v[228:231], v[56:59], v[72:75], v[228:231]
    v_mfma_f32_16x16x32_bf16 v[232:235], v[60:63], v[72:75], v[232:235]
    v_mfma_f32_16x16x32_bf16 v[236:239], v[44:47], v[76:79], v[236:239]
    v_mfma_f32_16x16x32_bf16 v[240:243], v[48:51], v[76:79], v[240:243]
    v_mfma_f32_16x16x32_bf16 v[244:247], v[52:55], v[76:79], v[244:247]
    v_mfma_f32_16x16x32_bf16 v[248:251], v[56:59], v[76:79], v[248:251]
    v_mfma_f32_16x16x32_bf16 v[252:255], v[60:63], v[76:79], v[252:255]
g2_skip_53:
    s_nop 3
    s_cmp_eq_u32 s3, 0
    s_cbranch_scc1 g2_nw_54
    s_sub_u32 s6, s3, 1
    s_and_b32 s6, s6, 3
    s_mul_i32 s6, s6, 5120
    s_add_u32 s6, s6, 0
    v_add_u32 v172, s6, v1
    ds_write_b128 v172, v[176:179] offset:0
    ds_write_b128 v172, v[180:183] offset:1024
    ds_write_b128 v172, v[184:187] offset:2048
    ds_write_b128 v172, v[188:191] offset:3072
    ds_write_b128 v172, v[192:195] offset:4096
g2_nw_54:
    s_cmp_eq_u32 s3, 1
    s_cbranch_scc1 g2_nw_55
    s_sub_u32 s6, s3, 2
    s_and_b32 s6, s6, 3
    s_mul_i32 s6, s6, 5120
    s_add_u32 s6, s6, 15360
    v_add_u32 v173, s6, v1
    ds_write_b128 v173, v[196:199] offset:0
    ds_write_b128 v173, v[200:203] offset:1024
    ds_write_b128 v173, v[204:207] offset:2048
    ds_write_b128 v173, v[208:211] offset:3072
    ds_write_b128 v173, v[212:215] offset:4096
g2_nw_55:
    s_cmp_eq_u32 s3, 2
    s_cbranch_scc1 g2_nw_56
    s_sub_u32 s6, s3, 3
    s_and_b32 s6, s6, 3
    s_mul_i32 s6, s6, 5120
    s_add_u32 s6, s6, 30720
    v_add_u32 v174, s6, v1
    ds_write_b128 v174, v[216:219] offset:0
    ds_write_b128 v174, v[220:223] offset:1024
    ds_write_b128 v174, v[224:227] offset:2048
    ds_write_b128 v174, v[228:231] offset:3072
    ds_write_b128 v174, v[232:235] offset:4096
g2_nw_56:
    s_cmp_eq_u32 s3, 3
    s_cbranch_scc1 g2_nw_57
    s_sub_u32 s6, s3, 4
    s_and_b32 s6, s6, 3
    s_mul_i32 s6, s6, 5120
    s_add_u32 s6, s6, 46080
    v_add_u32 v175, s6, v1
    ds_write_b128 v175, v[236:239] offset:0
    ds_write_b128 v175, v[240:243] offset:1024
    ds_write_b128 v175, v[244:247] offset:2048
    ds_write_b128 v175, v[248:251] offset:3072
    ds_write_b128 v175, v[252:255] offset:4096
g2_nw_57:
    s_cmp_lg_u32 s3, 0
    s_cbranch_scc1 g2_mv_58
    v_mov_b32 v8, v176
    v_mov_b32 v9, v177
    v_mov_b32 v10, v178
    v_mov_b32 v11, v179
    v_mov_b32 v12, v180
    v_mov_b32 v13, v181
    v_mov_b32 v14, v182
    v_mov_b32 v15, v183
    v_mov_b32 v16, v184
    v_mov_b32 v17, v185
    v_mov_b32 v18, v186
    v_mov_b32 v19, v187
    v_mov_b32 v20, v188
    v_mov_b32 v21, v189
    v_mov_b32 v22, v190
    v_mov_b32 v23, v191
    v_mov_b32 v24, v192
    v_mov_b32 v25, v193
    v_mov_b32 v26, v194
    v_mov_b32 v27, v195
g2_mv_58:
    s_cmp_lg_u32 s3, 1
    s_cbranch_scc1 g2_mv_59
    v_mov_b32 v8, v196
    v_mov_b32 v9, v197
    v_mov_b32 v10, v198
    v_mov_b32 v11, v199
    v_mov_b32 v12, v200
    v_mov_b32 v13, v201
    v_mov_b32 v14, v202
    v_mov_b32 v15, v203
    v_mov_b32 v16, v204
    v_mov_b32 v17, v205
    v_mov_b32 v18, v206
    v_mov_b32 v19, v207
    v_mov_b32 v20, v208
    v_mov_b32 v21, v209
    v_mov_b32 v22, v210
    v_mov_b32 v23, v211
    v_mov_b32 v24, v212
    v_mov_b32 v25, v213
    v_mov_b32 v26, v214
    v_mov_b32 v27, v215
g2_mv_59:
    s_cmp_lg_u32 s3, 2
    s_cbranch_scc1 g2_mv_60
    v_mov_b32 v8, v216
    v_mov_b32 v9, v217
    v_mov_b32 v10, v218
    v_mov_b32 v11, v219
    v_mov_b32 v12, v220
    v_mov_b32 v13, v221
    v_mov_b32 v14, v222
    v_mov_b32 v15, v223
    v_mov_b32 v16, v224
    v_mov_b32 v17, v225
    v_mov_b32 v18, v226
    v_mov_b32 v19, v227
    v_mov_b32 v20, v228
    v_mov_b32 v21, v229
    v_mov_b32 v22, v230
    v_mov_b32 v23, v231
    v_mov_b32 v24, v232
    v_mov_b32 v25, v233
    v_mov_b32 v26, v234
    v_mov_b32 v27, v235
g2_mv_60:
    s_cmp_lg_u32 s3, 3
    s_cbranch_scc1 g2_mv_61
    v_mov_b32 v8, v236
    v_mov_b32 v9, v237
    v_mov_b32 v10, v238
    v_mov_b32 v11, v239
    v_mov_b32 v12, v240
    v_mov_b32 v13, v241
    v_mov_b32 v14, v242
    v_mov_b32 v15, v243
    v_mov_b32 v16, v244
    v_mov_b32 v17, v245
    v_mov_b32 v18, v246
    v_mov_b32 v19, v247
    v_mov_b32 v20, v248
    v_mov_b32 v21, v249
    v_mov_b32 v22, v250
    v_mov_b32 v23, v251
    v_mov_b32 v24, v252
    v_mov_b32 v25, v253
    v_mov_b32 v26, v254
    v_mov_b32 v27, v255
g2_mv_61:
    s_mul_i32 s6, s3, 15360
    v_add_u32 v5, s6, v1
    s_mov_b32 s11, 0xffff0000
    s_waitcnt vmcnt(0) lgkmcnt(0)
    s_cmp_lg_u32 s3, 3
    s_cbranch_scc1 w3i_62
    s_add_u32 s12, s46, 16842752
    s_addc_u32 s13, s47, 0
    s_mov_b32 s14, 8192
    s_mov_b32 s15, 0x00020000
    v_lshlrev_b32 v173, 2, v0
    s_lshl_b32 s95, s99, 7
    s_add_u32 s95, s95, 4096
    s_lshl_b32 s96, s98, 2
    s_add_u32 s96, s96, 5120
    buffer_load_dword v172, v173, s[12:15], s95 offen sc1
    buffer_load_dword v174, v173, s[12:15], s96 offen sc1
w3i_62:
    s_barrier
    ds_read_b128 v[32:35], v5 offset:0
    ds_read_b128 v[36:39], v5 offset:1024
    ds_read_b128 v[40:43], v5 offset:2048
    ds_read_b128 v[44:47], v5 offset:3072
    ds_read_b128 v[48:51], v5 offset:4096
    ds_read_b128 v[52:55], v5 offset:5120
    ds_read_b128 v[56:59], v5 offset:6144
    ds_read_b128 v[60:63], v5 offset:7168
    ds_read_b128 v[64:67], v5 offset:8192
    ds_read_b128 v[68:71], v5 offset:9216
    ds_read_b128 v[72:75], v5 offset:10240
    ds_read_b128 v[76:79], v5 offset:11264
    ds_read_b128 v[80:83], v5 offset:12288
    ds_read_b128 v[84:87], v5 offset:13312
    ds_read_b128 v[88:91], v5 offset:14336
    v_lshlrev_b32 v128, 16, v160
    v_and_b32 v129, s11, v160
    v_lshlrev_b32 v130, 16, v161
    v_and_b32 v131, s11, v161
    v_lshlrev_b32 v132, 16, v162
    v_and_b32 v133, s11, v162
    v_lshlrev_b32 v134, 16, v163
    v_and_b32 v135, s11, v163
    v_lshlrev_b32 v136, 16, v164
    v_and_b32 v137, s11, v164
    v_lshlrev_b32 v138, 16, v165
    v_and_b32 v139, s11, v165
    v_lshlrev_b32 v140, 16, v166
    v_and_b32 v141, s11, v166
    v_lshlrev_b32 v142, 16, v167
    v_and_b32 v143, s11, v167
    v_lshlrev_b32 v144, 16, v168
    v_and_b32 v145, s11, v168
    v_lshlrev_b32 v146, 16, v169
    v_and_b32 v147, s11, v169
    s_waitcnt lgkmcnt(10)
    v_add_f32 v8, v8, v32
    v_add_f32 v9, v9, v33
    v_add_f32 v10, v10, v34
    v_add_f32 v11, v11, v35
    v_add_f32 v12, v12, v36
    v_add_f32 v13, v13, v37
    v_add_f32 v14, v14, v38
    v_add_f32 v15, v15, v39
    v_add_f32 v16, v16, v40
    v_add_f32 v17, v17, v41
    v_add_f32 v18, v18, v42
    v_add_f32 v19, v19, v43
    v_add_f32 v20, v20, v44
    v_add_f32 v21, v21, v45
    v_add_f32 v22, v22, v46
    v_add_f32 v23, v23, v47
    v_add_f32 v24, v24, v48
    v_add_f32 v25, v25, v49
    v_add_f32 v26, v26, v50
    v_add_f32 v27, v27, v51
    s_waitcnt lgkmcnt(5)
    v_add_f32 v8, v8, v52
    v_add_f32 v9, v9, v53
    v_add_f32 v10, v10, v54
    v_add_f32 v11, v11, v55
    v_add_f32 v12, v12, v56
    v_add_f32 v13, v13, v57
    v_add_f32 v14, v14, v58
    v_add_f32 v15, v15, v59
    v_add_f32 v16, v16, v60
    v_add_f32 v17, v17, v61
    v_add_f32 v18, v18, v62
    v_add_f32 v19, v19, v63
    v_add_f32 v20, v20, v64
    v_add_f32 v21, v21, v65
    v_add_f32 v22, v22, v66
    v_add_f32 v23, v23, v67
    v_add_f32 v24, v24, v68
    v_add_f32 v25, v25, v69
    v_add_f32 v26, v26, v70
    v_add_f32 v27, v27, v71
    s_waitcnt lgkmcnt(0)
    v_add_f32 v8, v8, v72
    v_add_f32 v9, v9, v73
    v_add_f32 v10, v10, v74
    v_add_f32 v11, v11, v75
    v_add_f32 v12, v12, v76
    v_add_f32 v13, v13, v77
    v_add_f32 v14, v14, v78
    v_add_f32 v15, v15, v79
    v_add_f32 v16, v16, v80
    v_add_f32 v17, v17, v81
    v_add_f32 v18, v18, v82
    v_add_f32 v19, v19, v83
    v_add_f32 v20, v20, v84
    v_add_f32 v21, v21, v85
    v_add_f32 v22, v22, v86
    v_add_f32 v23, v23, v87
    v_add_f32 v24, v24, v88
    v_add_f32 v25, v25, v89
    v_add_f32 v26, v26, v90
    v_add_f32 v27, v27, v91
    v_cvt_pk_bf16_f32 v32, v8, v9
    v_cvt_pk_bf16_f32 v33, v10, v11
    v_lshlrev_b32 v34, 16, v32
    v_and_b32 v35, s11, v32
    v_lshlrev_b32 v36, 16, v33
    v_and_b32 v37, s11, v33
    v_add_f32 v34, v34, v128
    v_add_f32 v35, v35, v129
    v_add_f32 v36, v36, v130
    v_add_f32 v37, v37, v131
    v_cvt_pk_bf16_f32 v32, v34, v35
    v_cvt_pk_bf16_f32 v33, v36, v37
    v_lshlrev_b32 v148, 16, v32
    v_and_b32 v149, s11, v32
    v_lshlrev_b32 v150, 16, v33
    v_and_b32 v151, s11, v33
    v_cvt_pk_bf16_f32 v32, v12, v13
    v_cvt_pk_bf16_f32 v33, v14, v15
    v_lshlrev_b32 v34, 16, v32
    v_and_b32 v35, s11, v32
    v_lshlrev_b32 v36, 16, v33
    v_and_b32 v37, s11, v33
    v_add_f32 v34, v34, v132
    v_add_f32 v35, v35, v133
    v_add_f32 v36, v36, v134
    v_add_f32 v37, v37, v135
    v_cvt_pk_bf16_f32 v32, v34, v35
    v_cvt_pk_bf16_f32 v33, v36, v37
    v_lshlrev_b32 v152, 16, v32
    v_and_b32 v153, s11, v32
    v_lshlrev_b32 v154, 16, v33
    v_and_b32 v155, s11, v33
    v_cvt_pk_bf16_f32 v32, v16, v17
    v_cvt_pk_bf16_f32 v33, v18, v19
    v_lshlrev_b32 v34, 16, v32
    v_and_b32 v35, s11, v32
    v_lshlrev_b32 v36, 16, v33
    v_and_b32 v37, s11, v33
    v_add_f32 v34, v34, v136
    v_add_f32 v35, v35, v137
    v_add_f32 v36, v36, v138
    v_add_f32 v37, v37, v139
    v_cvt_pk_bf16_f32 v32, v34, v35
    v_cvt_pk_bf16_f32 v33, v36, v37
    v_lshlrev_b32 v156, 16, v32
    v_and_b32 v157, s11, v32
    v_lshlrev_b32 v158, 16, v33
    v_and_b32 v159, s11, v33
    v_cvt_pk_bf16_f32 v32, v20, v21
    v_cvt_pk_bf16_f32 v33, v22, v23
    v_lshlrev_b32 v34, 16, v32
    v_and_b32 v35, s11, v32
    v_lshlrev_b32 v36, 16, v33
    v_and_b32 v37, s11, v33
    v_add_f32 v34, v34, v140
    v_add_f32 v35, v35, v141
    v_add_f32 v36, v36, v142
    v_add_f32 v37, v37, v143
    v_cvt_pk_bf16_f32 v32, v34, v35
    v_cvt_pk_bf16_f32 v33, v36, v37
    v_lshlrev_b32 v160, 16, v32
    v_and_b32 v161, s11, v32
    v_lshlrev_b32 v162, 16, v33
    v_and_b32 v163, s11, v33
    v_cvt_pk_bf16_f32 v32, v24, v25
    v_cvt_pk_bf16_f32 v33, v26, v27
    v_lshlrev_b32 v34, 16, v32
    v_and_b32 v35, s11, v32
    v_lshlrev_b32 v36, 16, v33
    v_and_b32 v37, s11, v33
    v_add_f32 v34, v34, v144
    v_add_f32 v35, v35, v145
    v_add_f32 v36, v36, v146
    v_add_f32 v37, v37, v147
    v_cvt_pk_bf16_f32 v32, v34, v35
    v_cvt_pk_bf16_f32 v33, v36, v37
    v_lshlrev_b32 v164, 16, v32
    v_and_b32 v165, s11, v32
    v_lshlrev_b32 v166, 16, v33
    v_and_b32 v167, s11, v33
    s_cmp_lg_u32 s3, 3
    s_cbranch_scc1 g2_w3_63
    s_waitcnt vmcnt(0)
    v_cmp_eq_u32 vcc, s101, v172
    s_nop 0
    s_mov_b32 s90, vcc_lo
    v_cmp_eq_u32 vcc, s101, v174
    s_nop 0
    s_and_b32 s91, vcc_lo, 1
    s_cmp_eq_u32 s90, -1
    s_cselect_b32 s91, s91, 0
    s_cmp_eq_u32 s91, 1
    s_cbranch_scc1 w3ok_64
    s_add_u32 s12, s46, 16842752
    s_addc_u32 s13, s47, 0
    s_mov_b32 s14, 8192
    s_mov_b32 s15, 0x00020000
    v_lshlrev_b32 v173, 2, v0
    s_mov_b32 s10, 400000
poll_66:
    buffer_load_dword v172, v173, s[12:15], s95 offen sc1
    s_waitcnt vmcnt(0)
    v_cmp_eq_u32 vcc, s101, v172
    s_sub_u32 s10, s10, 1
    s_cmp_eq_u32 s10, 0
    s_cbranch_scc1 pollto_68
    s_and_b32 s11, vcc_lo, 0xffffffff
    s_cmp_eq_u32 s11, 0xffffffff
    s_cbranch_scc1 polld_67
    s_sleep 1
    s_branch poll_66
pollto_68:
polld_67:
    s_mov_b32 s10, 400000
poll_69:
    buffer_load_dword v172, v173, s[12:15], s96 offen sc1
    s_waitcnt vmcnt(0)
    v_cmp_eq_u32 vcc, s101, v172
    s_sub_u32 s10, s10, 1
    s_cmp_eq_u32 s10, 0
    s_cbranch_scc1 pollto_71
    s_and_b32 s11, vcc_lo, 0x1
    s_cmp_eq_u32 s11, 0x1
    s_cbranch_scc1 polld_70
    s_sleep 1
    s_branch poll_69
pollto_71:
polld_70:
w3ok_64:
    v_lshrrev_b32 v3, 3, v0
    v_lshlrev_b32 v3, 12, v3
    v_and_b32 v4, 7, v0
    v_lshl_add_u32 v3, v4, 4, v3
    s_mul_i32 s6, s99, 327680
    s_lshl_b32 s7, s98, 7
    s_add_u32 s6, s6, s7
    s_mov_b32 m0, 61440
    s_nop 0
    buffer_load_dwordx4 v3, s[56:59], s6 offen sc1 lds
    s_add_u32 s6, s6, 32768
    s_mov_b32 m0, 62464
    s_nop 0
    buffer_load_dwordx4 v3, s[56:59], s6 offen sc1 lds
    s_add_u32 s6, s6, 32768
    s_mov_b32 m0, 63488
    s_nop 0
    buffer_load_dwordx4 v3, s[56:59], s6 offen sc1 lds
    s_add_u32 s6, s6, 32768
    s_mov_b32 m0, 64512
    s_nop 0
    buffer_load_dwordx4 v3, s[56:59], s6 offen sc1 lds
    s_add_u32 s6, s6, 32768
    s_mov_b32 m0, 65536
    s_nop 0
    buffer_load_dwordx4 v3, s[56:59], s6 offen sc1 lds
    s_add_u32 s6, s6, 32768
    s_mov_b32 m0, 66560
    s_nop 0
    buffer_load_dwordx4 v3, s[56:59], s6 offen sc1 lds
    s_add_u32 s6, s6, 32768
    s_mov_b32 m0, 67584
    s_nop 0
    buffer_load_dwordx4 v3, s[56:59], s6 offen sc1 lds
    s_add_u32 s6, s6, 32768
    s_mov_b32 m0, 68608
    s_nop 0
    buffer_load_dwordx4 v3, s[56:59], s6 offen sc1 lds
    s_add_u32 s6, s6, 32768
    s_mov_b32 m0, 69632
    s_nop 0
    buffer_load_dwordx4 v3, s[56:59], s6 offen sc1 lds
    s_add_u32 s6, s6, 32768
    s_mov_b32 m0, 70656
    s_nop 0
    buffer_load_dwordx4 v3, s[56:59], s6 offen sc1 lds
    s_add_u32 s6, s6, 32768
    v_lshlrev_b32 v4, 2, v0
    s_lshl_b32 s6, s98, 8
    s_mov_b32 m0, 73728
    s_nop 0
    buffer_load_dword v4, s[64:67], s6 offen sc1 lds
g2_w3_63:
    v_lshrrev_b32 v3, 4, v0
    v_bfe_u32 v4, v0, 2, 2
    v_lshl_add_u32 v4, v3, 2, v4
    v_lshlrev_b32 v4, 7, v4
    v_and_b32 v6, 3, v0
    v_lshl_add_u32 v4, v6, 3, v4
    s_lshl_b32 s6, s3, 5
    s_add_u32 s6, s6, 61440
    v_add_u32 v4, s6, v4
    v_and_b32 v2, 15, v0
    v_mul_u32_u24 v2, 1280, v2
    v_and_b32 v6, 1, v3
    v_lshlrev_b32 v28, 3, v3
    v_mul_u32_u24 v6, 24, v6
    v_add3_u32 v31, v2, v28, v6
    v_add_u32 v29, v2, v28
    s_lshl_b32 s6, s98, 6
    s_lshl_b32 s7, s3, 4
    s_add_u32 s6, s6, s7
    s_mul_i32 s6, s6, 1280
    s_mul_i32 s7, s99, 160
    s_add_u32 s6, s6, s7
    s_mov_b32 s11, 0xffff0000
    s_waitcnt vmcnt(0)
    s_barrier
    v_and_b32 v5, 15, v0
    v_lshlrev_b32 v5, 2, v5
    s_lshl_b32 s7, s3, 6
    s_add_u32 s7, s7, 73728
    v_add_u32 v5, s7, v5
    ds_read_b32 v170, v5
    ds_read_b64_tr_b16 v[96:97], v4 offset:0
    ds_read_b64_tr_b16 v[98:99], v4 offset:2048
    ds_read_b64_tr_b16 v[100:101], v4 offset:4096
    ds_read_b64_tr_b16 v[102:103], v4 offset:6144
    ds_read_b64_tr_b16 v[104:105], v4 offset:8192
    s_waitcnt lgkmcnt(5)
    v_sub_f32 v30, 1.0, v170
    v_cvt_pk_bf16_f32 v30, v30, v30
    v_lshlrev_b32 v30, 16, v30
    v_mul_f32 v148, v30, v148
    v_mul_f32 v149, v30, v149
    v_mul_f32 v150, v30, v150
    v_mul_f32 v151, v30, v151
    v_cvt_pk_bf16_f32 v178, v148, v149
    v_cvt_pk_bf16_f32 v179, v150, v151
    v_mul_f32 v152, v30, v152
    v_mul_f32 v153, v30, v153
    v_mul_f32 v154, v30, v154
    v_mul_f32 v155, v30, v155
    v_cvt_pk_bf16_f32 v180, v152, v153
    v_cvt_pk_bf16_f32 v181, v154, v155
    v_mul_f32 v156, v30, v156
    v_mul_f32 v157, v30, v157
    v_mul_f32 v158, v30, v158
    v_mul_f32 v159, v30, v159
    v_cvt_pk_bf16_f32 v182, v156, v157
    v_cvt_pk_bf16_f32 v183, v158, v159
    v_mul_f32 v160, v30, v160
    v_mul_f32 v161, v30, v161
    v_mul_f32 v162, v30, v162
    v_mul_f32 v163, v30, v163
    v_cvt_pk_bf16_f32 v184, v160, v161
    v_cvt_pk_bf16_f32 v185, v162, v163
    v_mul_f32 v164, v30, v164
    v_mul_f32 v165, v30, v165
    v_mul_f32 v166, v30, v166
    v_mul_f32 v167, v30, v167
    v_cvt_pk_bf16_f32 v186, v164, v165
    v_cvt_pk_bf16_f32 v187, v166, v167
    s_waitcnt lgkmcnt(0)
    v_lshlrev_b32 v38, 16, v96
    v_and_b32 v39, s11, v96
    v_lshlrev_b32 v40, 16, v97
    v_and_b32 v41, s11, v97
    v_mul_f32 v38, v170, v38
    v_mul_f32 v39, v170, v39
    v_mul_f32 v40, v170, v40
    v_mul_f32 v41, v170, v41
    v_cvt_pk_bf16_f32 v42, v38, v39
    v_cvt_pk_bf16_f32 v43, v40, v41
    v_lshlrev_b32 v34, 16, v178
    v_and_b32 v35, s11, v178
    v_lshlrev_b32 v36, 16, v179
    v_and_b32 v37, s11, v179
    v_lshlrev_b32 v38, 16, v42
    v_and_b32 v39, s11, v42
    v_lshlrev_b32 v40, 16, v43
    v_and_b32 v41, s11, v43
    v_add_f32 v34, v38, v34
    v_add_f32 v35, v39, v35
    v_add_f32 v36, v40, v36
    v_add_f32 v37, v41, v37
    v_cvt_pk_bf16_f32 v108, v34, v35
    v_cvt_pk_bf16_f32 v109, v36, v37
    v_lshlrev_b32 v50, 16, v98
    v_and_b32 v51, s11, v98
    v_lshlrev_b32 v52, 16, v99
    v_and_b32 v53, s11, v99
    v_mul_f32 v50, v170, v50
    v_mul_f32 v51, v170, v51
    v_mul_f32 v52, v170, v52
    v_mul_f32 v53, v170, v53
    v_cvt_pk_bf16_f32 v54, v50, v51
    v_cvt_pk_bf16_f32 v55, v52, v53
    v_lshlrev_b32 v46, 16, v180
    v_and_b32 v47, s11, v180
    v_lshlrev_b32 v48, 16, v181
    v_and_b32 v49, s11, v181
    v_lshlrev_b32 v50, 16, v54
    v_and_b32 v51, s11, v54
    v_lshlrev_b32 v52, 16, v55
    v_and_b32 v53, s11, v55
    v_add_f32 v46, v50, v46
    v_add_f32 v47, v51, v47
    v_add_f32 v48, v52, v48
    v_add_f32 v49, v53, v49
    v_cvt_pk_bf16_f32 v110, v46, v47
    v_cvt_pk_bf16_f32 v111, v48, v49
    s_nop 1
    v_permlane16_swap_b32 v108, v110
    v_permlane16_swap_b32 v109, v111
    s_nop 0
    buffer_store_dwordx4 v[108:111], v31, s[60:63], s6 offen offset:0
    v_lshlrev_b32 v38, 16, v100
    v_and_b32 v39, s11, v100
    v_lshlrev_b32 v40, 16, v101
    v_and_b32 v41, s11, v101
    v_mul_f32 v38, v170, v38
    v_mul_f32 v39, v170, v39
    v_mul_f32 v40, v170, v40
    v_mul_f32 v41, v170, v41
    v_cvt_pk_bf16_f32 v42, v38, v39
    v_cvt_pk_bf16_f32 v43, v40, v41
    v_lshlrev_b32 v34, 16, v182
    v_and_b32 v35, s11, v182
    v_lshlrev_b32 v36, 16, v183
    v_and_b32 v37, s11, v183
    v_lshlrev_b32 v38, 16, v42
    v_and_b32 v39, s11, v42
    v_lshlrev_b32 v40, 16, v43
    v_and_b32 v41, s11, v43
    v_add_f32 v34, v38, v34
    v_add_f32 v35, v39, v35
    v_add_f32 v36, v40, v36
    v_add_f32 v37, v41, v37
    v_cvt_pk_bf16_f32 v112, v34, v35
    v_cvt_pk_bf16_f32 v113, v36, v37
    v_lshlrev_b32 v50, 16, v102
    v_and_b32 v51, s11, v102
    v_lshlrev_b32 v52, 16, v103
    v_and_b32 v53, s11, v103
    v_mul_f32 v50, v170, v50
    v_mul_f32 v51, v170, v51
    v_mul_f32 v52, v170, v52
    v_mul_f32 v53, v170, v53
    v_cvt_pk_bf16_f32 v54, v50, v51
    v_cvt_pk_bf16_f32 v55, v52, v53
    v_lshlrev_b32 v46, 16, v184
    v_and_b32 v47, s11, v184
    v_lshlrev_b32 v48, 16, v185
    v_and_b32 v49, s11, v185
    v_lshlrev_b32 v50, 16, v54
    v_and_b32 v51, s11, v54
    v_lshlrev_b32 v52, 16, v55
    v_and_b32 v53, s11, v55
    v_add_f32 v46, v50, v46
    v_add_f32 v47, v51, v47
    v_add_f32 v48, v52, v48
    v_add_f32 v49, v53, v49
    v_cvt_pk_bf16_f32 v114, v46, v47
    v_cvt_pk_bf16_f32 v115, v48, v49
    s_nop 1
    v_permlane16_swap_b32 v112, v114
    v_permlane16_swap_b32 v113, v115
    s_nop 0
    buffer_store_dwordx4 v[112:115], v31, s[60:63], s6 offen offset:64
    v_lshlrev_b32 v38, 16, v104
    v_and_b32 v39, s11, v104
    v_lshlrev_b32 v40, 16, v105
    v_and_b32 v41, s11, v105
    v_mul_f32 v38, v170, v38
    v_mul_f32 v39, v170, v39
    v_mul_f32 v40, v170, v40
    v_mul_f32 v41, v170, v41
    v_cvt_pk_bf16_f32 v42, v38, v39
    v_cvt_pk_bf16_f32 v43, v40, v41
    v_lshlrev_b32 v34, 16, v186
    v_and_b32 v35, s11, v186
    v_lshlrev_b32 v36, 16, v187
    v_and_b32 v37, s11, v187
    v_lshlrev_b32 v38, 16, v42
    v_and_b32 v39, s11, v42
    v_lshlrev_b32 v40, 16, v43
    v_and_b32 v41, s11, v43
    v_add_f32 v34, v38, v34
    v_add_f32 v35, v39, v35
    v_add_f32 v36, v40, v36
    v_add_f32 v37, v41, v37
    v_cvt_pk_bf16_f32 v116, v34, v35
    v_cvt_pk_bf16_f32 v117, v36, v37
    buffer_store_dwordx2 v[116:117], v29, s[60:63], s6 offen offset:128
fz_end:
    s_endpgm
gated_mix__ssm_conv_s4d__dense_activation_squared_relu__prompt_kernel_end:
.section .rodata,"a"
.p2align 6
.amdhsa_kernel gated_mix__ssm_conv_s4d__dense_activation_squared_relu__prompt_kernel
  .amdhsa_next_free_vgpr 256
  .amdhsa_next_free_sgpr 102
  .amdhsa_accum_offset 256
  .amdhsa_group_segment_fixed_size 0
  .amdhsa_kernarg_size 128
  .amdhsa_user_sgpr_count 2
  .amdhsa_user_sgpr_kernarg_segment_ptr 1
  .amdhsa_system_sgpr_workgroup_id_x 1
.end_amdhsa_kernel
```
